```python
import torch

def _softmax(x, axis=-1):
    return torch.softmax(x, dim=axis)
def _gelu(x):
    return torch.nn.functional.gelu(x, approximate="tanh")
def _silu(x):
    return torch.nn.functional.silu(x)
def _sigmoid(x):
    return torch.sigmoid(x)
def _layernorm(x, axis=-1, eps=1e-5):
    m = x.mean(dim=axis, keepdim=True)
    v = x.var(dim=axis, keepdim=True, unbiased=False)
    return (x - m) / torch.sqrt(v + eps)
def _scatter_add(tgt, idx, src, axis=0):
    return tgt.clone().index_add_(axis, idx, src)
def _segment_sum(src, seg, n):
    out = torch.zeros((n,) + src.shape[1:], dtype=src.dtype)
    return out.index_add_(0, seg, src)
def _pad(x, pw):
    flat = tuple(v for pair in reversed(pw) for v in pair)
    return torch.nn.functional.pad(x, flat)

kernel_name = 'sequential_preLN__compressed_kv_cla__geglu_ffn__prompt'

def setup_inputs():

    _w = (lambda a: (lambda t: t.to(torch.bfloat16) if t.is_floating_point() else t)(torch.as_tensor(a)))
    def _A_setup():
        B, H, Sq, Sk, D, M = 1, 16, 2048, 2048, 256, 448
        Dc = 4 * D
        return {
            "x": _w((lambda *s: torch.randn(*s, dtype=torch.bfloat16) * 0.05)(B, Sq, M)),
            "c_kv": _w((lambda *s: torch.randn(*s, dtype=torch.bfloat16) * 0.4)(B, Sk, Dc)),
            "w_q": _w((lambda *s: torch.randn(*s, dtype=torch.bfloat16) * 3.2)(M, H, D) * (M ** -0.5)),
            "w_uk": _w((lambda *s: torch.randn(*s, dtype=torch.bfloat16) * 3.2)(Dc, H, D) * (Dc ** -0.5)),
            "w_uv": _w((lambda *s: torch.randn(*s, dtype=torch.bfloat16) * 0.4)(Dc, H, D) * (Dc ** -0.5)),
            "w_o": _w((lambda *s: torch.randn(*s, dtype=torch.bfloat16) * 0.4)(H, D, M) * ((H * D) ** -0.5)),
        }
    _A_in = _A_setup()

    def _B_setup():
        B, S, D, F = 1, 2048, 448, 1792
        return {
            "x": _w((lambda *s: torch.randn(*s, dtype=torch.bfloat16) * 0.05)(B, S, D)),
            "w_gate": _w((lambda *s: torch.randn(*s, dtype=torch.bfloat16) * 0.05)(D, F)),
            "w_up": _w((lambda *s: torch.randn(*s, dtype=torch.bfloat16) * 0.05)(D, F)),
            "w_down": _w((lambda *s: torch.randn(*s, dtype=torch.bfloat16) * 0.05)(F, D)),
        }
    _B_in = _B_setup()

    return {
        "A_x": _A_in["x"],
        "A_c_kv": _A_in["c_kv"],
        "A_w_q": _A_in["w_q"],
        "A_w_uk": _A_in["w_uk"],
        "A_w_uv": _A_in["w_uv"],
        "A_w_o": _A_in["w_o"],
        "B_x": _B_in["x"],
        "B_w_gate": _B_in["w_gate"],
        "B_w_up": _B_in["w_up"],
        "B_w_down": _B_in["w_down"],
    }

def reference(A_x, A_c_kv, A_w_q, A_w_uk, A_w_uv, A_w_o, B_x, B_w_gate, B_w_up, B_w_down):
    def _A_ref(x, c_kv, w_q, w_uk, w_uv, w_o):
        B, Sq, M = x.shape[0], x.shape[1], x.shape[2]
        Sk = c_kv.shape[1]
        H, D = w_q.shape[1], w_q.shape[2]
        q = torch.einsum("bqm,mhd->bhqd", x, w_q)
        k = torch.einsum("bkc,chd->bhkd", c_kv, w_uk)
        v = torch.einsum("bkc,chd->bhkd", c_kv, w_uv)
        scores = torch.einsum("bhqd,bhkd->bhqk", q, k) * (D ** -0.5)
        off = Sk - Sq
        qi = torch.arange(Sq)[:, None]
        kj = torch.arange(Sk)[None, :]
        cmask = kj <= (qi + off)
        scores = torch.where(cmask[None, None], scores, -1e9)
        p = _softmax(scores, axis=-1)
        ctx = torch.einsum("bhqk,bhkd->bhqd", p, v)
        return torch.einsum("bhqd,hdm->bqm", ctx, w_o)

    def _B_ref(x, w_gate, w_up, w_down):
        return (_gelu(x @ w_gate) * (x @ w_up)) @ w_down

    x = A_x
    h = x + _A_ref(_layernorm(x, axis=-1), A_c_kv, A_w_q, A_w_uk, A_w_uv, A_w_o)
    h2 = h + _B_ref(_layernorm(h, axis=-1), B_w_gate, B_w_up, B_w_down)
    return h2
```

```asm
; @launch grid=(256,1,1) block=(256,1,1) lds=163840
.amdgcn_target "amdgcn-amd-amdhsa--gfx950"

.macro MV d,x,y
 v_mfma_f32_16x16x32_bf16 v[\d:\d+3], a[\x:\x+3], a[\y:\y+3], v[\d:\d+3]
.endm
.macro MVZ d,x,y
 v_mfma_f32_16x16x32_bf16 v[\d:\d+3], a[\x:\x+3], a[\y:\y+3], 0
.endm
.macro MA d,x,y
 v_mfma_f32_16x16x32_bf16 a[\d:\d+3], a[\x:\x+3], a[\y:\y+3], a[\d:\d+3]
.endm
.macro MAZ d,x,y
 v_mfma_f32_16x16x32_bf16 a[\d:\d+3], a[\x:\x+3], a[\y:\y+3], 0
.endm
.macro RC d,v,o
 ds_read_b128 a[\d:\d+3], v\v offset:\o
.endm
.macro RW d,v,o
 ds_read_b64_tr_b16 a[\d:\d+1], v\v offset:\o
.endm
.macro DL v,r,s,o
 buffer_load_dwordx4 v\v, s[\r:\r+3], s\s offen offset:\o lds
.endm

.macro QK d,x,y,c
 v_mfma_f32_16x16x32_bf16 v[\d:\d+3], a[\x:\x+3], a[\y:\y+3], v[\c:\c+3]
.endm
.macro PV d,x,y
 v_mfma_f32_16x16x32_bf16 v[\d:\d+3], a[\x:\x+3], v[\y:\y+3], v[\d:\d+3]
.endm
.macro PVZ d,x,y
 v_mfma_f32_16x16x32_bf16 v[\d:\d+3], a[\x:\x+3], v[\y:\y+3], 0
.endm
.macro GA d,x,y
 v_mfma_f32_16x16x32_bf16 v[\d:\d+3], a[\x:\x+3], a[\y:\y+3], v[\d:\d+3]
.endm
.macro GAZ d,x,y
 v_mfma_f32_16x16x32_bf16 v[\d:\d+3], a[\x:\x+3], a[\y:\y+3], 0
.endm
.macro ZZ d,y
 v_mfma_f32_16x16x32_bf16 v[\d:\d+3], v[\y:\y+3], v[\y:\y+3], 0
.endm

.macro GH d,x,y
 v_mfma_f32_16x16x16_bf16 v[\d:\d+3], a[\x:\x+1], v[\y:\y+1], v[\d:\d+3]
.endm

.text
.globl sequential_preLN__compressed_kv_cla__geglu_ffn__prompt_kernel
.p2align 8
.type sequential_preLN__compressed_kv_cla__geglu_ffn__prompt_kernel,@function
sequential_preLN__compressed_kv_cla__geglu_ffn__prompt_kernel:
 s_cmp_lt_u32 s2, 256
 s_cbranch_scc1 mk_go
 s_endpgm
mk_go:
 s_load_dwordx2 s[80:81], s[0:1], 8
 s_load_dwordx4 s[84:87], s[0:1], 24
 s_load_dwordx4 s[88:91], s[0:1], 88
 s_load_dwordx2 s[92:93], s[0:1], 0
 s_load_dwordx2 s[12:13], s[0:1], 16
 s_load_dwordx2 s[14:15], s[0:1], 40
 s_mov_b32 s3, s2
 v_lshrrev_b32 v3, 6, v0
 v_and_b32 v2, 63, v0
 v_readfirstlane_b32 s20, v3
 v_lshlrev_b32 v1, 4, v2
 s_nop 2
 s_lshr_b32 s68, s20, 1
 s_and_b32 s69, s20, 1
 v_and_b32 v60, 7, v0
 v_lshrrev_b32 v61, 5, v0
 v_bfe_u32 v62, v0, 3, 2
 s_and_b32 s41, s3, 1
 s_lshl_b32 s41, s41, 3
 v_add_u32 v63, s41, v60
 v_lshl_add_u32 v56, v62, 4, v63
 v_lshlrev_b32 v56, 4, v56
 v_lshl_add_u32 v56, v61, 10, v56
 v_mul_u32_u24 v57, 896, v60
 v_lshl_add_u32 v57, v61, 6, v57
 v_lshl_add_u32 v57, v62, 3, v57
 v_lshrrev_b32 v58, 6, v0
 v_lshl_add_u32 v58, v60, 2, v58
 v_lshlrev_b32 v58, 2, v58
 v_lshlrev_b32 v59, 4, v60
 s_waitcnt lgkmcnt(0)
 s_mov_b32 s16, s88
 s_mov_b32 s17, s89
 s_mov_b32 s94, 1835008
 s_mov_b32 s95, 0x20000
 s_mul_i32 s42, s3, 7168
 buffer_load_dwordx2 v[32:33], v57, s[92:95], s42 offen
 buffer_load_dwordx2 v[34:35], v57, s[92:95], s42 offen offset:32
 s_cmp_eq_u32 s20, 3
 s_cbranch_scc1 mk_w3_1
 buffer_load_dwordx2 v[36:37], v57, s[92:95], s42 offen offset:512
 buffer_load_dwordx2 v[38:39], v57, s[92:95], s42 offen offset:544
mk_w3_1:
 v_lshrrev_b32 v25, 3, v2
 v_lshlrev_b32 v25, 11, v25
 v_and_b32 v26, 7, v2
 v_lshrrev_b32 v27, 4, v2
 v_xor_b32 v28, v26, v27
 v_lshl_add_u32 v4, v28, 4, v25
 v_xor_b32 v28, v26, v27
 v_xor_b32 v28, 4, v28
 v_lshl_add_u32 v5, v28, 4, v25
 v_add_u32 v5, 15360, v5
 v_xor_b32 v28, v26, v27
 v_lshl_add_u32 v6, v28, 4, v25
 v_add_u32 v6, 30720, v6
 v_xor_b32 v28, v26, v27
 v_xor_b32 v28, 4, v28
 v_lshl_add_u32 v7, v28, 4, v25
 v_add_u32 v7, 46080, v7
 v_lshrrev_b32 v25, 5, v2
 v_and_b32 v26, 31, v2
 s_lshl_b32 s76, s69, 3
 v_lshlrev_b32 v27, 1, v25
 v_or_b32 v27, 0, v27
 v_or_b32 v27, s76, v27
 v_xor_b32 v27, v26, v27
 v_lshlrev_b32 v27, 4, v27
 v_lshl_add_u32 v8, v25, 13, v27
 v_lshlrev_b32 v27, 1, v25
 v_or_b32 v27, 4, v27
 v_or_b32 v27, s76, v27
 v_xor_b32 v27, v26, v27
 v_lshlrev_b32 v27, 4, v27
 v_lshl_add_u32 v9, v25, 13, v27
 v_add_u32 v9, 15360, v9
 v_lshlrev_b32 v27, 1, v25
 v_or_b32 v27, 0, v27
 v_or_b32 v27, s76, v27
 v_xor_b32 v27, v26, v27
 v_lshlrev_b32 v27, 4, v27
 v_lshl_add_u32 v10, v25, 13, v27
 v_add_u32 v10, 30720, v10
 v_lshlrev_b32 v27, 1, v25
 v_or_b32 v27, 4, v27
 v_or_b32 v27, s76, v27
 v_xor_b32 v27, v26, v27
 v_lshlrev_b32 v27, 4, v27
 v_lshl_add_u32 v11, v25, 13, v27
 v_add_u32 v11, 46080, v11
 s_and_b32 s41, s2, 7
 s_lshr_b32 s42, s2, 3
 s_and_b32 s43, s42, 1
 s_lshl_b32 s21, s41, 1
 s_add_u32 s21, s21, s43
 s_lshr_b32 s70, s42, 1
 s_and_b32 s70, s70, 1
 s_lshr_b32 s71, s42, 2
 s_lshr_b32 s42, s42, 1
 s_and_b32 s23, s42, 7
 s_lshr_b32 s22, s42, 3
 s_mov_b32 s4, s90
 s_mov_b32 s5, s91
 s_mov_b32 s6, 0x10000000
 s_mov_b32 s7, 0x20000
 s_add_u32 s96, s90, 0x3c00000
 s_addc_u32 s97, s91, 0
 s_cmp_eq_u32 s70, 0
 s_mov_b32 s60, s80
 s_mov_b32 s61, s81
 s_mov_b32 s62, 0x400000
 s_mov_b32 s63, 0x20000
 s_cselect_b32 s64, s84, s86
 s_cselect_b32 s65, s85, s87
 s_mov_b32 s66, 0x800000
 s_mov_b32 s67, 0x20000
 s_lshl_b32 s76, s71, 8
 s_lshl_b32 s77, s20, 6
 s_add_u32 s76, s76, s77
 s_lshl_b32 s72, s76, 11
 s_lshl_b32 s73, s20, 16
 s_lshl_b32 s76, s21, 9
 s_add_u32 s73, s73, s76
 s_lshl_b32 s74, s20, 13
 s_lshl_b32 s75, s20, 12
 s_add_u32 s75, s75, 98304
 s_getpc_b64 s[98:99]
mk_ct_2:
 s_add_u32 s98, s98, mk_go-mk_ct_2
 s_addc_u32 s99, s99, -1
 s_lshr_b32 s41, s2, 3
 s_lshl_b32 s41, s41, 2
 s_add_u32 s41, s41, s20
 s_lshl_b32 s41, s41, 7
 v_lshrrev_b32 v28, 4, v1
 v_min_u32 v28, 8, v28
 v_lshlrev_b32 v28, 14, v28
 v_add_u32 v28, s41, v28
 v_min_u32 v28, (mk_done-mk_go)-4, v28
 v_and_b32 v28, 0xfffffffc, v28
 global_load_dword v31, v28, s[98:99]
 s_load_dwordx4 s[80:83], s[0:1], 56
 s_load_dwordx2 s[84:85], s[0:1], 72
 s_lshr_b32 s86, s2, 6
 s_lshl_b32 s87, s86, 21
 s_lshl_b32 s86, s86, 9
 s_add_u32 m0, s74, 0
 s_add_u32 s76, s86, 0
 s_and_b32 s76, s76, 2047
 s_add_u32 s76, s76, s72
 s_nop 0
 DL 4,60,76,0
 DL 5,60,76,1024
 DL 6,60,76,2048
 DL 7,60,76,3072
 s_add_u32 m0, s74, 4096
 s_add_u32 s76, s86, 0
 s_and_b32 s76, s76, 2047
 s_add_u32 s76, s76, s72
 s_add_u32 s76, s76, 65536
 s_nop 0
 DL 4,60,76,0
 DL 5,60,76,1024
 DL 6,60,76,2048
 DL 7,60,76,3072
 s_add_u32 m0, s75, 0
 s_add_u32 s77, s87, 0
 s_and_b32 s77, s77, 0x7fffff
 s_add_u32 s77, s77, s73
 s_nop 0
 DL 8,64,77,0
 DL 9,64,77,1024
 DL 10,64,77,2048
 DL 11,64,77,3072
 s_add_u32 m0, s75, 16384
 s_add_u32 s77, s87, 262144
 s_and_b32 s77, s77, 0x7fffff
 s_add_u32 s77, s77, s73
 s_nop 0
 DL 8,64,77,0
 DL 9,64,77,1024
 DL 10,64,77,2048
 DL 11,64,77,3072
 s_add_u32 m0, s74, 32768
 s_add_u32 s76, s86, 128
 s_and_b32 s76, s76, 2047
 s_add_u32 s76, s76, s72
 s_nop 0
 DL 4,60,76,0
 DL 5,60,76,1024
 DL 6,60,76,2048
 DL 7,60,76,3072
 s_add_u32 m0, s75, 32768
 s_add_u32 s77, s87, 524288
 s_and_b32 s77, s77, 0x7fffff
 s_add_u32 s77, s77, s73
 s_nop 0
 DL 8,64,77,0
 DL 9,64,77,1024
 DL 10,64,77,2048
 DL 11,64,77,3072
 s_add_u32 m0, s74, 36864
 s_add_u32 s76, s86, 128
 s_and_b32 s76, s76, 2047
 s_add_u32 s76, s76, s72
 s_add_u32 s76, s76, 65536
 s_nop 0
 DL 4,60,76,0
 DL 5,60,76,1024
 DL 6,60,76,2048
 DL 7,60,76,3072
 s_add_u32 m0, s75, 49152
 s_add_u32 s77, s87, 786432
 s_and_b32 s77, s77, 0x7fffff
 s_add_u32 s77, s77, s73
 s_nop 0
 DL 8,64,77,0
 DL 9,64,77,1024
 DL 10,64,77,2048
 DL 11,64,77,3072
 s_add_u32 m0, s74, 65536
 s_add_u32 s76, s86, 256
 s_and_b32 s76, s76, 2047
 s_add_u32 s76, s76, s72
 s_nop 0
 DL 4,60,76,0
 DL 5,60,76,1024
 DL 6,60,76,2048
 DL 7,60,76,3072
 v_and_b32 v25, 15, v2
 v_lshrrev_b32 v26, 4, v2
 v_lshrrev_b32 v27, 1, v25
 s_lshl_b32 s76, s68, 14
 v_or_b32 v28, 0, v26
 v_xor_b32 v28, v28, v27
 v_lshlrev_b32 v28, 4, v28
 v_lshl_add_u32 v12, v25, 7, v28
 v_add_u32 v12, s76, v12
 v_add_u32 v14, 0x10000, v12
 v_or_b32 v28, 4, v26
 v_xor_b32 v28, v28, v27
 v_lshlrev_b32 v28, 4, v28
 v_lshl_add_u32 v13, v25, 7, v28
 v_add_u32 v13, s76, v13
 v_add_u32 v15, 0x10000, v13
 v_lshrrev_b32 v27, 2, v25
 v_lshl_add_u32 v28, v26, 3, v27
 v_lshlrev_b32 v28, 9, v28
 v_and_b32 v29, 1, v25
 v_lshl_add_u32 v28, v29, 3, v28
 v_add_u32 v28, 98304, v28
 v_and_b32 v29, 1, v26
 v_lshl_add_u32 v29, v29, 2, v27
 v_lshlrev_b32 v29, 1, v29
 v_bfe_u32 v30, v25, 1, 1
 v_xor_b32 v29, v29, v30
 s_lshl_b32 s76, s69, 4
 v_xor_b32 v30, 0, v29
 v_add_u32 v30, s76, v30
 v_lshl_add_u32 v16, v30, 4, v28
 v_xor_b32 v30, 2, v29
 v_add_u32 v30, s76, v30
 v_lshl_add_u32 v17, v30, 4, v28
 v_xor_b32 v30, 4, v29
 v_add_u32 v30, s76, v30
 v_lshl_add_u32 v18, v30, 4, v28
 v_xor_b32 v30, 6, v29
 v_add_u32 v30, s76, v30
 v_lshl_add_u32 v19, v30, 4, v28
 v_xor_b32 v30, 8, v29
 v_add_u32 v30, s76, v30
 v_lshl_add_u32 v20, v30, 4, v28
 v_xor_b32 v30, 10, v29
 v_add_u32 v30, s76, v30
 v_lshl_add_u32 v21, v30, 4, v28
 v_xor_b32 v30, 12, v29
 v_add_u32 v30, s76, v30
 v_lshl_add_u32 v22, v30, 4, v28
 v_xor_b32 v30, 14, v29
 v_add_u32 v30, s76, v30
 v_lshl_add_u32 v23, v30, 4, v28
 s_lshl_b32 s78, s70, 24
 s_lshl_b32 s76, s21, 20
 s_add_u32 s78, s78, s76
 s_lshl_b32 s76, s71, 17
 s_add_u32 s78, s78, s76
 s_lshl_b32 s76, s68, 16
 s_add_u32 s78, s78, s76
 s_add_u32 s77, s70, 12
 s_lshl_b32 s76, s69, s77
 s_add_u32 s78, s78, s76
 s_lshl_b32 s26, s20, 12
 s_add_u32 s18, s26, 0x4000
 s_lshl_b32 s27, s20, 13
 s_sub_u32 s41, 15, s23
 s_lshl_b32 s42, s41, 2
 s_add_u32 s42, s42, 4
 s_cmp_eq_u32 s23, 5
 s_cselect_b32 s44, 40, 40
 s_cmp_eq_u32 s22, 0
 s_cbranch_scc0 mk_roleB
 s_mov_b32 s39, s41
 s_mov_b32 s19, 0
 s_cmp_le_u32 s23, 5
 s_cselect_b32 s40, s44, s42
 s_cselect_b32 s35, 1, 0
 s_branch mk_roledone
mk_roleB:
 s_lshl_b32 s43, s23, 2
 s_add_u32 s43, s43, 4
 s_sub_u32 s42, s42, s44
 s_cmp_le_u32 s23, 5
 s_cselect_b32 s39, s41, s23
 s_cselect_b32 s19, s44, 0
 s_cselect_b32 s40, s42, s43
 s_cselect_b32 s35, 2, 0
mk_roledone:
 s_lshl_b32 s41, s21, 3
 s_add_u32 s41, s41, s23
 s_lshl_b32 s41, s41, 2
 s_add_u32 s41, s41, s20
 s_lshl_b32 s57, s41, 14
 s_add_u32 s57, s57, 0x2800000
 s_lshl_b32 s58, s41, 9
 s_add_u32 s58, s58, 0x3a00000
 s_mov_b32 s24, 0
 s_mov_b32 s99, 0
 s_and_b32 s41, s3, 127
 s_lshl_b32 s41, s41, 8
 s_add_u32 s41, s41, 0x3c00000
 v_lshlrev_b32 v28, 2, v2
 v_mov_b32 v29, 0
 buffer_store_dword v29, v28, s[4:7], s41 offen sc1
 s_waitcnt vmcnt(38)
 v_lshlrev_b32 v40, 16, v32
 v_and_b32 v41, 0xffff0000, v32
 v_lshlrev_b32 v42, 16, v33
 v_and_b32 v43, 0xffff0000, v33
 v_lshlrev_b32 v44, 16, v34
 v_and_b32 v45, 0xffff0000, v34
 v_lshlrev_b32 v46, 16, v35
 v_and_b32 v47, 0xffff0000, v35
 s_cmp_eq_u32 s20, 3
 s_cbranch_scc1 mk_w3_3
 v_lshlrev_b32 v48, 16, v36
 v_and_b32 v49, 0xffff0000, v36
 v_lshlrev_b32 v50, 16, v37
 v_and_b32 v51, 0xffff0000, v37
 v_lshlrev_b32 v52, 16, v38
 v_and_b32 v53, 0xffff0000, v38
 v_lshlrev_b32 v54, 16, v39
 v_and_b32 v55, 0xffff0000, v39
mk_w3_3:
 v_lshlrev_b32 v58, 1, v58
 v_add_u32 v58, 69632, v58
 v_lshlrev_b32 v59, 1, v59
 v_add_u32 v59, 69632, v59
 v_add_f32 v64, v40, v41
 v_mul_f32 v65, v40, v40
 v_fmac_f32 v65, v41, v41
 v_add_f32 v64, v64, v42
 v_fmac_f32 v65, v42, v42
 v_add_f32 v64, v64, v43
 v_fmac_f32 v65, v43, v43
 v_add_f32 v64, v64, v44
 v_fmac_f32 v65, v44, v44
 v_add_f32 v64, v64, v45
 v_fmac_f32 v65, v45, v45
 v_add_f32 v64, v64, v46
 v_fmac_f32 v65, v46, v46
 v_add_f32 v64, v64, v47
 v_fmac_f32 v65, v47, v47
 s_cmp_eq_u32 s20, 3
 s_cbranch_scc1 mk_w3_4
 v_add_f32 v64, v64, v48
 v_fmac_f32 v65, v48, v48
 v_add_f32 v64, v64, v49
 v_fmac_f32 v65, v49, v49
 v_add_f32 v64, v64, v50
 v_fmac_f32 v65, v50, v50
 v_add_f32 v64, v64, v51
 v_fmac_f32 v65, v51, v51
 v_add_f32 v64, v64, v52
 v_fmac_f32 v65, v52, v52
 v_add_f32 v64, v64, v53
 v_fmac_f32 v65, v53, v53
 v_add_f32 v64, v64, v54
 v_fmac_f32 v65, v54, v54
 v_add_f32 v64, v64, v55
 v_fmac_f32 v65, v55, v55
mk_w3_4:
 s_nop 1
 v_add_f32_dpp v64, v64, v64 row_ror:8 row_mask:0xf bank_mask:0xf
 v_add_f32_dpp v65, v65, v65 row_ror:8 row_mask:0xf bank_mask:0xf
 v_mov_b32 v66, v64
 v_mov_b32 v67, v65
 s_nop 1
 v_permlane16_swap_b32 v66, v64
 v_permlane16_swap_b32 v67, v65
 v_add_f32 v64, v64, v66
 v_add_f32 v65, v65, v67
 v_mov_b32 v66, v64
 v_mov_b32 v67, v65
 s_nop 1
 v_permlane32_swap_b32 v66, v64
 v_permlane32_swap_b32 v67, v65
 v_add_f32 v64, v64, v66
 v_add_f32 v65, v65, v67
 ds_write_b64 v58, v[64:65]
 s_waitcnt lgkmcnt(0)
 s_barrier
 ds_read_b128 v[64:67], v59
 ds_read_b128 v[68:71], v59 offset:16
 s_waitcnt lgkmcnt(0)
 v_add_f32 v64, v64, v66
 v_add_f32 v65, v65, v67
 v_add_f32 v64, v64, v68
 v_add_f32 v65, v65, v69
 v_add_f32 v64, v64, v70
 v_add_f32 v65, v65, v71
 v_mul_f32 v64, 0x3b124925, v64
 v_mul_f32 v65, 0x3b124925, v65
 v_fma_f32 v65, -v64, v64, v65
 v_max_f32 v65, 0, v65
 v_add_f32 v65, 0x3727c5ac, v65
 v_rsq_f32 v65, v65
 s_nop 0
 v_mul_f32 v65, 0x3db8aa3b, v65
 s_lshr_b32 s42, s3, 1
 s_mul_i32 s42, s42, 14336
 s_add_u32 s42, s42, 0x2000000
 v_sub_f32 v40, v40, v64
 v_sub_f32 v41, v41, v64
 v_sub_f32 v42, v42, v64
 v_sub_f32 v43, v43, v64
 v_sub_f32 v44, v44, v64
 v_sub_f32 v45, v45, v64
 v_sub_f32 v46, v46, v64
 v_sub_f32 v47, v47, v64
 v_mul_f32 v40, v40, v65
 v_mul_f32 v41, v41, v65
 v_mul_f32 v42, v42, v65
 v_mul_f32 v43, v43, v65
 v_mul_f32 v44, v44, v65
 v_mul_f32 v45, v45, v65
 v_mul_f32 v46, v46, v65
 v_mul_f32 v47, v47, v65
 v_cvt_pk_bf16_f32 v68, v40, v41
 v_cvt_pk_bf16_f32 v69, v42, v43
 v_cvt_pk_bf16_f32 v70, v44, v45
 v_cvt_pk_bf16_f32 v71, v46, v47
 buffer_store_dwordx4 v[68:71], v56, s[4:7], s42 offen sc1
 s_nop 1
 s_cmp_eq_u32 s20, 3
 s_cbranch_scc1 mk_w3_5
 v_sub_f32 v48, v48, v64
 v_sub_f32 v49, v49, v64
 v_sub_f32 v50, v50, v64
 v_sub_f32 v51, v51, v64
 v_sub_f32 v52, v52, v64
 v_sub_f32 v53, v53, v64
 v_sub_f32 v54, v54, v64
 v_sub_f32 v55, v55, v64
 v_mul_f32 v48, v48, v65
 v_mul_f32 v49, v49, v65
 v_mul_f32 v50, v50, v65
 v_mul_f32 v51, v51, v65
 v_mul_f32 v52, v52, v65
 v_mul_f32 v53, v53, v65
 v_mul_f32 v54, v54, v65
 v_mul_f32 v55, v55, v65
 v_cvt_pk_bf16_f32 v68, v48, v49
 v_cvt_pk_bf16_f32 v69, v50, v51
 v_cvt_pk_bf16_f32 v70, v52, v53
 v_cvt_pk_bf16_f32 v71, v54, v55
 s_add_u32 s42, s42, 8192
 buffer_store_dwordx4 v[68:71], v56, s[4:7], s42 offen sc1
 s_nop 1
mk_w3_5:
 s_waitcnt vmcnt(26)
 s_barrier
 RC 0,12,0
 RW 32,16,0
 RW 34,16,2048
 RC 4,12,2048
 RW 36,17,0
 RW 38,17,2048
 RC 8,12,4096
 RW 40,18,0
 RW 42,18,2048
 RC 12,12,6144
 RW 44,19,0
 RW 46,19,2048
 RC 16,12,8192
 RW 48,20,0
 RW 50,20,2048
 RC 20,12,10240
 RW 52,21,0
 RW 54,21,2048
 RC 24,12,12288
 RW 56,22,0
 RW 58,22,2048
 RC 28,12,14336
 RW 60,23,0
 RW 62,23,2048
 s_waitcnt vmcnt(22) lgkmcnt(0)
 s_barrier
 s_cmp_eq_u32 s70, 0
 s_cbranch_scc0 mk_vloop
 MVZ 32,32,0
 MVZ 36,32,4
 RC 64,13,0
 MVZ 40,32,8
 s_add_u32 m0, s75, 0
 s_add_u32 s77, s87, 1048576
 s_and_b32 s77, s77, 0x7fffff
 s_add_u32 s77, s77, s73
 MVZ 44,32,12
 RW 96,16,16384
 MVZ 48,32,16
 DL 8,64,77,0
 MVZ 52,32,20
 RW 98,16,18432
 MVZ 56,32,24
 MVZ 60,32,28
 RC 68,13,2048
 MVZ 92,36,28
 MVZ 88,36,24
 RW 100,17,16384
 MVZ 84,36,20
 DL 9,64,77,1024
 MVZ 80,36,16
 RW 102,17,18432
 MVZ 76,36,12
 MVZ 72,36,8
 RC 72,13,4096
 MVZ 68,36,4
 MVZ 64,36,0
 RW 104,18,16384
 MVZ 96,40,0
 DL 10,64,77,2048
 MVZ 100,40,4
 RW 106,18,18432
 MVZ 104,40,8
 MVZ 108,40,12
 RC 76,13,6144
 MVZ 112,40,16
 MVZ 116,40,20
 RW 108,19,16384
 MVZ 120,40,24
 DL 11,64,77,3072
 MVZ 124,40,28
 RW 110,19,18432
 MVZ 156,44,28
 MVZ 152,44,24
 RC 80,13,8192
 MVZ 148,44,20
 MVZ 144,44,16
 RW 112,20,16384
 MVZ 140,44,12
 s_add_u32 m0, s74, 69632
 s_add_u32 s76, s86, 256
 s_and_b32 s76, s76, 2047
 s_add_u32 s76, s76, s72
 s_add_u32 s76, s76, 65536
 MVZ 136,44,8
 RW 114,20,18432
 MVZ 132,44,4
 DL 4,60,76,0
 MVZ 128,44,0
 RC 84,13,10240
 MVZ 160,48,0
 MVZ 164,48,4
 RW 116,21,16384
 MVZ 168,48,8
 MVZ 172,48,12
 RW 118,21,18432
 MVZ 176,48,16
 DL 5,60,76,1024
 MVZ 180,48,20
 RC 88,13,12288
 MVZ 184,48,24
 MVZ 188,48,28
 RW 120,22,16384
 MVZ 220,52,28
 MVZ 216,52,24
 RW 122,22,18432
 MVZ 212,52,20
 DL 6,60,76,2048
 MVZ 208,52,16
 RC 92,13,14336
 MVZ 204,52,12
 MVZ 200,52,8
 RW 124,23,16384
 MVZ 196,52,4
 MVZ 192,52,0
 RW 126,23,18432
 MVZ 224,56,0
 DL 7,60,76,3072
 MVZ 228,56,4
 MVZ 232,56,8
 MVZ 236,56,12
 MVZ 240,56,16
 MVZ 244,56,20
 MVZ 248,56,24
 MVZ 252,56,28
 MAZ 156,60,28
 MAZ 152,60,24
 MAZ 148,60,20
 MAZ 144,60,16
 MAZ 140,60,12
 MAZ 136,60,8
 MAZ 132,60,4
 MAZ 128,60,0
 s_waitcnt vmcnt(18) lgkmcnt(0)
 s_barrier
 MV 32,96,64
 MV 36,96,68
 RC 0,12,32768
 MV 40,96,72
 s_add_u32 m0, s75, 16384
 s_add_u32 s77, s87, 1310720
 s_and_b32 s77, s77, 0x7fffff
 s_add_u32 s77, s77, s73
 MV 44,96,76
 RW 32,16,32768
 MV 48,96,80
 DL 8,64,77,0
 MV 52,96,84
 RW 34,16,34816
 MV 56,96,88
 MV 60,96,92
 RC 4,12,34816
 MV 92,100,92
 MV 88,100,88
 RW 36,17,32768
 MV 84,100,84
 DL 9,64,77,1024
 MV 80,100,80
 RW 38,17,34816
 MV 76,100,76
 MV 72,100,72
 RC 8,12,36864
 MV 68,100,68
 MV 64,100,64
 RW 40,18,32768
 MV 96,104,64
 DL 10,64,77,2048
 MV 100,104,68
 RW 42,18,34816
 MV 104,104,72
 MV 108,104,76
 RC 12,12,38912
 MV 112,104,80
 MV 116,104,84
 RW 44,19,32768
 MV 120,104,88
 DL 11,64,77,3072
 MV 124,104,92
 RW 46,19,34816
 MV 156,108,92
 MV 152,108,88
 RC 16,12,40960
 MV 148,108,84
 MV 144,108,80
 RW 48,20,32768
 MV 140,108,76
 s_add_u32 m0, s74, 0
 s_add_u32 s76, s86, 384
 s_and_b32 s76, s76, 2047
 s_add_u32 s76, s76, s72
 MV 136,108,72
 RW 50,20,34816
 MV 132,108,68
 DL 4,60,76,0
 MV 128,108,64
 RC 20,12,43008
 MV 160,112,64
 MV 164,112,68
 RW 52,21,32768
 MV 168,112,72
 MV 172,112,76
 RW 54,21,34816
 MV 176,112,80
 DL 5,60,76,1024
 MV 180,112,84
 RC 24,12,45056
 MV 184,112,88
 MV 188,112,92
 RW 56,22,32768
 MV 220,116,92
 MV 216,116,88
 RW 58,22,34816
 MV 212,116,84
 DL 6,60,76,2048
 MV 208,116,80
 RC 28,12,47104
 MV 204,116,76
 MV 200,116,72
 RW 60,23,32768
 MV 196,116,68
 MV 192,116,64
 RW 62,23,34816
 MV 224,120,64
 DL 7,60,76,3072
 MV 228,120,68
 MV 232,120,72
 MV 236,120,76
 MV 240,120,80
 MV 244,120,84
 MV 248,120,88
 MV 252,120,92
 MA 156,124,92
 MA 152,124,88
 MA 148,124,84
 MA 144,124,80
 MA 140,124,76
 MA 136,124,72
 MA 132,124,68
 MA 128,124,64
 s_waitcnt vmcnt(22) lgkmcnt(0)
 s_barrier
 MV 32,32,0
 MV 36,32,4
 RC 64,13,32768
 MV 40,32,8
 s_add_u32 m0, s75, 32768
 s_add_u32 s77, s87, 1572864
 s_and_b32 s77, s77, 0x7fffff
 s_add_u32 s77, s77, s73
 MV 44,32,12
 RW 96,16,49152
 MV 48,32,16
 DL 8,64,77,0
 MV 52,32,20
 RW 98,16,51200
 MV 56,32,24
 MV 60,32,28
 RC 68,13,34816
 MV 92,36,28
 MV 88,36,24
 RW 100,17,49152
 MV 84,36,20
 DL 9,64,77,1024
 MV 80,36,16
 RW 102,17,51200
 MV 76,36,12
 MV 72,36,8
 RC 72,13,36864
 MV 68,36,4
 MV 64,36,0
 RW 104,18,49152
 MV 96,40,0
 DL 10,64,77,2048
 MV 100,40,4
 RW 106,18,51200
 MV 104,40,8
 MV 108,40,12
 RC 76,13,38912
 MV 112,40,16
 MV 116,40,20
 RW 108,19,49152
 MV 120,40,24
 DL 11,64,77,3072
 MV 124,40,28
 RW 110,19,51200
 MV 156,44,28
 MV 152,44,24
 RC 80,13,40960
 MV 148,44,20
 MV 144,44,16
 RW 112,20,49152
 MV 140,44,12
 s_add_u32 m0, s74, 4096
 s_add_u32 s76, s86, 384
 s_and_b32 s76, s76, 2047
 s_add_u32 s76, s76, s72
 s_add_u32 s76, s76, 65536
 MV 136,44,8
 RW 114,20,51200
 MV 132,44,4
 DL 4,60,76,0
 MV 128,44,0
 RC 84,13,43008
 MV 160,48,0
 MV 164,48,4
 RW 116,21,49152
 MV 168,48,8
 MV 172,48,12
 RW 118,21,51200
 MV 176,48,16
 DL 5,60,76,1024
 MV 180,48,20
 RC 88,13,45056
 MV 184,48,24
 MV 188,48,28
 RW 120,22,49152
 MV 220,52,28
 MV 216,52,24
 RW 122,22,51200
 MV 212,52,20
 DL 6,60,76,2048
 MV 208,52,16
 RC 92,13,47104
 MV 204,52,12
 MV 200,52,8
 RW 124,23,49152
 MV 196,52,4
 MV 192,52,0
 RW 126,23,51200
 MV 224,56,0
 DL 7,60,76,3072
 MV 228,56,4
 MV 232,56,8
 MV 236,56,12
 MV 240,56,16
 MV 244,56,20
 MV 248,56,24
 MV 252,56,28
 MA 156,60,28
 MA 152,60,24
 MA 148,60,20
 MA 144,60,16
 MA 140,60,12
 MA 136,60,8
 MA 132,60,4
 MA 128,60,0
 s_waitcnt vmcnt(16) lgkmcnt(0)
 s_barrier
 s_lshr_b32 s41, s3, 4
 s_cmp_eq_u32 s20, 0
 s_cbranch_scc0 mk_sg_6
 s_lshl_b32 s44, s41, 2
 v_mov_b32 v29, s44
 v_mov_b32 v30, 1
 s_mov_b64 exec, 1
 global_atomic_add v29, v30, s[16:17] sc1
 s_mov_b64 exec, -1
mk_sg_6:
 MV 32,96,64
 MV 36,96,68
 RC 0,14,0
 MV 40,96,72
 s_add_u32 m0, s75, 49152
 s_add_u32 s77, s87, 1835008
 s_and_b32 s77, s77, 0x7fffff
 s_add_u32 s77, s77, s73
 MV 44,96,76
 RW 32,16,0
 MV 48,96,80
 DL 8,64,77,0
 MV 52,96,84
 RW 34,16,2048
 MV 56,96,88
 MV 60,96,92
 RC 4,14,2048
 MV 92,100,92
 MV 88,100,88
 RW 36,17,0
 MV 84,100,84
 DL 9,64,77,1024
 MV 80,100,80
 RW 38,17,2048
 MV 76,100,76
 MV 72,100,72
 RC 8,14,4096
 MV 68,100,68
 MV 64,100,64
 RW 40,18,0
 MV 96,104,64
 DL 10,64,77,2048
 MV 100,104,68
 RW 42,18,2048
 MV 104,104,72
 MV 108,104,76
 RC 12,14,6144
 MV 112,104,80
 MV 116,104,84
 RW 44,19,0
 MV 120,104,88
 DL 11,64,77,3072
 MV 124,104,92
 RW 46,19,2048
 MV 156,108,92
 MV 152,108,88
 RC 16,14,8192
 MV 148,108,84
 MV 144,108,80
 RW 48,20,0
 MV 140,108,76
 s_add_u32 m0, s74, 32768
 s_add_u32 s76, s86, 512
 s_and_b32 s76, s76, 2047
 s_add_u32 s76, s76, s72
 MV 136,108,72
 RW 50,20,2048
 MV 132,108,68
 DL 4,60,76,0
 MV 128,108,64
 RC 20,14,10240
 MV 160,112,64
 MV 164,112,68
 RW 52,21,0
 MV 168,112,72
 MV 172,112,76
 RW 54,21,2048
 MV 176,112,80
 DL 5,60,76,1024
 MV 180,112,84
 RC 24,14,12288
 MV 184,112,88
 MV 188,112,92
 RW 56,22,0
 MV 220,116,92
 MV 216,116,88
 RW 58,22,2048
 MV 212,116,84
 DL 6,60,76,2048
 MV 208,116,80
 RC 28,14,14336
 MV 204,116,76
 MV 200,116,72
 RW 60,23,0
 MV 196,116,68
 MV 192,116,64
 RW 62,23,2048
 MV 224,120,64
 DL 7,60,76,3072
 MV 228,120,68
 MV 232,120,72
 MV 236,120,76
 MV 240,120,80
 MV 244,120,84
 MV 248,120,88
 MV 252,120,92
 MA 156,124,92
 MA 152,124,88
 MA 148,124,84
 MA 144,124,80
 MA 140,124,76
 MA 136,124,72
 MA 132,124,68
 MA 128,124,64
 s_waitcnt vmcnt(20) lgkmcnt(0)
 s_barrier
 MV 32,32,0
 MV 36,32,4
 RC 64,15,0
 MV 40,32,8
 s_add_u32 m0, s75, 0
 s_add_u32 s77, s87, 2097152
 s_and_b32 s77, s77, 0x7fffff
 s_add_u32 s77, s77, s73
 MV 44,32,12
 RW 96,16,16384
 MV 48,32,16
 DL 8,64,77,0
 MV 52,32,20
 RW 98,16,18432
 MV 56,32,24
 MV 60,32,28
 RC 68,15,2048
 MV 92,36,28
 MV 88,36,24
 RW 100,17,16384
 MV 84,36,20
 DL 9,64,77,1024
 MV 80,36,16
 RW 102,17,18432
 MV 76,36,12
 MV 72,36,8
 RC 72,15,4096
 MV 68,36,4
 MV 64,36,0
 RW 104,18,16384
 MV 96,40,0
 DL 10,64,77,2048
 MV 100,40,4
 RW 106,18,18432
 MV 104,40,8
 MV 108,40,12
 RC 76,15,6144
 MV 112,40,16
 MV 116,40,20
 RW 108,19,16384
 MV 120,40,24
 DL 11,64,77,3072
 MV 124,40,28
 RW 110,19,18432
 MV 156,44,28
 MV 152,44,24
 RC 80,15,8192
 MV 148,44,20
 MV 144,44,16
 RW 112,20,16384
 MV 140,44,12
 s_add_u32 m0, s74, 36864
 s_add_u32 s76, s86, 512
 s_and_b32 s76, s76, 2047
 s_add_u32 s76, s76, s72
 s_add_u32 s76, s76, 65536
 MV 136,44,8
 RW 114,20,18432
 MV 132,44,4
 DL 4,60,76,0
 MV 128,44,0
 RC 84,15,10240
 MV 160,48,0
 MV 164,48,4
 RW 116,21,16384
 MV 168,48,8
 MV 172,48,12
 RW 118,21,18432
 MV 176,48,16
 DL 5,60,76,1024
 MV 180,48,20
 RC 88,15,12288
 MV 184,48,24
 MV 188,48,28
 RW 120,22,16384
 MV 220,52,28
 MV 216,52,24
 RW 122,22,18432
 MV 212,52,20
 DL 6,60,76,2048
 MV 208,52,16
 RC 92,15,14336
 MV 204,52,12
 MV 200,52,8
 RW 124,23,16384
 MV 196,52,4
 MV 192,52,0
 RW 126,23,18432
 MV 224,56,0
 DL 7,60,76,3072
 MV 228,56,4
 MV 232,56,8
 MV 236,56,12
 MV 240,56,16
 MV 244,56,20
 MV 248,56,24
 MV 252,56,28
 MA 156,60,28
 MA 152,60,24
 MA 148,60,20
 MA 144,60,16
 MA 140,60,12
 MA 136,60,8
 MA 132,60,4
 MA 128,60,0
 s_waitcnt vmcnt(16) lgkmcnt(0)
 s_barrier
 MV 32,96,64
 MV 36,96,68
 RC 0,12,0
 MV 40,96,72
 s_add_u32 m0, s75, 16384
 s_add_u32 s77, s87, 2359296
 s_and_b32 s77, s77, 0x7fffff
 s_add_u32 s77, s77, s73
 MV 44,96,76
 RW 32,16,32768
 MV 48,96,80
 DL 8,64,77,0
 MV 52,96,84
 RW 34,16,34816
 MV 56,96,88
 MV 60,96,92
 RC 4,12,2048
 MV 92,100,92
 MV 88,100,88
 RW 36,17,32768
 MV 84,100,84
 DL 9,64,77,1024
 MV 80,100,80
 RW 38,17,34816
 MV 76,100,76
 MV 72,100,72
 RC 8,12,4096
 MV 68,100,68
 MV 64,100,64
 RW 40,18,32768
 MV 96,104,64
 DL 10,64,77,2048
 MV 100,104,68
 RW 42,18,34816
 MV 104,104,72
 MV 108,104,76
 RC 12,12,6144
 MV 112,104,80
 MV 116,104,84
 RW 44,19,32768
 MV 120,104,88
 DL 11,64,77,3072
 MV 124,104,92
 RW 46,19,34816
 MV 156,108,92
 MV 152,108,88
 RC 16,12,8192
 MV 148,108,84
 MV 144,108,80
 RW 48,20,32768
 MV 140,108,76
 s_add_u32 m0, s74, 65536
 s_add_u32 s76, s86, 640
 s_and_b32 s76, s76, 2047
 s_add_u32 s76, s76, s72
 MV 136,108,72
 RW 50,20,34816
 MV 132,108,68
 DL 4,60,76,0
 MV 128,108,64
 RC 20,12,10240
 MV 160,112,64
 MV 164,112,68
 RW 52,21,32768
 MV 168,112,72
 MV 172,112,76
 RW 54,21,34816
 MV 176,112,80
 DL 5,60,76,1024
 MV 180,112,84
 RC 24,12,12288
 MV 184,112,88
 MV 188,112,92
 RW 56,22,32768
 MV 220,116,92
 MV 216,116,88
 RW 58,22,34816
 MV 212,116,84
 DL 6,60,76,2048
 MV 208,116,80
 RC 28,12,14336
 MV 204,116,76
 MV 200,116,72
 RW 60,23,32768
 MV 196,116,68
 MV 192,116,64
 RW 62,23,34816
 MV 224,120,64
 DL 7,60,76,3072
 MV 228,120,68
 MV 232,120,72
 MV 236,120,76
 MV 240,120,80
 MV 244,120,84
 MV 248,120,88
 MV 252,120,92
 MA 156,124,92
 MA 152,124,88
 MA 148,124,84
 MA 144,124,80
 MA 140,124,76
 MA 136,124,72
 MA 132,124,68
 MA 128,124,64
 s_waitcnt vmcnt(20) lgkmcnt(0)
 s_barrier
 MV 32,32,0
 MV 36,32,4
 RC 64,13,0
 MV 40,32,8
 s_add_u32 m0, s75, 32768
 s_add_u32 s77, s87, 2621440
 s_and_b32 s77, s77, 0x7fffff
 s_add_u32 s77, s77, s73
 MV 44,32,12
 RW 96,16,49152
 MV 48,32,16
 DL 8,64,77,0
 MV 52,32,20
 RW 98,16,51200
 MV 56,32,24
 MV 60,32,28
 RC 68,13,2048
 MV 92,36,28
 MV 88,36,24
 RW 100,17,49152
 MV 84,36,20
 DL 9,64,77,1024
 MV 80,36,16
 RW 102,17,51200
 MV 76,36,12
 MV 72,36,8
 RC 72,13,4096
 MV 68,36,4
 MV 64,36,0
 RW 104,18,49152
 MV 96,40,0
 DL 10,64,77,2048
 MV 100,40,4
 RW 106,18,51200
 MV 104,40,8
 MV 108,40,12
 RC 76,13,6144
 MV 112,40,16
 MV 116,40,20
 RW 108,19,49152
 MV 120,40,24
 DL 11,64,77,3072
 MV 124,40,28
 RW 110,19,51200
 MV 156,44,28
 MV 152,44,24
 RC 80,13,8192
 MV 148,44,20
 MV 144,44,16
 RW 112,20,49152
 MV 140,44,12
 s_add_u32 m0, s74, 69632
 s_add_u32 s76, s86, 640
 s_and_b32 s76, s76, 2047
 s_add_u32 s76, s76, s72
 s_add_u32 s76, s76, 65536
 MV 136,44,8
 RW 114,20,51200
 MV 132,44,4
 DL 4,60,76,0
 MV 128,44,0
 RC 84,13,10240
 MV 160,48,0
 MV 164,48,4
 RW 116,21,49152
 MV 168,48,8
 MV 172,48,12
 RW 118,21,51200
 MV 176,48,16
 DL 5,60,76,1024
 MV 180,48,20
 RC 88,13,12288
 MV 184,48,24
 MV 188,48,28
 RW 120,22,49152
 MV 220,52,28
 MV 216,52,24
 RW 122,22,51200
 MV 212,52,20
 DL 6,60,76,2048
 MV 208,52,16
 RC 92,13,14336
 MV 204,52,12
 MV 200,52,8
 RW 124,23,49152
 MV 196,52,4
 MV 192,52,0
 RW 126,23,51200
 MV 224,56,0
 DL 7,60,76,3072
 MV 228,56,4
 MV 232,56,8
 MV 236,56,12
 MV 240,56,16
 MV 244,56,20
 MV 248,56,24
 MV 252,56,28
 MA 156,60,28
 MA 152,60,24
 MA 148,60,20
 MA 144,60,16
 MA 140,60,12
 MA 136,60,8
 MA 132,60,4
 MA 128,60,0
 s_waitcnt vmcnt(16) lgkmcnt(0)
 s_barrier
 MV 32,96,64
 MV 36,96,68
 RC 0,12,32768
 MV 40,96,72
 s_add_u32 m0, s75, 49152
 s_add_u32 s77, s87, 2883584
 s_and_b32 s77, s77, 0x7fffff
 s_add_u32 s77, s77, s73
 MV 44,96,76
 RW 32,16,0
 MV 48,96,80
 DL 8,64,77,0
 MV 52,96,84
 RW 34,16,2048
 MV 56,96,88
 MV 60,96,92
 RC 4,12,34816
 MV 92,100,92
 MV 88,100,88
 RW 36,17,0
 MV 84,100,84
 DL 9,64,77,1024
 MV 80,100,80
 RW 38,17,2048
 MV 76,100,76
 MV 72,100,72
 RC 8,12,36864
 MV 68,100,68
 MV 64,100,64
 RW 40,18,0
 MV 96,104,64
 DL 10,64,77,2048
 MV 100,104,68
 RW 42,18,2048
 MV 104,104,72
 MV 108,104,76
 RC 12,12,38912
 MV 112,104,80
 MV 116,104,84
 RW 44,19,0
 MV 120,104,88
 DL 11,64,77,3072
 MV 124,104,92
 RW 46,19,2048
 MV 156,108,92
 MV 152,108,88
 RC 16,12,40960
 MV 148,108,84
 MV 144,108,80
 RW 48,20,0
 MV 140,108,76
 s_add_u32 m0, s74, 0
 s_add_u32 s76, s86, 768
 s_and_b32 s76, s76, 2047
 s_add_u32 s76, s76, s72
 MV 136,108,72
 RW 50,20,2048
 MV 132,108,68
 DL 4,60,76,0
 MV 128,108,64
 RC 20,12,43008
 MV 160,112,64
 MV 164,112,68
 RW 52,21,0
 MV 168,112,72
 MV 172,112,76
 RW 54,21,2048
 MV 176,112,80
 DL 5,60,76,1024
 MV 180,112,84
 RC 24,12,45056
 MV 184,112,88
 MV 188,112,92
 RW 56,22,0
 MV 220,116,92
 MV 216,116,88
 RW 58,22,2048
 MV 212,116,84
 DL 6,60,76,2048
 MV 208,116,80
 RC 28,12,47104
 MV 204,116,76
 MV 200,116,72
 RW 60,23,0
 MV 196,116,68
 MV 192,116,64
 RW 62,23,2048
 MV 224,120,64
 DL 7,60,76,3072
 MV 228,120,68
 MV 232,120,72
 MV 236,120,76
 MV 240,120,80
 MV 244,120,84
 MV 248,120,88
 MV 252,120,92
 MA 156,124,92
 MA 152,124,88
 MA 148,124,84
 MA 144,124,80
 MA 140,124,76
 MA 136,124,72
 MA 132,124,68
 MA 128,124,64
 s_waitcnt vmcnt(20) lgkmcnt(0)
 s_barrier
 s_cmp_eq_u32 s20, 0
 s_cbranch_scc0 mk_pl_7
 v_and_b32 v29, 31, v2
 v_lshlrev_b32 v29, 2, v29
 global_load_dword v30, v29, s[16:17] sc1
mk_pl_7:
 MV 32,32,0
 MV 36,32,4
 RC 64,13,32768
 MV 40,32,8
 s_add_u32 m0, s75, 0
 s_add_u32 s77, s87, 3145728
 s_and_b32 s77, s77, 0x7fffff
 s_add_u32 s77, s77, s73
 MV 44,32,12
 RW 96,16,16384
 MV 48,32,16
 DL 8,64,77,0
 MV 52,32,20
 RW 98,16,18432
 MV 56,32,24
 MV 60,32,28
 RC 68,13,34816
 MV 92,36,28
 MV 88,36,24
 RW 100,17,16384
 MV 84,36,20
 DL 9,64,77,1024
 MV 80,36,16
 RW 102,17,18432
 MV 76,36,12
 MV 72,36,8
 RC 72,13,36864
 MV 68,36,4
 MV 64,36,0
 RW 104,18,16384
 MV 96,40,0
 DL 10,64,77,2048
 MV 100,40,4
 RW 106,18,18432
 MV 104,40,8
 MV 108,40,12
 RC 76,13,38912
 MV 112,40,16
 MV 116,40,20
 RW 108,19,16384
 MV 120,40,24
 DL 11,64,77,3072
 MV 124,40,28
 RW 110,19,18432
 MV 156,44,28
 MV 152,44,24
 RC 80,13,40960
 MV 148,44,20
 MV 144,44,16
 RW 112,20,16384
 MV 140,44,12
 s_add_u32 m0, s74, 4096
 s_add_u32 s76, s86, 768
 s_and_b32 s76, s76, 2047
 s_add_u32 s76, s76, s72
 s_add_u32 s76, s76, 65536
 MV 136,44,8
 RW 114,20,18432
 MV 132,44,4
 DL 4,60,76,0
 MV 128,44,0
 RC 84,13,43008
 MV 160,48,0
 MV 164,48,4
 RW 116,21,16384
 MV 168,48,8
 MV 172,48,12
 RW 118,21,18432
 MV 176,48,16
 DL 5,60,76,1024
 MV 180,48,20
 RC 88,13,45056
 MV 184,48,24
 MV 188,48,28
 RW 120,22,16384
 MV 220,52,28
 MV 216,52,24
 RW 122,22,18432
 MV 212,52,20
 DL 6,60,76,2048
 MV 208,52,16
 RC 92,13,47104
 MV 204,52,12
 MV 200,52,8
 RW 124,23,16384
 MV 196,52,4
 MV 192,52,0
 RW 126,23,18432
 MV 224,56,0
 DL 7,60,76,3072
 MV 228,56,4
 MV 232,56,8
 MV 236,56,12
 MV 240,56,16
 MV 244,56,20
 MV 248,56,24
 MV 252,56,28
 MA 156,60,28
 MA 152,60,24
 MA 148,60,20
 MA 144,60,16
 MA 140,60,12
 MA 136,60,8
 MA 132,60,4
 MA 128,60,0
 s_waitcnt vmcnt(16) lgkmcnt(0)
 s_barrier
 MV 32,96,64
 MV 36,96,68
 RC 0,14,0
 MV 40,96,72
 s_add_u32 m0, s75, 16384
 s_add_u32 s77, s87, 3407872
 s_and_b32 s77, s77, 0x7fffff
 s_add_u32 s77, s77, s73
 MV 44,96,76
 RW 32,16,32768
 MV 48,96,80
 DL 8,64,77,0
 MV 52,96,84
 RW 34,16,34816
 MV 56,96,88
 MV 60,96,92
 RC 4,14,2048
 MV 92,100,92
 MV 88,100,88
 RW 36,17,32768
 MV 84,100,84
 DL 9,64,77,1024
 MV 80,100,80
 RW 38,17,34816
 MV 76,100,76
 MV 72,100,72
 RC 8,14,4096
 MV 68,100,68
 MV 64,100,64
 RW 40,18,32768
 MV 96,104,64
 DL 10,64,77,2048
 MV 100,104,68
 RW 42,18,34816
 MV 104,104,72
 MV 108,104,76
 RC 12,14,6144
 MV 112,104,80
 MV 116,104,84
 RW 44,19,32768
 MV 120,104,88
 DL 11,64,77,3072
 MV 124,104,92
 RW 46,19,34816
 MV 156,108,92
 MV 152,108,88
 RC 16,14,8192
 MV 148,108,84
 MV 144,108,80
 RW 48,20,32768
 MV 140,108,76
 s_add_u32 m0, s74, 32768
 s_add_u32 s76, s86, 896
 s_and_b32 s76, s76, 2047
 s_add_u32 s76, s76, s72
 MV 136,108,72
 RW 50,20,34816
 MV 132,108,68
 DL 4,60,76,0
 MV 128,108,64
 RC 20,14,10240
 MV 160,112,64
 MV 164,112,68
 RW 52,21,32768
 MV 168,112,72
 MV 172,112,76
 RW 54,21,34816
 MV 176,112,80
 DL 5,60,76,1024
 MV 180,112,84
 RC 24,14,12288
 MV 184,112,88
 MV 188,112,92
 RW 56,22,32768
 MV 220,116,92
 MV 216,116,88
 RW 58,22,34816
 MV 212,116,84
 DL 6,60,76,2048
 MV 208,116,80
 RC 28,14,14336
 MV 204,116,76
 MV 200,116,72
 RW 60,23,32768
 MV 196,116,68
 MV 192,116,64
 RW 62,23,34816
 MV 224,120,64
 DL 7,60,76,3072
 MV 228,120,68
 MV 232,120,72
 MV 236,120,76
 MV 240,120,80
 MV 244,120,84
 MV 248,120,88
 MV 252,120,92
 MA 156,124,92
 MA 152,124,88
 MA 148,124,84
 MA 144,124,80
 MA 140,124,76
 MA 136,124,72
 MA 132,124,68
 MA 128,124,64
 s_waitcnt vmcnt(20) lgkmcnt(0)
 s_barrier
 MV 32,32,0
 MV 36,32,4
 RC 64,15,0
 MV 40,32,8
 s_add_u32 m0, s75, 32768
 s_add_u32 s77, s87, 3670016
 s_and_b32 s77, s77, 0x7fffff
 s_add_u32 s77, s77, s73
 MV 44,32,12
 RW 96,16,49152
 MV 48,32,16
 DL 8,64,77,0
 MV 52,32,20
 RW 98,16,51200
 MV 56,32,24
 MV 60,32,28
 RC 68,15,2048
 MV 92,36,28
 MV 88,36,24
 RW 100,17,49152
 MV 84,36,20
 DL 9,64,77,1024
 MV 80,36,16
 RW 102,17,51200
 MV 76,36,12
 MV 72,36,8
 RC 72,15,4096
 MV 68,36,4
 MV 64,36,0
 RW 104,18,49152
 MV 96,40,0
 DL 10,64,77,2048
 MV 100,40,4
 RW 106,18,51200
 MV 104,40,8
 MV 108,40,12
 RC 76,15,6144
 MV 112,40,16
 MV 116,40,20
 RW 108,19,49152
 MV 120,40,24
 DL 11,64,77,3072
 MV 124,40,28
 RW 110,19,51200
 MV 156,44,28
 MV 152,44,24
 RC 80,15,8192
 MV 148,44,20
 MV 144,44,16
 RW 112,20,49152
 MV 140,44,12
 s_add_u32 m0, s74, 36864
 s_add_u32 s76, s86, 896
 s_and_b32 s76, s76, 2047
 s_add_u32 s76, s76, s72
 s_add_u32 s76, s76, 65536
 MV 136,44,8
 RW 114,20,51200
 MV 132,44,4
 DL 4,60,76,0
 MV 128,44,0
 RC 84,15,10240
 MV 160,48,0
 MV 164,48,4
 RW 116,21,49152
 MV 168,48,8
 MV 172,48,12
 RW 118,21,51200
 MV 176,48,16
 DL 5,60,76,1024
 MV 180,48,20
 RC 88,15,12288
 MV 184,48,24
 MV 188,48,28
 RW 120,22,49152
 MV 220,52,28
 MV 216,52,24
 RW 122,22,51200
 MV 212,52,20
 DL 6,60,76,2048
 MV 208,52,16
 RC 92,15,14336
 MV 204,52,12
 MV 200,52,8
 RW 124,23,49152
 MV 196,52,4
 MV 192,52,0
 RW 126,23,51200
 MV 224,56,0
 DL 7,60,76,3072
 MV 228,56,4
 MV 232,56,8
 MV 236,56,12
 MV 240,56,16
 MV 244,56,20
 MV 248,56,24
 MV 252,56,28
 MA 156,60,28
 MA 152,60,24
 MA 148,60,20
 MA 144,60,16
 MA 140,60,12
 MA 136,60,8
 MA 132,60,4
 MA 128,60,0
 s_waitcnt vmcnt(16) lgkmcnt(0)
 s_barrier
 MV 32,96,64
 MV 36,96,68
 RC 0,12,0
 MV 40,96,72
 s_add_u32 m0, s75, 49152
 s_add_u32 s77, s87, 3932160
 s_and_b32 s77, s77, 0x7fffff
 s_add_u32 s77, s77, s73
 MV 44,96,76
 RW 32,16,0
 MV 48,96,80
 DL 8,64,77,0
 MV 52,96,84
 RW 34,16,2048
 MV 56,96,88
 MV 60,96,92
 RC 4,12,2048
 MV 92,100,92
 MV 88,100,88
 RW 36,17,0
 MV 84,100,84
 DL 9,64,77,1024
 MV 80,100,80
 RW 38,17,2048
 MV 76,100,76
 MV 72,100,72
 RC 8,12,4096
 MV 68,100,68
 MV 64,100,64
 RW 40,18,0
 MV 96,104,64
 DL 10,64,77,2048
 MV 100,104,68
 RW 42,18,2048
 MV 104,104,72
 MV 108,104,76
 RC 12,12,6144
 MV 112,104,80
 MV 116,104,84
 RW 44,19,0
 MV 120,104,88
 DL 11,64,77,3072
 MV 124,104,92
 RW 46,19,2048
 MV 156,108,92
 MV 152,108,88
 RC 16,12,8192
 MV 148,108,84
 MV 144,108,80
 RW 48,20,0
 MV 140,108,76
 s_add_u32 m0, s74, 65536
 s_add_u32 s76, s86, 1024
 s_and_b32 s76, s76, 2047
 s_add_u32 s76, s76, s72
 MV 136,108,72
 RW 50,20,2048
 MV 132,108,68
 DL 4,60,76,0
 MV 128,108,64
 RC 20,12,10240
 MV 160,112,64
 MV 164,112,68
 RW 52,21,0
 MV 168,112,72
 MV 172,112,76
 RW 54,21,2048
 MV 176,112,80
 DL 5,60,76,1024
 MV 180,112,84
 RC 24,12,12288
 MV 184,112,88
 MV 188,112,92
 RW 56,22,0
 MV 220,116,92
 MV 216,116,88
 RW 58,22,2048
 MV 212,116,84
 DL 6,60,76,2048
 MV 208,116,80
 RC 28,12,14336
 MV 204,116,76
 MV 200,116,72
 RW 60,23,0
 MV 196,116,68
 MV 192,116,64
 RW 62,23,2048
 MV 224,120,64
 DL 7,60,76,3072
 MV 228,120,68
 MV 232,120,72
 MV 236,120,76
 MV 240,120,80
 MV 244,120,84
 MV 248,120,88
 MV 252,120,92
 MA 156,124,92
 MA 152,124,88
 MA 148,124,84
 MA 144,124,80
 MA 140,124,76
 MA 136,124,72
 MA 132,124,68
 MA 128,124,64
 s_waitcnt vmcnt(20) lgkmcnt(0)
 s_barrier
 MV 32,32,0
 MV 36,32,4
 RC 64,13,0
 MV 40,32,8
 s_add_u32 m0, s75, 0
 s_add_u32 s77, s87, 4194304
 s_and_b32 s77, s77, 0x7fffff
 s_add_u32 s77, s77, s73
 MV 44,32,12
 RW 96,16,16384
 MV 48,32,16
 DL 8,64,77,0
 MV 52,32,20
 RW 98,16,18432
 MV 56,32,24
 MV 60,32,28
 RC 68,13,2048
 MV 92,36,28
 MV 88,36,24
 RW 100,17,16384
 MV 84,36,20
 DL 9,64,77,1024
 MV 80,36,16
 RW 102,17,18432
 MV 76,36,12
 MV 72,36,8
 RC 72,13,4096
 MV 68,36,4
 MV 64,36,0
 RW 104,18,16384
 MV 96,40,0
 DL 10,64,77,2048
 MV 100,40,4
 RW 106,18,18432
 MV 104,40,8
 MV 108,40,12
 RC 76,13,6144
 MV 112,40,16
 MV 116,40,20
 RW 108,19,16384
 MV 120,40,24
 DL 11,64,77,3072
 MV 124,40,28
 RW 110,19,18432
 MV 156,44,28
 MV 152,44,24
 RC 80,13,8192
 MV 148,44,20
 MV 144,44,16
 RW 112,20,16384
 MV 140,44,12
 s_add_u32 m0, s74, 69632
 s_add_u32 s76, s86, 1024
 s_and_b32 s76, s76, 2047
 s_add_u32 s76, s76, s72
 s_add_u32 s76, s76, 65536
 MV 136,44,8
 RW 114,20,18432
 MV 132,44,4
 DL 4,60,76,0
 MV 128,44,0
 RC 84,13,10240
 MV 160,48,0
 MV 164,48,4
 RW 116,21,16384
 MV 168,48,8
 MV 172,48,12
 RW 118,21,18432
 MV 176,48,16
 DL 5,60,76,1024
 MV 180,48,20
 RC 88,13,12288
 MV 184,48,24
 MV 188,48,28
 RW 120,22,16384
 MV 220,52,28
 MV 216,52,24
 RW 122,22,18432
 MV 212,52,20
 DL 6,60,76,2048
 MV 208,52,16
 RC 92,13,14336
 MV 204,52,12
 MV 200,52,8
 RW 124,23,16384
 MV 196,52,4
 MV 192,52,0
 RW 126,23,18432
 MV 224,56,0
 DL 7,60,76,3072
 MV 228,56,4
 MV 232,56,8
 MV 236,56,12
 MV 240,56,16
 MV 244,56,20
 MV 248,56,24
 MV 252,56,28
 MA 156,60,28
 MA 152,60,24
 MA 148,60,20
 MA 144,60,16
 MA 140,60,12
 MA 136,60,8
 MA 132,60,4
 MA 128,60,0
 s_waitcnt vmcnt(16) lgkmcnt(0)
 s_barrier
 MV 32,96,64
 MV 36,96,68
 RC 0,12,32768
 MV 40,96,72
 s_add_u32 m0, s75, 16384
 s_add_u32 s77, s87, 4456448
 s_and_b32 s77, s77, 0x7fffff
 s_add_u32 s77, s77, s73
 MV 44,96,76
 RW 32,16,32768
 MV 48,96,80
 DL 8,64,77,0
 MV 52,96,84
 RW 34,16,34816
 MV 56,96,88
 MV 60,96,92
 RC 4,12,34816
 MV 92,100,92
 MV 88,100,88
 RW 36,17,32768
 MV 84,100,84
 DL 9,64,77,1024
 MV 80,100,80
 RW 38,17,34816
 MV 76,100,76
 MV 72,100,72
 RC 8,12,36864
 MV 68,100,68
 MV 64,100,64
 RW 40,18,32768
 MV 96,104,64
 DL 10,64,77,2048
 MV 100,104,68
 RW 42,18,34816
 MV 104,104,72
 MV 108,104,76
 RC 12,12,38912
 MV 112,104,80
 MV 116,104,84
 RW 44,19,32768
 MV 120,104,88
 DL 11,64,77,3072
 MV 124,104,92
 RW 46,19,34816
 MV 156,108,92
 MV 152,108,88
 RC 16,12,40960
 MV 148,108,84
 MV 144,108,80
 RW 48,20,32768
 MV 140,108,76
 s_add_u32 m0, s74, 0
 s_add_u32 s76, s86, 1152
 s_and_b32 s76, s76, 2047
 s_add_u32 s76, s76, s72
 MV 136,108,72
 RW 50,20,34816
 MV 132,108,68
 DL 4,60,76,0
 MV 128,108,64
 RC 20,12,43008
 MV 160,112,64
 MV 164,112,68
 RW 52,21,32768
 MV 168,112,72
 MV 172,112,76
 RW 54,21,34816
 MV 176,112,80
 DL 5,60,76,1024
 MV 180,112,84
 RC 24,12,45056
 MV 184,112,88
 MV 188,112,92
 RW 56,22,32768
 MV 220,116,92
 MV 216,116,88
 RW 58,22,34816
 MV 212,116,84
 DL 6,60,76,2048
 MV 208,116,80
 RC 28,12,47104
 MV 204,116,76
 MV 200,116,72
 RW 60,23,32768
 MV 196,116,68
 MV 192,116,64
 RW 62,23,34816
 MV 224,120,64
 DL 7,60,76,3072
 MV 228,120,68
 MV 232,120,72
 MV 236,120,76
 MV 240,120,80
 MV 244,120,84
 MV 248,120,88
 MV 252,120,92
 MA 156,124,92
 MA 152,124,88
 MA 148,124,84
 MA 144,124,80
 MA 140,124,76
 MA 136,124,72
 MA 132,124,68
 MA 128,124,64
 s_waitcnt vmcnt(20) lgkmcnt(0)
 s_cmp_eq_u32 s20, 0
 s_cbranch_scc0 mk_x0_8
 s_mov_b32 s41, 0xffff
 s_mov_b32 s42, 0xffff
 s_mov_b32 s44, 0
 s_branch mk_xw_9_t
mk_xw_9:
 s_sleep 2
 global_load_dword v30, v29, s[16:17] sc1
 s_waitcnt vmcnt(0)
mk_xw_9_t:
 v_cmp_gt_u32 vcc, 16, v30
 s_add_u32 s44, s44, 1
 s_nop 3
 s_and_b32 vcc_lo, vcc_lo, s41
 s_and_b32 vcc_hi, vcc_hi, s42
 s_cbranch_vccz mk_xw_9_ok
 s_cmp_lt_u32 s44, 0x40000
 s_cbranch_scc1 mk_xw_9
mk_xw_9_ok:
mk_x0_8:
 s_barrier
 s_lshl_b32 s59, s39, 2
 s_add_u32 s59, s59, s20
 s_mul_i32 s59, s59, 28672
 s_add_u32 s59, s59, 0x2000000
 MV 32,32,0
 MV 36,32,4
 RC 64,13,32768
 MV 40,32,8
 s_add_u32 m0, s75, 32768
 s_add_u32 s77, s87, 4718592
 s_and_b32 s77, s77, 0x7fffff
 s_add_u32 s77, s77, s73
 MV 44,32,12
 RW 96,16,49152
 MV 48,32,16
 DL 8,64,77,0
 MV 52,32,20
 RW 98,16,51200
 MV 56,32,24
 MV 60,32,28
 RC 68,13,34816
 MV 92,36,28
 MV 88,36,24
 RW 100,17,49152
 MV 84,36,20
 DL 9,64,77,1024
 MV 80,36,16
 RW 102,17,51200
 MV 76,36,12
 MV 72,36,8
 RC 72,13,36864
 MV 68,36,4
 MV 64,36,0
 RW 104,18,49152
 MV 96,40,0
 DL 10,64,77,2048
 MV 100,40,4
 RW 106,18,51200
 MV 104,40,8
 MV 108,40,12
 RC 76,13,38912
 MV 112,40,16
 MV 116,40,20
 RW 108,19,49152
 MV 120,40,24
 DL 11,64,77,3072
 MV 124,40,28
 RW 110,19,51200
 MV 156,44,28
 MV 152,44,24
 RC 80,13,40960
 MV 148,44,20
 MV 144,44,16
 RW 112,20,49152
 MV 140,44,12
 s_add_u32 m0, s74, 4096
 s_add_u32 s76, s86, 1152
 s_and_b32 s76, s76, 2047
 s_add_u32 s76, s76, s72
 s_add_u32 s76, s76, 65536
 MV 136,44,8
 RW 114,20,51200
 MV 132,44,4
 DL 4,60,76,0
 MV 128,44,0
 RC 84,13,43008
 MV 160,48,0
 MV 164,48,4
 RW 116,21,49152
 MV 168,48,8
 MV 172,48,12
 RW 118,21,51200
 MV 176,48,16
 DL 5,60,76,1024
 MV 180,48,20
 RC 88,13,45056
 MV 184,48,24
 MV 188,48,28
 RW 120,22,49152
 MV 220,52,28
 MV 216,52,24
 RW 122,22,51200
 MV 212,52,20
 DL 6,60,76,2048
 MV 208,52,16
 RC 92,13,47104
 MV 204,52,12
 MV 200,52,8
 RW 124,23,49152
 MV 196,52,4
 MV 192,52,0
 RW 126,23,51200
 MV 224,56,0
 DL 7,60,76,3072
 MV 228,56,4
 MV 232,56,8
 MV 236,56,12
 MV 240,56,16
 MV 244,56,20
 MV 248,56,24
 s_add_u32 s42, s59, 8192
 buffer_load_dwordx4 a[208:211], v1, s[4:7], s42 offen offset:0
 MV 252,56,28
 MA 156,60,28
 MA 152,60,24
 MA 148,60,20
 MA 144,60,16
 MA 140,60,12
 s_add_u32 s42, s59, 8192
 buffer_load_dwordx4 a[212:215], v1, s[4:7], s42 offen offset:1024
 MA 136,60,8
 MA 132,60,4
 MA 128,60,0
 s_waitcnt vmcnt(18) lgkmcnt(0)
 s_barrier
 MV 32,96,64
 MV 36,96,68
 RC 0,14,0
 MV 40,96,72
 s_add_u32 m0, s75, 49152
 s_add_u32 s77, s87, 4980736
 s_and_b32 s77, s77, 0x7fffff
 s_add_u32 s77, s77, s73
 MV 44,96,76
 RW 32,16,0
 MV 48,96,80
 DL 8,64,77,0
 MV 52,96,84
 RW 34,16,2048
 MV 56,96,88
 MV 60,96,92
 RC 4,14,2048
 MV 92,100,92
 MV 88,100,88
 RW 36,17,0
 MV 84,100,84
 DL 9,64,77,1024
 MV 80,100,80
 RW 38,17,2048
 MV 76,100,76
 MV 72,100,72
 RC 8,14,4096
 MV 68,100,68
 MV 64,100,64
 RW 40,18,0
 MV 96,104,64
 DL 10,64,77,2048
 MV 100,104,68
 RW 42,18,2048
 MV 104,104,72
 MV 108,104,76
 RC 12,14,6144
 MV 112,104,80
 MV 116,104,84
 RW 44,19,0
 MV 120,104,88
 DL 11,64,77,3072
 MV 124,104,92
 RW 46,19,2048
 MV 156,108,92
 MV 152,108,88
 RC 16,14,8192
 MV 148,108,84
 MV 144,108,80
 RW 48,20,0
 MV 140,108,76
 s_add_u32 m0, s74, 32768
 s_add_u32 s76, s86, 1280
 s_and_b32 s76, s76, 2047
 s_add_u32 s76, s76, s72
 MV 136,108,72
 RW 50,20,2048
 MV 132,108,68
 DL 4,60,76,0
 MV 128,108,64
 RC 20,14,10240
 MV 160,112,64
 MV 164,112,68
 RW 52,21,0
 MV 168,112,72
 MV 172,112,76
 RW 54,21,2048
 MV 176,112,80
 DL 5,60,76,1024
 MV 180,112,84
 RC 24,14,12288
 MV 184,112,88
 MV 188,112,92
 RW 56,22,0
 MV 220,116,92
 MV 216,116,88
 RW 58,22,2048
 MV 212,116,84
 DL 6,60,76,2048
 MV 208,116,80
 RC 28,14,14336
 MV 204,116,76
 MV 200,116,72
 RW 60,23,0
 MV 196,116,68
 MV 192,116,64
 RW 62,23,2048
 MV 224,120,64
 DL 7,60,76,3072
 MV 228,120,68
 MV 232,120,72
 MV 236,120,76
 MV 240,120,80
 MV 244,120,84
 MV 248,120,88
 s_add_u32 s42, s59, 8192
 buffer_load_dwordx4 a[216:219], v1, s[4:7], s42 offen offset:2048
 MV 252,120,92
 MA 156,124,92
 MA 152,124,88
 MA 148,124,84
 MA 144,124,80
 MA 140,124,76
 s_add_u32 s42, s59, 8192
 buffer_load_dwordx4 a[220:223], v1, s[4:7], s42 offen offset:3072
 MA 136,124,72
 MA 132,124,68
 MA 128,124,64
 s_waitcnt vmcnt(24) lgkmcnt(0)
 s_barrier
 MV 32,32,0
 MV 36,32,4
 RC 64,15,0
 MV 40,32,8
 s_add_u32 m0, s75, 0
 s_add_u32 s77, s87, 5242880
 s_and_b32 s77, s77, 0x7fffff
 s_add_u32 s77, s77, s73
 MV 44,32,12
 RW 96,16,16384
 MV 48,32,16
 DL 8,64,77,0
 MV 52,32,20
 RW 98,16,18432
 MV 56,32,24
 MV 60,32,28
 RC 68,15,2048
 MV 92,36,28
 MV 88,36,24
 RW 100,17,16384
 MV 84,36,20
 DL 9,64,77,1024
 MV 80,36,16
 RW 102,17,18432
 MV 76,36,12
 MV 72,36,8
 RC 72,15,4096
 MV 68,36,4
 MV 64,36,0
 RW 104,18,16384
 MV 96,40,0
 DL 10,64,77,2048
 MV 100,40,4
 RW 106,18,18432
 MV 104,40,8
 MV 108,40,12
 RC 76,15,6144
 MV 112,40,16
 MV 116,40,20
 RW 108,19,16384
 MV 120,40,24
 DL 11,64,77,3072
 MV 124,40,28
 RW 110,19,18432
 MV 156,44,28
 MV 152,44,24
 RC 80,15,8192
 MV 148,44,20
 MV 144,44,16
 RW 112,20,16384
 MV 140,44,12
 s_add_u32 m0, s74, 36864
 s_add_u32 s76, s86, 1280
 s_and_b32 s76, s76, 2047
 s_add_u32 s76, s76, s72
 s_add_u32 s76, s76, 65536
 MV 136,44,8
 RW 114,20,18432
 MV 132,44,4
 DL 4,60,76,0
 MV 128,44,0
 RC 84,15,10240
 MV 160,48,0
 MV 164,48,4
 RW 116,21,16384
 MV 168,48,8
 MV 172,48,12
 RW 118,21,18432
 MV 176,48,16
 DL 5,60,76,1024
 MV 180,48,20
 RC 88,15,12288
 MV 184,48,24
 MV 188,48,28
 RW 120,22,16384
 MV 220,52,28
 MV 216,52,24
 RW 122,22,18432
 MV 212,52,20
 DL 6,60,76,2048
 MV 208,52,16
 RC 92,15,14336
 MV 204,52,12
 MV 200,52,8
 RW 124,23,16384
 MV 196,52,4
 MV 192,52,0
 RW 126,23,18432
 MV 224,56,0
 DL 7,60,76,3072
 MV 228,56,4
 MV 232,56,8
 MV 236,56,12
 MV 240,56,16
 MV 244,56,20
 MV 248,56,24
 s_add_u32 s42, s59, 12288
 buffer_load_dwordx4 a[224:227], v1, s[4:7], s42 offen offset:0
 MV 252,56,28
 MA 156,60,28
 MA 152,60,24
 MA 148,60,20
 MA 144,60,16
 MA 140,60,12
 s_add_u32 s42, s59, 12288
 buffer_load_dwordx4 a[228:231], v1, s[4:7], s42 offen offset:1024
 MA 136,60,8
 MA 132,60,4
 MA 128,60,0
 s_waitcnt vmcnt(22) lgkmcnt(0)
 s_barrier
 MV 32,96,64
 MV 36,96,68
 RC 0,12,0
 MV 40,96,72
 s_add_u32 m0, s75, 16384
 s_add_u32 s77, s87, 5505024
 s_and_b32 s77, s77, 0x7fffff
 s_add_u32 s77, s77, s73
 MV 44,96,76
 RW 32,16,32768
 MV 48,96,80
 DL 8,64,77,0
 MV 52,96,84
 RW 34,16,34816
 MV 56,96,88
 MV 60,96,92
 RC 4,12,2048
 MV 92,100,92
 MV 88,100,88
 RW 36,17,32768
 MV 84,100,84
 DL 9,64,77,1024
 MV 80,100,80
 RW 38,17,34816
 MV 76,100,76
 MV 72,100,72
 RC 8,12,4096
 MV 68,100,68
 MV 64,100,64
 RW 40,18,32768
 MV 96,104,64
 DL 10,64,77,2048
 MV 100,104,68
 RW 42,18,34816
 MV 104,104,72
 MV 108,104,76
 RC 12,12,6144
 MV 112,104,80
 MV 116,104,84
 RW 44,19,32768
 MV 120,104,88
 DL 11,64,77,3072
 MV 124,104,92
 RW 46,19,34816
 MV 156,108,92
 MV 152,108,88
 RC 16,12,8192
 MV 148,108,84
 MV 144,108,80
 RW 48,20,32768
 MV 140,108,76
 s_add_u32 m0, s74, 65536
 s_add_u32 s76, s86, 1408
 s_and_b32 s76, s76, 2047
 s_add_u32 s76, s76, s72
 MV 136,108,72
 RW 50,20,34816
 MV 132,108,68
 DL 4,60,76,0
 MV 128,108,64
 RC 20,12,10240
 MV 160,112,64
 MV 164,112,68
 RW 52,21,32768
 MV 168,112,72
 MV 172,112,76
 RW 54,21,34816
 MV 176,112,80
 DL 5,60,76,1024
 MV 180,112,84
 RC 24,12,12288
 MV 184,112,88
 MV 188,112,92
 RW 56,22,32768
 MV 220,116,92
 MV 216,116,88
 RW 58,22,34816
 MV 212,116,84
 DL 6,60,76,2048
 MV 208,116,80
 RC 28,12,14336
 MV 204,116,76
 MV 200,116,72
 RW 60,23,32768
 MV 196,116,68
 MV 192,116,64
 RW 62,23,34816
 MV 224,120,64
 DL 7,60,76,3072
 MV 228,120,68
 MV 232,120,72
 MV 236,120,76
 MV 240,120,80
 MV 244,120,84
 MV 248,120,88
 s_add_u32 s42, s59, 12288
 buffer_load_dwordx4 a[232:235], v1, s[4:7], s42 offen offset:2048
 MV 252,120,92
 MA 156,124,92
 MA 152,124,88
 MA 148,124,84
 MA 144,124,80
 MA 140,124,76
 s_add_u32 s42, s59, 12288
 buffer_load_dwordx4 a[236:239], v1, s[4:7], s42 offen offset:3072
 MA 136,124,72
 MA 132,124,68
 MA 128,124,64
 s_waitcnt vmcnt(26) lgkmcnt(0)
 s_barrier
 MV 32,32,0
 MV 36,32,4
 RC 64,13,0
 MV 40,32,8
 s_add_u32 m0, s75, 32768
 s_add_u32 s77, s87, 5767168
 s_and_b32 s77, s77, 0x7fffff
 s_add_u32 s77, s77, s73
 MV 44,32,12
 RW 96,16,49152
 MV 48,32,16
 DL 8,64,77,0
 MV 52,32,20
 RW 98,16,51200
 MV 56,32,24
 MV 60,32,28
 RC 68,13,2048
 MV 92,36,28
 MV 88,36,24
 RW 100,17,49152
 MV 84,36,20
 DL 9,64,77,1024
 MV 80,36,16
 RW 102,17,51200
 MV 76,36,12
 MV 72,36,8
 RC 72,13,4096
 MV 68,36,4
 MV 64,36,0
 RW 104,18,49152
 MV 96,40,0
 DL 10,64,77,2048
 MV 100,40,4
 RW 106,18,51200
 MV 104,40,8
 MV 108,40,12
 RC 76,13,6144
 MV 112,40,16
 MV 116,40,20
 RW 108,19,49152
 MV 120,40,24
 DL 11,64,77,3072
 MV 124,40,28
 RW 110,19,51200
 MV 156,44,28
 MV 152,44,24
 RC 80,13,8192
 MV 148,44,20
 MV 144,44,16
 RW 112,20,49152
 MV 140,44,12
 s_add_u32 m0, s74, 69632
 s_add_u32 s76, s86, 1408
 s_and_b32 s76, s76, 2047
 s_add_u32 s76, s76, s72
 s_add_u32 s76, s76, 65536
 MV 136,44,8
 RW 114,20,51200
 MV 132,44,4
 DL 4,60,76,0
 MV 128,44,0
 RC 84,13,10240
 MV 160,48,0
 MV 164,48,4
 RW 116,21,49152
 MV 168,48,8
 MV 172,48,12
 RW 118,21,51200
 MV 176,48,16
 DL 5,60,76,1024
 MV 180,48,20
 RC 88,13,12288
 MV 184,48,24
 MV 188,48,28
 RW 120,22,49152
 MV 220,52,28
 MV 216,52,24
 RW 122,22,51200
 MV 212,52,20
 DL 6,60,76,2048
 MV 208,52,16
 RC 92,13,14336
 MV 204,52,12
 MV 200,52,8
 RW 124,23,49152
 MV 196,52,4
 MV 192,52,0
 RW 126,23,51200
 MV 224,56,0
 DL 7,60,76,3072
 MV 228,56,4
 MV 232,56,8
 MV 236,56,12
 MV 240,56,16
 MV 244,56,20
 MV 248,56,24
 s_add_u32 s42, s59, 16384
 buffer_load_dwordx4 a[160:163], v1, s[4:7], s42 offen offset:0
 MV 252,56,28
 MA 156,60,28
 MA 152,60,24
 MA 148,60,20
 MA 144,60,16
 MA 140,60,12
 s_add_u32 s42, s59, 16384
 buffer_load_dwordx4 a[164:167], v1, s[4:7], s42 offen offset:1024
 MA 136,60,8
 MA 132,60,4
 MA 128,60,0
 s_waitcnt vmcnt(22) lgkmcnt(0)
 s_barrier
 MV 32,96,64
 MV 36,96,68
 RC 0,12,32768
 MV 40,96,72
 s_add_u32 m0, s75, 49152
 s_add_u32 s77, s87, 6029312
 s_and_b32 s77, s77, 0x7fffff
 s_add_u32 s77, s77, s73
 MV 44,96,76
 RW 32,16,0
 MV 48,96,80
 DL 8,64,77,0
 MV 52,96,84
 RW 34,16,2048
 MV 56,96,88
 MV 60,96,92
 RC 4,12,34816
 MV 92,100,92
 MV 88,100,88
 RW 36,17,0
 MV 84,100,84
 DL 9,64,77,1024
 MV 80,100,80
 RW 38,17,2048
 MV 76,100,76
 MV 72,100,72
 RC 8,12,36864
 MV 68,100,68
 MV 64,100,64
 RW 40,18,0
 MV 96,104,64
 DL 10,64,77,2048
 MV 100,104,68
 RW 42,18,2048
 MV 104,104,72
 MV 108,104,76
 RC 12,12,38912
 MV 112,104,80
 MV 116,104,84
 RW 44,19,0
 MV 120,104,88
 DL 11,64,77,3072
 MV 124,104,92
 RW 46,19,2048
 MV 156,108,92
 MV 152,108,88
 RC 16,12,40960
 MV 148,108,84
 MV 144,108,80
 RW 48,20,0
 MV 140,108,76
 s_add_u32 m0, s74, 0
 s_add_u32 s76, s86, 1536
 s_and_b32 s76, s76, 2047
 s_add_u32 s76, s76, s72
 MV 136,108,72
 RW 50,20,2048
 MV 132,108,68
 DL 4,60,76,0
 MV 128,108,64
 RC 20,12,43008
 MV 160,112,64
 MV 164,112,68
 RW 52,21,0
 MV 168,112,72
 MV 172,112,76
 RW 54,21,2048
 MV 176,112,80
 DL 5,60,76,1024
 MV 180,112,84
 RC 24,12,45056
 MV 184,112,88
 MV 188,112,92
 RW 56,22,0
 MV 220,116,92
 MV 216,116,88
 RW 58,22,2048
 MV 212,116,84
 DL 6,60,76,2048
 MV 208,116,80
 RC 28,12,47104
 MV 204,116,76
 MV 200,116,72
 RW 60,23,0
 MV 196,116,68
 MV 192,116,64
 RW 62,23,2048
 MV 224,120,64
 DL 7,60,76,3072
 MV 228,120,68
 MV 232,120,72
 MV 236,120,76
 MV 240,120,80
 MV 244,120,84
 MV 248,120,88
 s_add_u32 s42, s59, 16384
 buffer_load_dwordx4 a[168:171], v1, s[4:7], s42 offen offset:2048
 MV 252,120,92
 MA 156,124,92
 MA 152,124,88
 MA 148,124,84
 MA 144,124,80
 MA 140,124,76
 s_add_u32 s42, s59, 16384
 buffer_load_dwordx4 a[172:175], v1, s[4:7], s42 offen offset:3072
 MA 136,124,72
 MA 132,124,68
 MA 128,124,64
 s_waitcnt vmcnt(26) lgkmcnt(0)
 s_barrier
 MV 32,32,0
 MV 36,32,4
 RC 64,13,32768
 MV 40,32,8
 s_add_u32 m0, s75, 0
 s_add_u32 s77, s87, 6291456
 s_and_b32 s77, s77, 0x7fffff
 s_add_u32 s77, s77, s73
 MV 44,32,12
 RW 96,16,16384
 MV 48,32,16
 DL 8,64,77,0
 MV 52,32,20
 RW 98,16,18432
 MV 56,32,24
 MV 60,32,28
 RC 68,13,34816
 MV 92,36,28
 MV 88,36,24
 RW 100,17,16384
 MV 84,36,20
 DL 9,64,77,1024
 MV 80,36,16
 RW 102,17,18432
 MV 76,36,12
 MV 72,36,8
 RC 72,13,36864
 MV 68,36,4
 MV 64,36,0
 RW 104,18,16384
 MV 96,40,0
 DL 10,64,77,2048
 MV 100,40,4
 RW 106,18,18432
 MV 104,40,8
 MV 108,40,12
 RC 76,13,38912
 MV 112,40,16
 MV 116,40,20
 RW 108,19,16384
 MV 120,40,24
 DL 11,64,77,3072
 MV 124,40,28
 RW 110,19,18432
 MV 156,44,28
 MV 152,44,24
 RC 80,13,40960
 MV 148,44,20
 MV 144,44,16
 RW 112,20,16384
 MV 140,44,12
 s_add_u32 m0, s74, 4096
 s_add_u32 s76, s86, 1536
 s_and_b32 s76, s76, 2047
 s_add_u32 s76, s76, s72
 s_add_u32 s76, s76, 65536
 MV 136,44,8
 RW 114,20,18432
 MV 132,44,4
 DL 4,60,76,0
 MV 128,44,0
 RC 84,13,43008
 MV 160,48,0
 MV 164,48,4
 RW 116,21,16384
 MV 168,48,8
 MV 172,48,12
 RW 118,21,18432
 MV 176,48,16
 DL 5,60,76,1024
 MV 180,48,20
 RC 88,13,45056
 MV 184,48,24
 MV 188,48,28
 RW 120,22,16384
 MV 220,52,28
 MV 216,52,24
 RW 122,22,18432
 MV 212,52,20
 DL 6,60,76,2048
 MV 208,52,16
 RC 92,13,47104
 MV 204,52,12
 MV 200,52,8
 RW 124,23,16384
 MV 196,52,4
 MV 192,52,0
 RW 126,23,18432
 MV 224,56,0
 DL 7,60,76,3072
 MV 228,56,4
 MV 232,56,8
 MV 236,56,12
 MV 240,56,16
 MV 244,56,20
 MV 248,56,24
 s_add_u32 s42, s59, 20480
 buffer_load_dwordx4 a[176:179], v1, s[4:7], s42 offen offset:0
 MV 252,56,28
 MA 156,60,28
 MA 152,60,24
 MA 148,60,20
 MA 144,60,16
 MA 140,60,12
 MA 136,60,8
 MA 132,60,4
 MA 128,60,0
 s_waitcnt vmcnt(21) lgkmcnt(0)
 s_barrier
 MV 32,96,64
 MV 36,96,68
 RC 0,14,0
 MV 40,96,72
 s_add_u32 m0, s75, 16384
 s_add_u32 s77, s87, 6553600
 s_and_b32 s77, s77, 0x7fffff
 s_add_u32 s77, s77, s73
 MV 44,96,76
 RW 32,16,32768
 MV 48,96,80
 DL 8,64,77,0
 MV 52,96,84
 RW 34,16,34816
 MV 56,96,88
 MV 60,96,92
 RC 4,14,2048
 MV 92,100,92
 MV 88,100,88
 RW 36,17,32768
 MV 84,100,84
 DL 9,64,77,1024
 MV 80,100,80
 RW 38,17,34816
 MV 76,100,76
 MV 72,100,72
 RC 8,14,4096
 MV 68,100,68
 MV 64,100,64
 RW 40,18,32768
 MV 96,104,64
 DL 10,64,77,2048
 MV 100,104,68
 RW 42,18,34816
 MV 104,104,72
 MV 108,104,76
 RC 12,14,6144
 MV 112,104,80
 MV 116,104,84
 RW 44,19,32768
 MV 120,104,88
 DL 11,64,77,3072
 MV 124,104,92
 RW 46,19,34816
 MV 156,108,92
 MV 152,108,88
 RC 16,14,8192
 MV 148,108,84
 MV 144,108,80
 RW 48,20,32768
 MV 140,108,76
 s_add_u32 m0, s74, 32768
 s_add_u32 s76, s86, 1664
 s_and_b32 s76, s76, 2047
 s_add_u32 s76, s76, s72
 MV 136,108,72
 RW 50,20,34816
 MV 132,108,68
 DL 4,60,76,0
 MV 128,108,64
 RC 20,14,10240
 MV 160,112,64
 MV 164,112,68
 RW 52,21,32768
 MV 168,112,72
 MV 172,112,76
 RW 54,21,34816
 MV 176,112,80
 DL 5,60,76,1024
 MV 180,112,84
 RC 24,14,12288
 MV 184,112,88
 MV 188,112,92
 RW 56,22,32768
 MV 220,116,92
 MV 216,116,88
 RW 58,22,34816
 MV 212,116,84
 DL 6,60,76,2048
 MV 208,116,80
 RC 28,14,14336
 MV 204,116,76
 MV 200,116,72
 RW 60,23,32768
 MV 196,116,68
 MV 192,116,64
 RW 62,23,34816
 MV 224,120,64
 DL 7,60,76,3072
 MV 228,120,68
 MV 232,120,72
 MV 236,120,76
 MV 240,120,80
 MV 244,120,84
 MV 248,120,88
 s_add_u32 s42, s59, 20480
 buffer_load_dwordx4 a[180:183], v1, s[4:7], s42 offen offset:1024
 MV 252,120,92
 MA 156,124,92
 MA 152,124,88
 MA 148,124,84
 MA 144,124,80
 MA 140,124,76
 MA 136,124,72
 MA 132,124,68
 MA 128,124,64
 s_waitcnt vmcnt(24) lgkmcnt(0)
 s_barrier
 MV 32,32,0
 MV 36,32,4
 RC 64,15,0
 MV 40,32,8
 s_add_u32 m0, s75, 32768
 s_add_u32 s77, s87, 6815744
 s_and_b32 s77, s77, 0x7fffff
 s_add_u32 s77, s77, s73
 MV 44,32,12
 RW 96,16,49152
 MV 48,32,16
 DL 8,64,77,0
 MV 52,32,20
 RW 98,16,51200
 MV 56,32,24
 MV 60,32,28
 RC 68,15,2048
 MV 92,36,28
 MV 88,36,24
 RW 100,17,49152
 MV 84,36,20
 DL 9,64,77,1024
 MV 80,36,16
 RW 102,17,51200
 MV 76,36,12
 MV 72,36,8
 RC 72,15,4096
 MV 68,36,4
 MV 64,36,0
 RW 104,18,49152
 MV 96,40,0
 DL 10,64,77,2048
 MV 100,40,4
 RW 106,18,51200
 MV 104,40,8
 MV 108,40,12
 RC 76,15,6144
 MV 112,40,16
 MV 116,40,20
 RW 108,19,49152
 MV 120,40,24
 DL 11,64,77,3072
 MV 124,40,28
 RW 110,19,51200
 MV 156,44,28
 MV 152,44,24
 RC 80,15,8192
 MV 148,44,20
 MV 144,44,16
 RW 112,20,49152
 MV 140,44,12
 s_add_u32 m0, s74, 36864
 s_add_u32 s76, s86, 1664
 s_and_b32 s76, s76, 2047
 s_add_u32 s76, s76, s72
 s_add_u32 s76, s76, 65536
 MV 136,44,8
 RW 114,20,51200
 MV 132,44,4
 DL 4,60,76,0
 MV 128,44,0
 RC 84,15,10240
 MV 160,48,0
 MV 164,48,4
 RW 116,21,49152
 MV 168,48,8
 MV 172,48,12
 RW 118,21,51200
 MV 176,48,16
 DL 5,60,76,1024
 MV 180,48,20
 RC 88,15,12288
 MV 184,48,24
 MV 188,48,28
 RW 120,22,49152
 MV 220,52,28
 MV 216,52,24
 RW 122,22,51200
 MV 212,52,20
 DL 6,60,76,2048
 MV 208,52,16
 RC 92,15,14336
 MV 204,52,12
 MV 200,52,8
 RW 124,23,49152
 MV 196,52,4
 MV 192,52,0
 RW 126,23,51200
 MV 224,56,0
 DL 7,60,76,3072
 MV 228,56,4
 MV 232,56,8
 MV 236,56,12
 MV 240,56,16
 MV 244,56,20
 MV 248,56,24
 s_add_u32 s42, s59, 20480
 buffer_load_dwordx4 a[184:187], v1, s[4:7], s42 offen offset:2048
 MV 252,56,28
 MA 156,60,28
 MA 152,60,24
 MA 148,60,20
 MA 144,60,16
 MA 140,60,12
 MA 136,60,8
 MA 132,60,4
 MA 128,60,0
 s_waitcnt vmcnt(19) lgkmcnt(0)
 s_barrier
 MV 32,96,64
 MV 36,96,68
 RC 0,12,0
 MV 40,96,72
 s_add_u32 m0, s75, 49152
 s_add_u32 s77, s87, 7077888
 s_and_b32 s77, s77, 0x7fffff
 s_add_u32 s77, s77, s73
 MV 44,96,76
 RW 32,16,0
 MV 48,96,80
 DL 8,64,77,0
 MV 52,96,84
 RW 34,16,2048
 MV 56,96,88
 MV 60,96,92
 RC 4,12,2048
 MV 92,100,92
 MV 88,100,88
 RW 36,17,0
 MV 84,100,84
 DL 9,64,77,1024
 MV 80,100,80
 RW 38,17,2048
 MV 76,100,76
 MV 72,100,72
 RC 8,12,4096
 MV 68,100,68
 MV 64,100,64
 RW 40,18,0
 MV 96,104,64
 DL 10,64,77,2048
 MV 100,104,68
 RW 42,18,2048
 MV 104,104,72
 MV 108,104,76
 RC 12,12,6144
 MV 112,104,80
 MV 116,104,84
 RW 44,19,0
 MV 120,104,88
 DL 11,64,77,3072
 MV 124,104,92
 RW 46,19,2048
 MV 156,108,92
 MV 152,108,88
 RC 16,12,8192
 MV 148,108,84
 MV 144,108,80
 RW 48,20,0
 MV 140,108,76
 s_add_u32 m0, s74, 65536
 s_add_u32 s76, s86, 1792
 s_and_b32 s76, s76, 2047
 s_add_u32 s76, s76, s72
 MV 136,108,72
 RW 50,20,2048
 MV 132,108,68
 DL 4,60,76,0
 MV 128,108,64
 RC 20,12,10240
 MV 160,112,64
 MV 164,112,68
 RW 52,21,0
 MV 168,112,72
 MV 172,112,76
 RW 54,21,2048
 MV 176,112,80
 DL 5,60,76,1024
 MV 180,112,84
 RC 24,12,12288
 MV 184,112,88
 MV 188,112,92
 RW 56,22,0
 MV 220,116,92
 MV 216,116,88
 RW 58,22,2048
 MV 212,116,84
 DL 6,60,76,2048
 MV 208,116,80
 RC 28,12,14336
 MV 204,116,76
 MV 200,116,72
 RW 60,23,0
 MV 196,116,68
 MV 192,116,64
 RW 62,23,2048
 MV 224,120,64
 DL 7,60,76,3072
 MV 228,120,68
 MV 232,120,72
 MV 236,120,76
 MV 240,120,80
 MV 244,120,84
 MV 248,120,88
 s_add_u32 s42, s59, 20480
 buffer_load_dwordx4 a[188:191], v1, s[4:7], s42 offen offset:3072
 MV 252,120,92
 MA 156,124,92
 MA 152,124,88
 MA 148,124,84
 MA 144,124,80
 MA 140,124,76
 MA 136,124,72
 MA 132,124,68
 MA 128,124,64
 s_waitcnt vmcnt(23) lgkmcnt(0)
 s_barrier
 MV 32,32,0
 MV 36,32,4
 RC 64,13,0
 MV 40,32,8
 s_add_u32 m0, s75, 0
 s_add_u32 s77, s87, 7340032
 s_and_b32 s77, s77, 0x7fffff
 s_add_u32 s77, s77, s73
 MV 44,32,12
 RW 96,16,16384
 MV 48,32,16
 DL 8,64,77,0
 MV 52,32,20
 RW 98,16,18432
 MV 56,32,24
 MV 60,32,28
 RC 68,13,2048
 MV 92,36,28
 MV 88,36,24
 RW 100,17,16384
 MV 84,36,20
 DL 9,64,77,1024
 MV 80,36,16
 RW 102,17,18432
 MV 76,36,12
 MV 72,36,8
 RC 72,13,4096
 MV 68,36,4
 MV 64,36,0
 RW 104,18,16384
 MV 96,40,0
 DL 10,64,77,2048
 MV 100,40,4
 RW 106,18,18432
 MV 104,40,8
 MV 108,40,12
 RC 76,13,6144
 MV 112,40,16
 MV 116,40,20
 RW 108,19,16384
 MV 120,40,24
 DL 11,64,77,3072
 MV 124,40,28
 RW 110,19,18432
 MV 156,44,28
 MV 152,44,24
 RC 80,13,8192
 MV 148,44,20
 MV 144,44,16
 RW 112,20,16384
 MV 140,44,12
 s_add_u32 m0, s74, 69632
 s_add_u32 s76, s86, 1792
 s_and_b32 s76, s76, 2047
 s_add_u32 s76, s76, s72
 s_add_u32 s76, s76, 65536
 MV 136,44,8
 RW 114,20,18432
 MV 132,44,4
 DL 4,60,76,0
 MV 128,44,0
 RC 84,13,10240
 MV 160,48,0
 MV 164,48,4
 RW 116,21,16384
 MV 168,48,8
 MV 172,48,12
 RW 118,21,18432
 MV 176,48,16
 DL 5,60,76,1024
 MV 180,48,20
 RC 88,13,12288
 MV 184,48,24
 MV 188,48,28
 RW 120,22,16384
 MV 220,52,28
 MV 216,52,24
 RW 122,22,18432
 MV 212,52,20
 DL 6,60,76,2048
 MV 208,52,16
 RC 92,13,14336
 MV 204,52,12
 MV 200,52,8
 RW 124,23,16384
 MV 196,52,4
 MV 192,52,0
 RW 126,23,18432
 MV 224,56,0
 DL 7,60,76,3072
 MV 228,56,4
 MV 232,56,8
 MV 236,56,12
 MV 240,56,16
 MV 244,56,20
 MV 248,56,24
 s_add_u32 s42, s59, 24576
 buffer_load_dwordx4 a[192:195], v1, s[4:7], s42 offen offset:0
 MV 252,56,28
 MA 156,60,28
 MA 152,60,24
 MA 148,60,20
 MA 144,60,16
 MA 140,60,12
 MA 136,60,8
 MA 132,60,4
 MA 128,60,0
 s_waitcnt vmcnt(19) lgkmcnt(0)
 s_barrier
 MV 32,96,64
 MV 36,96,68
 RC 0,12,32768
 MV 40,96,72
 s_add_u32 m0, s75, 16384
 s_add_u32 s77, s87, 7602176
 s_and_b32 s77, s77, 0x7fffff
 s_add_u32 s77, s77, s73
 MV 44,96,76
 RW 32,16,32768
 MV 48,96,80
 DL 8,64,77,0
 MV 52,96,84
 RW 34,16,34816
 MV 56,96,88
 MV 60,96,92
 RC 4,12,34816
 MV 92,100,92
 MV 88,100,88
 RW 36,17,32768
 MV 84,100,84
 DL 9,64,77,1024
 MV 80,100,80
 RW 38,17,34816
 MV 76,100,76
 MV 72,100,72
 RC 8,12,36864
 MV 68,100,68
 MV 64,100,64
 RW 40,18,32768
 MV 96,104,64
 DL 10,64,77,2048
 MV 100,104,68
 RW 42,18,34816
 MV 104,104,72
 MV 108,104,76
 RC 12,12,38912
 MV 112,104,80
 MV 116,104,84
 RW 44,19,32768
 MV 120,104,88
 DL 11,64,77,3072
 MV 124,104,92
 RW 46,19,34816
 MV 156,108,92
 MV 152,108,88
 RC 16,12,40960
 MV 148,108,84
 MV 144,108,80
 RW 48,20,32768
 MV 140,108,76
 s_add_u32 m0, s74, 0
 s_add_u32 s76, s86, 1920
 s_and_b32 s76, s76, 2047
 s_add_u32 s76, s76, s72
 MV 136,108,72
 RW 50,20,34816
 MV 132,108,68
 DL 4,60,76,0
 MV 128,108,64
 RC 20,12,43008
 MV 160,112,64
 MV 164,112,68
 RW 52,21,32768
 MV 168,112,72
 MV 172,112,76
 RW 54,21,34816
 MV 176,112,80
 DL 5,60,76,1024
 MV 180,112,84
 RC 24,12,45056
 MV 184,112,88
 MV 188,112,92
 RW 56,22,32768
 MV 220,116,92
 MV 216,116,88
 RW 58,22,34816
 MV 212,116,84
 DL 6,60,76,2048
 MV 208,116,80
 RC 28,12,47104
 MV 204,116,76
 MV 200,116,72
 RW 60,23,32768
 MV 196,116,68
 MV 192,116,64
 RW 62,23,34816
 MV 224,120,64
 DL 7,60,76,3072
 MV 228,120,68
 MV 232,120,72
 MV 236,120,76
 MV 240,120,80
 MV 244,120,84
 MV 248,120,88
 s_add_u32 s42, s59, 24576
 buffer_load_dwordx4 a[196:199], v1, s[4:7], s42 offen offset:1024
 MV 252,120,92
 MA 156,124,92
 MA 152,124,88
 MA 148,124,84
 MA 144,124,80
 MA 140,124,76
 MA 136,124,72
 MA 132,124,68
 MA 128,124,64
 s_waitcnt vmcnt(23) lgkmcnt(0)
 s_barrier
 MV 32,32,0
 MV 36,32,4
 RC 64,13,32768
 MV 40,32,8
 s_add_u32 m0, s75, 32768
 s_add_u32 s77, s87, 7864320
 s_and_b32 s77, s77, 0x7fffff
 s_add_u32 s77, s77, s73
 MV 44,32,12
 RW 96,16,49152
 MV 48,32,16
 DL 8,64,77,0
 MV 52,32,20
 RW 98,16,51200
 MV 56,32,24
 MV 60,32,28
 RC 68,13,34816
 MV 92,36,28
 MV 88,36,24
 RW 100,17,49152
 MV 84,36,20
 DL 9,64,77,1024
 MV 80,36,16
 RW 102,17,51200
 MV 76,36,12
 MV 72,36,8
 RC 72,13,36864
 MV 68,36,4
 MV 64,36,0
 RW 104,18,49152
 MV 96,40,0
 DL 10,64,77,2048
 MV 100,40,4
 RW 106,18,51200
 MV 104,40,8
 MV 108,40,12
 RC 76,13,38912
 MV 112,40,16
 MV 116,40,20
 RW 108,19,49152
 MV 120,40,24
 DL 11,64,77,3072
 MV 124,40,28
 RW 110,19,51200
 MV 156,44,28
 MV 152,44,24
 RC 80,13,40960
 MV 148,44,20
 MV 144,44,16
 RW 112,20,49152
 MV 140,44,12
 s_add_u32 m0, s74, 4096
 s_add_u32 s76, s86, 1920
 s_and_b32 s76, s76, 2047
 s_add_u32 s76, s76, s72
 s_add_u32 s76, s76, 65536
 MV 136,44,8
 RW 114,20,51200
 MV 132,44,4
 DL 4,60,76,0
 MV 128,44,0
 RC 84,13,43008
 MV 160,48,0
 MV 164,48,4
 RW 116,21,49152
 MV 168,48,8
 MV 172,48,12
 RW 118,21,51200
 MV 176,48,16
 DL 5,60,76,1024
 MV 180,48,20
 RC 88,13,45056
 MV 184,48,24
 MV 188,48,28
 RW 120,22,49152
 MV 220,52,28
 MV 216,52,24
 RW 122,22,51200
 MV 212,52,20
 DL 6,60,76,2048
 MV 208,52,16
 RC 92,13,47104
 MV 204,52,12
 MV 200,52,8
 RW 124,23,49152
 MV 196,52,4
 MV 192,52,0
 RW 126,23,51200
 MV 224,56,0
 DL 7,60,76,3072
 MV 228,56,4
 MV 232,56,8
 MV 236,56,12
 MV 240,56,16
 MV 244,56,20
 MV 248,56,24
 s_add_u32 s42, s59, 24576
 buffer_load_dwordx4 a[200:203], v1, s[4:7], s42 offen offset:2048
 MV 252,56,28
 MA 156,60,28
 MA 152,60,24
 MA 148,60,20
 MA 144,60,16
 MA 140,60,12
 MA 136,60,8
 MA 132,60,4
 MA 128,60,0
 s_waitcnt vmcnt(19) lgkmcnt(0)
 s_barrier
 MV 32,96,64
 MV 36,96,68
 RC 0,14,0
 MV 40,96,72
 s_add_u32 m0, s75, 49152
 s_add_u32 s77, s87, 8126464
 s_and_b32 s77, s77, 0x7fffff
 s_add_u32 s77, s77, s73
 MV 44,96,76
 RW 32,16,0
 MV 48,96,80
 DL 8,64,77,0
 MV 52,96,84
 RW 34,16,2048
 MV 56,96,88
 MV 60,96,92
 RC 4,14,2048
 MV 92,100,92
 MV 88,100,88
 RW 36,17,0
 MV 84,100,84
 DL 9,64,77,1024
 MV 80,100,80
 RW 38,17,2048
 MV 76,100,76
 MV 72,100,72
 RC 8,14,4096
 MV 68,100,68
 MV 64,100,64
 RW 40,18,0
 MV 96,104,64
 DL 10,64,77,2048
 MV 100,104,68
 RW 42,18,2048
 MV 104,104,72
 MV 108,104,76
 RC 12,14,6144
 MV 112,104,80
 MV 116,104,84
 RW 44,19,0
 MV 120,104,88
 DL 11,64,77,3072
 MV 124,104,92
 RW 46,19,2048
 MV 156,108,92
 MV 152,108,88
 RC 16,14,8192
 MV 148,108,84
 MV 144,108,80
 RW 48,20,0
 MV 140,108,76
 MV 136,108,72
 RW 50,20,2048
 MV 132,108,68
 MV 128,108,64
 RC 20,14,10240
 MV 160,112,64
 MV 164,112,68
 RW 52,21,0
 MV 168,112,72
 MV 172,112,76
 RW 54,21,2048
 MV 176,112,80
 MV 180,112,84
 RC 24,14,12288
 MV 184,112,88
 MV 188,112,92
 RW 56,22,0
 MV 220,116,92
 MV 216,116,88
 RW 58,22,2048
 MV 212,116,84
 MV 208,116,80
 RC 28,14,14336
 MV 204,116,76
 MV 200,116,72
 RW 60,23,0
 MV 196,116,68
 MV 192,116,64
 RW 62,23,2048
 MV 224,120,64
 MV 228,120,68
 MV 232,120,72
 MV 236,120,76
 MV 240,120,80
 MV 244,120,84
 MV 248,120,88
 s_add_u32 s42, s59, 24576
 buffer_load_dwordx4 a[204:207], v1, s[4:7], s42 offen offset:3072
 MV 252,120,92
 MA 156,124,92
 MA 152,124,88
 MA 148,124,84
 MA 144,124,80
 MA 140,124,76
 MA 136,124,72
 MA 132,124,68
 MA 128,124,64
 s_waitcnt vmcnt(19) lgkmcnt(0)
 s_barrier
 v_lshrrev_b32 v25, 3, v2
 v_lshrrev_b32 v26, 4, v2
 v_lshlrev_b32 v26, 1, v26
 v_and_b32 v27, 7, v2
 v_xor_b32 v26, v26, v27
 v_lshlrev_b32 v26, 4, v26
 v_lshl_add_u32 v4, v25, 13, v26
 v_add_u32 v5, 64512, v4
 v_add_u32 v6, 129024, v4
 v_add_u32 v7, 193536, v4
 s_mov_b32 s8, s12
 s_mov_b32 s9, s13
 s_mov_b32 s10, 3670016
 s_mov_b32 s11, 0x20000
 s_lshl_b32 s36, s21, 9
 s_lshl_b32 s41, s20, 7
 s_add_u32 s36, s36, s41
 s_mov_b32 s37, 262144
 s_mov_b32 s38, 524288
 s_getpc_b64 s[98:99]
mk_ct_10:
 s_add_u32 s98, s98, mk_p1done-mk_ct_10
 s_addc_u32 s99, s99, 0
 s_lshr_b32 s41, s2, 3
 s_lshl_b32 s41, s41, 2
 s_add_u32 s41, s41, s20
 s_lshl_b32 s41, s41, 7
 v_lshrrev_b32 v29, 4, v1
 v_min_u32 v29, 2, v29
 v_lshlrev_b32 v29, 14, v29
 v_add_u32 v29, s41, v29
 v_min_u32 v29, (mk_oproj-mk_p1done)-4, v29
 v_and_b32 v29, 0xfffffffc, v29
 global_load_dword v30, v29, s[98:99]
 s_lshl_b32 s98, s39, 2
 s_add_u32 s98, s98, s20
 s_mul_i32 s98, s98, 28672
 s_add_u32 s98, s98, 0x2000000
 MV 32,32,0
 MV 36,32,4
 RC 64,15,0
 s_add_u32 m0, s27, 32768
 MV 40,32,8
 MV 44,32,12
 RW 96,16,16384
 MV 48,32,16
 MV 52,32,20
 RW 98,16,18432
 s_add_u32 s41, s36, s37
 MV 56,32,24
 MV 60,32,28
 RC 68,15,2048
 MV 92,36,28
 MV 88,36,24
 RW 100,17,16384
 MV 84,36,20
 DL 4,8,36,0
 MV 80,36,16
 RW 102,17,18432
 MV 76,36,12
 MV 72,36,8
 RC 72,15,4096
 MV 68,36,4
 MV 64,36,0
 RW 104,18,16384
 DL 5,8,36,1024
 MV 96,40,0
 MV 100,40,4
 RW 106,18,18432
 MV 104,40,8
 MV 108,40,12
 RC 76,15,6144
 MV 112,40,16
 DL 6,8,36,2048
 MV 116,40,20
 RW 108,19,16384
 MV 120,40,24
 MV 124,40,28
 RW 110,19,18432
 MV 156,44,28
 MV 152,44,24
 RC 80,15,8192
 DL 7,8,36,3072
 MV 148,44,20
 MV 144,44,16
 RW 112,20,16384
 MV 140,44,12
 MV 136,44,8
 RW 114,20,18432
 MV 132,44,4
 s_add_u32 m0, m0, 0x1000
 MV 128,44,0
 RC 84,15,10240
 MV 160,48,0
 MV 164,48,4
 RW 116,21,16384
 MV 168,48,8
 MV 172,48,12
 RW 118,21,18432
 DL 4,8,41,0
 MV 176,48,16
 MV 180,48,20
 RC 88,15,12288
 MV 184,48,24
 MV 188,48,28
 RW 120,22,16384
 MV 220,52,28
 DL 5,8,41,1024
 MV 216,52,24
 RW 122,22,18432
 MV 212,52,20
 MV 208,52,16
 RC 92,15,14336
 MV 204,52,12
 MV 200,52,8
 RW 124,23,16384
 DL 6,8,41,2048
 MV 196,52,4
 MV 192,52,0
 RW 126,23,18432
 MV 224,56,0
 MV 228,56,4
 MV 232,56,8
 DL 7,8,41,3072
 MV 236,56,12
 MV 240,56,16
 MV 244,56,20
 MV 248,56,24
 MV 252,56,28
 s_add_u32 s36, s36, s38
 MA 156,60,28
 MA 152,60,24
 MA 148,60,20
 MA 144,60,16
 MA 140,60,12
 MA 136,60,8
 MA 132,60,4
 MA 128,60,0
 s_waitcnt vmcnt(15) lgkmcnt(0)
 s_barrier
 MV 32,96,64
 MV 36,96,68
 RC 0,12,0
 s_add_u32 m0, s27, 65536
 MV 40,96,72
 MV 44,96,76
 RW 32,16,32768
 MV 48,96,80
 MV 52,96,84
 RW 34,16,34816
 s_add_u32 s41, s36, s37
 MV 56,96,88
 MV 60,96,92
 RC 4,12,2048
 MV 92,100,92
 MV 88,100,88
 RW 36,17,32768
 MV 84,100,84
 DL 4,8,36,0
 MV 80,100,80
 RW 38,17,34816
 MV 76,100,76
 MV 72,100,72
 RC 8,12,4096
 MV 68,100,68
 MV 64,100,64
 RW 40,18,32768
 DL 5,8,36,1024
 MV 96,104,64
 MV 100,104,68
 RW 42,18,34816
 MV 104,104,72
 MV 108,104,76
 RC 12,12,6144
 MV 112,104,80
 DL 6,8,36,2048
 MV 116,104,84
 RW 44,19,32768
 MV 120,104,88
 MV 124,104,92
 RW 46,19,34816
 MV 156,108,92
 MV 152,108,88
 RC 16,12,8192
 DL 7,8,36,3072
 MV 148,108,84
 MV 144,108,80
 RW 48,20,32768
 MV 140,108,76
 MV 136,108,72
 RW 50,20,34816
 MV 132,108,68
 s_add_u32 m0, m0, 0x1000
 MV 128,108,64
 RC 20,12,10240
 MV 160,112,64
 MV 164,112,68
 RW 52,21,32768
 MV 168,112,72
 MV 172,112,76
 RW 54,21,34816
 DL 4,8,41,0
 MV 176,112,80
 MV 180,112,84
 RC 24,12,12288
 MV 184,112,88
 MV 188,112,92
 RW 56,22,32768
 MV 220,116,92
 DL 5,8,41,1024
 MV 216,116,88
 RW 58,22,34816
 MV 212,116,84
 MV 208,116,80
 RC 28,12,14336
 MV 204,116,76
 MV 200,116,72
 RW 60,23,32768
 DL 6,8,41,2048
 MV 196,116,68
 MV 192,116,64
 RW 62,23,34816
 MV 224,120,64
 MV 228,120,68
 MV 232,120,72
 DL 7,8,41,3072
 MV 236,120,76
 MV 240,120,80
 MV 244,120,84
 MV 248,120,88
 MV 252,120,92
 s_add_u32 s36, s36, s38
 MA 156,124,92
 MA 152,124,88
 MA 148,124,84
 MA 144,124,80
 MA 140,124,76
 MA 136,124,72
 MA 132,124,68
 MA 128,124,64
 s_waitcnt vmcnt(18) lgkmcnt(0)
 s_barrier
 MV 32,32,0
 MV 36,32,4
 RC 64,13,0
 s_add_u32 m0, s27, 98304
 MV 40,32,8
 MV 44,32,12
 RW 96,16,49152
 MV 48,32,16
 MV 52,32,20
 RW 98,16,51200
 s_add_u32 s41, s36, s37
 MV 56,32,24
 MV 60,32,28
 RC 68,13,2048
 MV 92,36,28
 MV 88,36,24
 RW 100,17,49152
 MV 84,36,20
 DL 4,8,36,0
 MV 80,36,16
 RW 102,17,51200
 MV 76,36,12
 MV 72,36,8
 RC 72,13,4096
 MV 68,36,4
 MV 64,36,0
 RW 104,18,49152
 DL 5,8,36,1024
 MV 96,40,0
 MV 100,40,4
 RW 106,18,51200
 MV 104,40,8
 MV 108,40,12
 RC 76,13,6144
 MV 112,40,16
 DL 6,8,36,2048
 MV 116,40,20
 RW 108,19,49152
 MV 120,40,24
 MV 124,40,28
 RW 110,19,51200
 MV 156,44,28
 MV 152,44,24
 RC 80,13,8192
 DL 7,8,36,3072
 MV 148,44,20
 MV 144,44,16
 RW 112,20,49152
 MV 140,44,12
 MV 136,44,8
 RW 114,20,51200
 MV 132,44,4
 s_add_u32 m0, m0, 0x1000
 MV 128,44,0
 RC 84,13,10240
 MV 160,48,0
 MV 164,48,4
 RW 116,21,49152
 MV 168,48,8
 MV 172,48,12
 RW 118,21,51200
 DL 4,8,41,0
 MV 176,48,16
 MV 180,48,20
 RC 88,13,12288
 MV 184,48,24
 MV 188,48,28
 RW 120,22,49152
 MV 220,52,28
 DL 5,8,41,1024
 MV 216,52,24
 RW 122,22,51200
 MV 212,52,20
 MV 208,52,16
 RC 92,13,14336
 MV 204,52,12
 MV 200,52,8
 RW 124,23,49152
 DL 6,8,41,2048
 MV 196,52,4
 MV 192,52,0
 RW 126,23,51200
 MV 224,56,0
 MV 228,56,4
 MV 232,56,8
 DL 7,8,41,3072
 MV 236,56,12
 MV 240,56,16
 MV 244,56,20
 MV 248,56,24
 MV 252,56,28
 s_add_u32 s36, s36, s38
 MA 156,60,28
 MA 152,60,24
 MA 148,60,20
 MA 144,60,16
 MA 140,60,12
 MA 136,60,8
 MA 132,60,4
 MA 128,60,0
 s_waitcnt lgkmcnt(0)
 s_barrier
 v_mov_b32 v3, v2
 v_lshrrev_b32 v24, 3, v3
 v_lshrrev_b32 v25, 4, v3
 v_lshlrev_b32 v25, 1, v25
 v_and_b32 v26, 7, v3
 v_xor_b32 v25, v25, v26
 v_lshlrev_b32 v25, 4, v25
 v_lshl_add_u32 v15, v24, 13, v25
 v_mul_u32_u24 v26, 896, v24
 v_add_u32 v19, v26, v25
 v_add_u32 v16, 64512, v15
 v_add_u32 v20, 6144, v19
 v_add_u32 v17, 129024, v15
 v_add_u32 v21, 12288, v19
 v_add_u32 v18, 193536, v15
 v_add_u32 v22, 18432, v19
 v_and_b32 v24, 15, v3
 v_lshrrev_b32 v25, 4, v3
 v_lshlrev_b32 v26, 2, v25
 v_sub_u32 v29, v24, v26
 v_mov_b32 v31, v29
 v_and_b32 v26, 1, v25
 v_lshrrev_b32 v27, 2, v24
 v_lshl_add_u32 v27, v26, 2, v27
 v_lshlrev_b32 v27, 7, v27
 v_lshrrev_b32 v28, 1, v25
 v_lshl_add_u32 v27, v28, 10, v27
 v_and_b32 v28, 3, v24
 v_lshl_add_u32 v27, v28, 3, v27
 v_lshrrev_b32 v28, 3, v24
 v_lshl_add_u32 v28, v26, 1, v28
 v_xor_b32 v29, 0, v28
 v_lshl_add_u32 v7, v29, 5, v27
 v_xor_b32 v29, 1, v28
 v_lshl_add_u32 v8, v29, 5, v27
 v_xor_b32 v29, 2, v28
 v_lshl_add_u32 v9, v29, 5, v27
 v_xor_b32 v29, 3, v28
 v_lshl_add_u32 v10, v29, 5, v27
 v_mov_b32 v28, 0xff800000
 v_mov_b32 v11, v15
 v_mov_b32 v12, v16
 v_mov_b32 v13, v17
 v_mov_b32 v14, v18
 s_mov_b32 s24, 0x8000
 MV 32,96,64
 MV 36,96,68
 s_add_u32 s42, s59, 0
 MV 40,96,72
 MV 44,96,76
 MV 48,96,80
 MV 52,96,84
 MV 56,96,88
 buffer_load_dwordx4 a[0:3], v1, s[4:7], s42 offen offset:0
 MV 60,96,92
 MV 92,100,92
 MV 88,100,88
 MV 84,100,84
 MV 80,100,80
 MV 76,100,76
 buffer_load_dwordx4 a[4:7], v1, s[4:7], s42 offen offset:1024
 MV 72,100,72
 MV 68,100,68
 MV 64,100,64
 MV 96,104,64
 MV 100,104,68
 MV 104,104,72
 buffer_load_dwordx4 a[8:11], v1, s[4:7], s42 offen offset:2048
 MV 108,104,76
 MV 112,104,80
 MV 116,104,84
 MV 120,104,88
 MV 124,104,92
 MV 156,108,92
 buffer_load_dwordx4 a[12:15], v1, s[4:7], s42 offen offset:3072
 MV 152,108,88
 MV 148,108,84
 MV 144,108,80
 MV 140,108,76
 MV 136,108,72
 MV 132,108,68
 s_add_u32 s42, s59, 4096
 MV 128,108,64
 MV 160,112,64
 MV 164,112,68
 MV 168,112,72
 MV 172,112,76
 MV 176,112,80
 buffer_load_dwordx4 a[16:19], v1, s[4:7], s42 offen offset:0
 MV 180,112,84
 MV 184,112,88
 MV 188,112,92
 MV 220,116,92
 MV 216,116,88
 MV 212,116,84
 buffer_load_dwordx4 a[20:23], v1, s[4:7], s42 offen offset:1024
 MV 208,116,80
 MV 204,116,76
 MV 200,116,72
 MV 196,116,68
 MV 192,116,64
 MV 224,120,64
 buffer_load_dwordx4 a[24:27], v1, s[4:7], s42 offen offset:2048
 MV 228,120,68
 MV 232,120,72
 MV 236,120,76
 MV 240,120,80
 MV 244,120,84
 MV 248,120,88
 buffer_load_dwordx4 a[28:31], v1, s[4:7], s42 offen offset:3072
 MV 252,120,92
 MA 156,124,92
 MA 152,124,88
 MA 148,124,84
 MA 144,124,80
 MA 140,124,76
 MA 136,124,72
 MA 132,124,68
 MA 128,124,64
 s_nop 7
 v_cvt_pk_bf16_f32 v32, v32, v33
 v_cvt_pk_bf16_f32 v33, v34, v35
 v_cvt_pk_bf16_f32 v34, v64, v65
 v_cvt_pk_bf16_f32 v35, v66, v67
 s_add_u32 s76, s78, 0
 buffer_store_dwordx4 v[32:35], v1, s[4:7], s76 offen offset:0 sc1
 v_cvt_pk_bf16_f32 v36, v36, v37
 v_cvt_pk_bf16_f32 v37, v38, v39
 v_cvt_pk_bf16_f32 v38, v68, v69
 v_cvt_pk_bf16_f32 v39, v70, v71
 s_add_u32 s76, s78, 8192
 buffer_store_dwordx4 v[36:39], v1, s[4:7], s76 offen offset:0 sc1
 v_cvt_pk_bf16_f32 v40, v40, v41
 v_cvt_pk_bf16_f32 v41, v42, v43
 v_cvt_pk_bf16_f32 v42, v72, v73
 v_cvt_pk_bf16_f32 v43, v74, v75
 s_add_u32 s76, s78, 16384
 buffer_store_dwordx4 v[40:43], v1, s[4:7], s76 offen offset:0 sc1
 v_cvt_pk_bf16_f32 v44, v44, v45
 v_cvt_pk_bf16_f32 v45, v46, v47
 v_cvt_pk_bf16_f32 v46, v76, v77
 v_cvt_pk_bf16_f32 v47, v78, v79
 s_add_u32 s76, s78, 24576
 buffer_store_dwordx4 v[44:47], v1, s[4:7], s76 offen offset:0 sc1
 v_cvt_pk_bf16_f32 v48, v48, v49
 v_cvt_pk_bf16_f32 v49, v50, v51
 v_cvt_pk_bf16_f32 v50, v80, v81
 v_cvt_pk_bf16_f32 v51, v82, v83
 s_add_u32 s76, s78, 32768
 buffer_store_dwordx4 v[48:51], v1, s[4:7], s76 offen offset:0 sc1
 v_cvt_pk_bf16_f32 v52, v52, v53
 v_cvt_pk_bf16_f32 v53, v54, v55
 v_cvt_pk_bf16_f32 v54, v84, v85
 v_cvt_pk_bf16_f32 v55, v86, v87
 s_add_u32 s76, s78, 40960
 buffer_store_dwordx4 v[52:55], v1, s[4:7], s76 offen offset:0 sc1
 v_cvt_pk_bf16_f32 v56, v56, v57
 v_cvt_pk_bf16_f32 v57, v58, v59
 v_cvt_pk_bf16_f32 v58, v88, v89
 v_cvt_pk_bf16_f32 v59, v90, v91
 s_add_u32 s76, s78, 49152
 buffer_store_dwordx4 v[56:59], v1, s[4:7], s76 offen offset:0 sc1
 v_cvt_pk_bf16_f32 v60, v60, v61
 v_cvt_pk_bf16_f32 v61, v62, v63
 v_cvt_pk_bf16_f32 v62, v92, v93
 v_cvt_pk_bf16_f32 v63, v94, v95
 s_add_u32 s76, s78, 57344
 buffer_store_dwordx4 v[60:63], v1, s[4:7], s76 offen offset:0 sc1
 v_cvt_pk_bf16_f32 v96, v96, v97
 v_cvt_pk_bf16_f32 v97, v98, v99
 v_cvt_pk_bf16_f32 v98, v128, v129
 v_cvt_pk_bf16_f32 v99, v130, v131
 s_add_u32 s76, s78, 0
 buffer_store_dwordx4 v[96:99], v1, s[4:7], s76 offen offset:1024 sc1
 v_cvt_pk_bf16_f32 v100, v100, v101
 v_cvt_pk_bf16_f32 v101, v102, v103
 v_cvt_pk_bf16_f32 v102, v132, v133
 v_cvt_pk_bf16_f32 v103, v134, v135
 s_add_u32 s76, s78, 8192
 buffer_store_dwordx4 v[100:103], v1, s[4:7], s76 offen offset:1024 sc1
 v_cvt_pk_bf16_f32 v104, v104, v105
 v_cvt_pk_bf16_f32 v105, v106, v107
 v_cvt_pk_bf16_f32 v106, v136, v137
 v_cvt_pk_bf16_f32 v107, v138, v139
 s_add_u32 s76, s78, 16384
 buffer_store_dwordx4 v[104:107], v1, s[4:7], s76 offen offset:1024 sc1
 v_cvt_pk_bf16_f32 v108, v108, v109
 v_cvt_pk_bf16_f32 v109, v110, v111
 v_cvt_pk_bf16_f32 v110, v140, v141
 v_cvt_pk_bf16_f32 v111, v142, v143
 s_add_u32 s76, s78, 24576
 buffer_store_dwordx4 v[108:111], v1, s[4:7], s76 offen offset:1024 sc1
 v_cvt_pk_bf16_f32 v112, v112, v113
 v_cvt_pk_bf16_f32 v113, v114, v115
 v_cvt_pk_bf16_f32 v114, v144, v145
 v_cvt_pk_bf16_f32 v115, v146, v147
 s_add_u32 s76, s78, 32768
 buffer_store_dwordx4 v[112:115], v1, s[4:7], s76 offen offset:1024 sc1
 v_cvt_pk_bf16_f32 v116, v116, v117
 v_cvt_pk_bf16_f32 v117, v118, v119
 v_cvt_pk_bf16_f32 v118, v148, v149
 v_cvt_pk_bf16_f32 v119, v150, v151
 s_add_u32 s76, s78, 40960
 buffer_store_dwordx4 v[116:119], v1, s[4:7], s76 offen offset:1024 sc1
 v_cvt_pk_bf16_f32 v120, v120, v121
 v_cvt_pk_bf16_f32 v121, v122, v123
 v_cvt_pk_bf16_f32 v122, v152, v153
 v_cvt_pk_bf16_f32 v123, v154, v155
 s_add_u32 s76, s78, 49152
 buffer_store_dwordx4 v[120:123], v1, s[4:7], s76 offen offset:1024 sc1
 v_cvt_pk_bf16_f32 v124, v124, v125
 v_cvt_pk_bf16_f32 v125, v126, v127
 v_cvt_pk_bf16_f32 v126, v156, v157
 v_cvt_pk_bf16_f32 v127, v158, v159
 s_add_u32 s76, s78, 57344
 buffer_store_dwordx4 v[124:127], v1, s[4:7], s76 offen offset:1024 sc1
 v_cvt_pk_bf16_f32 v160, v160, v161
 v_cvt_pk_bf16_f32 v161, v162, v163
 v_cvt_pk_bf16_f32 v162, v192, v193
 v_cvt_pk_bf16_f32 v163, v194, v195
 s_add_u32 s76, s78, 0
 buffer_store_dwordx4 v[160:163], v1, s[4:7], s76 offen offset:2048 sc1
 v_cvt_pk_bf16_f32 v164, v164, v165
 v_cvt_pk_bf16_f32 v165, v166, v167
 v_cvt_pk_bf16_f32 v166, v196, v197
 v_cvt_pk_bf16_f32 v167, v198, v199
 s_add_u32 s76, s78, 8192
 buffer_store_dwordx4 v[164:167], v1, s[4:7], s76 offen offset:2048 sc1
 v_cvt_pk_bf16_f32 v168, v168, v169
 v_cvt_pk_bf16_f32 v169, v170, v171
 v_cvt_pk_bf16_f32 v170, v200, v201
 v_cvt_pk_bf16_f32 v171, v202, v203
 s_add_u32 s76, s78, 16384
 buffer_store_dwordx4 v[168:171], v1, s[4:7], s76 offen offset:2048 sc1
 v_cvt_pk_bf16_f32 v172, v172, v173
 v_cvt_pk_bf16_f32 v173, v174, v175
 v_cvt_pk_bf16_f32 v174, v204, v205
 v_cvt_pk_bf16_f32 v175, v206, v207
 s_add_u32 s76, s78, 24576
 buffer_store_dwordx4 v[172:175], v1, s[4:7], s76 offen offset:2048 sc1
 v_cvt_pk_bf16_f32 v176, v176, v177
 v_cvt_pk_bf16_f32 v177, v178, v179
 v_cvt_pk_bf16_f32 v178, v208, v209
 v_cvt_pk_bf16_f32 v179, v210, v211
 s_add_u32 s76, s78, 32768
 buffer_store_dwordx4 v[176:179], v1, s[4:7], s76 offen offset:2048 sc1
 v_cvt_pk_bf16_f32 v180, v180, v181
 v_cvt_pk_bf16_f32 v181, v182, v183
 v_cvt_pk_bf16_f32 v182, v212, v213
 v_cvt_pk_bf16_f32 v183, v214, v215
 s_add_u32 s76, s78, 40960
 buffer_store_dwordx4 v[180:183], v1, s[4:7], s76 offen offset:2048 sc1
 v_cvt_pk_bf16_f32 v184, v184, v185
 v_cvt_pk_bf16_f32 v185, v186, v187
 v_cvt_pk_bf16_f32 v186, v216, v217
 v_cvt_pk_bf16_f32 v187, v218, v219
 s_add_u32 s76, s78, 49152
 buffer_store_dwordx4 v[184:187], v1, s[4:7], s76 offen offset:2048 sc1
 v_cvt_pk_bf16_f32 v188, v188, v189
 v_cvt_pk_bf16_f32 v189, v190, v191
 v_cvt_pk_bf16_f32 v190, v220, v221
 v_cvt_pk_bf16_f32 v191, v222, v223
 s_add_u32 s76, s78, 57344
 buffer_store_dwordx4 v[188:191], v1, s[4:7], s76 offen offset:2048 sc1
 v_cvt_pk_bf16_f32 v224, v224, v225
 v_cvt_pk_bf16_f32 v225, v226, v227
 v_accvgpr_read_b32 v26, a128
 v_accvgpr_read_b32 v27, a129
 v_cvt_pk_bf16_f32 v226, v26, v27
 v_accvgpr_read_b32 v26, a130
 v_accvgpr_read_b32 v27, a131
 v_cvt_pk_bf16_f32 v227, v26, v27
 s_add_u32 s76, s78, 0
 buffer_store_dwordx4 v[224:227], v1, s[4:7], s76 offen offset:3072 sc1
 v_cvt_pk_bf16_f32 v228, v228, v229
 v_cvt_pk_bf16_f32 v229, v230, v231
 v_accvgpr_read_b32 v26, a132
 v_accvgpr_read_b32 v27, a133
 v_cvt_pk_bf16_f32 v230, v26, v27
 v_accvgpr_read_b32 v26, a134
 v_accvgpr_read_b32 v27, a135
 v_cvt_pk_bf16_f32 v231, v26, v27
 s_add_u32 s76, s78, 8192
 buffer_store_dwordx4 v[228:231], v1, s[4:7], s76 offen offset:3072 sc1
 v_cvt_pk_bf16_f32 v232, v232, v233
 v_cvt_pk_bf16_f32 v233, v234, v235
 v_accvgpr_read_b32 v26, a136
 v_accvgpr_read_b32 v27, a137
 v_cvt_pk_bf16_f32 v234, v26, v27
 v_accvgpr_read_b32 v26, a138
 v_accvgpr_read_b32 v27, a139
 v_cvt_pk_bf16_f32 v235, v26, v27
 s_add_u32 s76, s78, 16384
 buffer_store_dwordx4 v[232:235], v1, s[4:7], s76 offen offset:3072 sc1
 v_cvt_pk_bf16_f32 v236, v236, v237
 v_cvt_pk_bf16_f32 v237, v238, v239
 v_accvgpr_read_b32 v26, a140
 v_accvgpr_read_b32 v27, a141
 v_cvt_pk_bf16_f32 v238, v26, v27
 v_accvgpr_read_b32 v26, a142
 v_accvgpr_read_b32 v27, a143
 v_cvt_pk_bf16_f32 v239, v26, v27
 s_add_u32 s76, s78, 24576
 buffer_store_dwordx4 v[236:239], v1, s[4:7], s76 offen offset:3072 sc1
 v_cvt_pk_bf16_f32 v240, v240, v241
 v_cvt_pk_bf16_f32 v241, v242, v243
 v_accvgpr_read_b32 v26, a144
 v_accvgpr_read_b32 v27, a145
 v_cvt_pk_bf16_f32 v242, v26, v27
 v_accvgpr_read_b32 v26, a146
 v_accvgpr_read_b32 v27, a147
 v_cvt_pk_bf16_f32 v243, v26, v27
 s_add_u32 s76, s78, 32768
 buffer_store_dwordx4 v[240:243], v1, s[4:7], s76 offen offset:3072 sc1
 v_cvt_pk_bf16_f32 v244, v244, v245
 v_cvt_pk_bf16_f32 v245, v246, v247
 v_accvgpr_read_b32 v26, a148
 v_accvgpr_read_b32 v27, a149
 v_cvt_pk_bf16_f32 v246, v26, v27
 v_accvgpr_read_b32 v26, a150
 v_accvgpr_read_b32 v27, a151
 v_cvt_pk_bf16_f32 v247, v26, v27
 s_add_u32 s76, s78, 40960
 buffer_store_dwordx4 v[244:247], v1, s[4:7], s76 offen offset:3072 sc1
 v_cvt_pk_bf16_f32 v248, v248, v249
 v_cvt_pk_bf16_f32 v249, v250, v251
 v_accvgpr_read_b32 v26, a152
 v_accvgpr_read_b32 v27, a153
 v_cvt_pk_bf16_f32 v250, v26, v27
 v_accvgpr_read_b32 v26, a154
 v_accvgpr_read_b32 v27, a155
 v_cvt_pk_bf16_f32 v251, v26, v27
 s_add_u32 s76, s78, 49152
 buffer_store_dwordx4 v[248:251], v1, s[4:7], s76 offen offset:3072 sc1
 v_cvt_pk_bf16_f32 v252, v252, v253
 v_cvt_pk_bf16_f32 v253, v254, v255
 v_accvgpr_read_b32 v26, a156
 v_accvgpr_read_b32 v27, a157
 v_cvt_pk_bf16_f32 v254, v26, v27
 v_accvgpr_read_b32 v26, a158
 v_accvgpr_read_b32 v27, a159
 v_cvt_pk_bf16_f32 v255, v26, v27
 s_add_u32 s76, s78, 57344
 buffer_store_dwordx4 v[252:255], v1, s[4:7], s76 offen offset:3072 sc1
 s_branch mk_p1done
mk_vloop:
 MVZ 32,0,32
 MVZ 36,4,32
 RC 64,13,0
 MVZ 40,8,32
 s_add_u32 m0, s75, 0
 s_add_u32 s77, s87, 1048576
 s_and_b32 s77, s77, 0x7fffff
 s_add_u32 s77, s77, s73
 MVZ 44,12,32
 RW 96,16,16384
 MVZ 48,16,32
 DL 8,64,77,0
 MVZ 52,20,32
 RW 98,16,18432
 MVZ 56,24,32
 MVZ 60,28,32
 RC 68,13,2048
 MVZ 92,28,36
 MVZ 88,24,36
 RW 100,17,16384
 MVZ 84,20,36
 DL 9,64,77,1024
 MVZ 80,16,36
 RW 102,17,18432
 MVZ 76,12,36
 MVZ 72,8,36
 RC 72,13,4096
 MVZ 68,4,36
 MVZ 64,0,36
 RW 104,18,16384
 MVZ 96,0,40
 DL 10,64,77,2048
 MVZ 100,4,40
 RW 106,18,18432
 MVZ 104,8,40
 MVZ 108,12,40
 RC 76,13,6144
 MVZ 112,16,40
 MVZ 116,20,40
 RW 108,19,16384
 MVZ 120,24,40
 DL 11,64,77,3072
 MVZ 124,28,40
 RW 110,19,18432
 MVZ 156,28,44
 MVZ 152,24,44
 RC 80,13,8192
 MVZ 148,20,44
 MVZ 144,16,44
 RW 112,20,16384
 MVZ 140,12,44
 s_add_u32 m0, s74, 69632
 s_add_u32 s76, s86, 256
 s_and_b32 s76, s76, 2047
 s_add_u32 s76, s76, s72
 s_add_u32 s76, s76, 65536
 MVZ 136,8,44
 RW 114,20,18432
 MVZ 132,4,44
 DL 4,60,76,0
 MVZ 128,0,44
 RC 84,13,10240
 MVZ 160,0,48
 MVZ 164,4,48
 RW 116,21,16384
 MVZ 168,8,48
 MVZ 172,12,48
 RW 118,21,18432
 MVZ 176,16,48
 DL 5,60,76,1024
 MVZ 180,20,48
 RC 88,13,12288
 MVZ 184,24,48
 MVZ 188,28,48
 RW 120,22,16384
 MVZ 220,28,52
 MVZ 216,24,52
 RW 122,22,18432
 MVZ 212,20,52
 DL 6,60,76,2048
 MVZ 208,16,52
 RC 92,13,14336
 MVZ 204,12,52
 MVZ 200,8,52
 RW 124,23,16384
 MVZ 196,4,52
 MVZ 192,0,52
 RW 126,23,18432
 MVZ 224,0,56
 DL 7,60,76,3072
 MVZ 228,4,56
 MVZ 232,8,56
 MVZ 236,12,56
 MVZ 240,16,56
 MVZ 244,20,56
 MVZ 248,24,56
 MVZ 252,28,56
 MAZ 156,28,60
 MAZ 152,24,60
 MAZ 148,20,60
 MAZ 144,16,60
 MAZ 140,12,60
 MAZ 136,8,60
 MAZ 132,4,60
 MAZ 128,0,60
 s_waitcnt vmcnt(18) lgkmcnt(0)
 s_barrier
 MV 32,64,96
 MV 36,68,96
 RC 0,12,32768
 MV 40,72,96
 s_add_u32 m0, s75, 16384
 s_add_u32 s77, s87, 1310720
 s_and_b32 s77, s77, 0x7fffff
 s_add_u32 s77, s77, s73
 MV 44,76,96
 RW 32,16,32768
 MV 48,80,96
 DL 8,64,77,0
 MV 52,84,96
 RW 34,16,34816
 MV 56,88,96
 MV 60,92,96
 RC 4,12,34816
 MV 92,92,100
 MV 88,88,100
 RW 36,17,32768
 MV 84,84,100
 DL 9,64,77,1024
 MV 80,80,100
 RW 38,17,34816
 MV 76,76,100
 MV 72,72,100
 RC 8,12,36864
 MV 68,68,100
 MV 64,64,100
 RW 40,18,32768
 MV 96,64,104
 DL 10,64,77,2048
 MV 100,68,104
 RW 42,18,34816
 MV 104,72,104
 MV 108,76,104
 RC 12,12,38912
 MV 112,80,104
 MV 116,84,104
 RW 44,19,32768
 MV 120,88,104
 DL 11,64,77,3072
 MV 124,92,104
 RW 46,19,34816
 MV 156,92,108
 MV 152,88,108
 RC 16,12,40960
 MV 148,84,108
 MV 144,80,108
 RW 48,20,32768
 MV 140,76,108
 s_add_u32 m0, s74, 0
 s_add_u32 s76, s86, 384
 s_and_b32 s76, s76, 2047
 s_add_u32 s76, s76, s72
 MV 136,72,108
 RW 50,20,34816
 MV 132,68,108
 DL 4,60,76,0
 MV 128,64,108
 RC 20,12,43008
 MV 160,64,112
 MV 164,68,112
 RW 52,21,32768
 MV 168,72,112
 MV 172,76,112
 RW 54,21,34816
 MV 176,80,112
 DL 5,60,76,1024
 MV 180,84,112
 RC 24,12,45056
 MV 184,88,112
 MV 188,92,112
 RW 56,22,32768
 MV 220,92,116
 MV 216,88,116
 RW 58,22,34816
 MV 212,84,116
 DL 6,60,76,2048
 MV 208,80,116
 RC 28,12,47104
 MV 204,76,116
 MV 200,72,116
 RW 60,23,32768
 MV 196,68,116
 MV 192,64,116
 RW 62,23,34816
 MV 224,64,120
 DL 7,60,76,3072
 MV 228,68,120
 MV 232,72,120
 MV 236,76,120
 MV 240,80,120
 MV 244,84,120
 MV 248,88,120
 MV 252,92,120
 MA 156,92,124
 MA 152,88,124
 MA 148,84,124
 MA 144,80,124
 MA 140,76,124
 MA 136,72,124
 MA 132,68,124
 MA 128,64,124
 s_waitcnt vmcnt(22) lgkmcnt(0)
 s_barrier
 MV 32,0,32
 MV 36,4,32
 RC 64,13,32768
 MV 40,8,32
 s_add_u32 m0, s75, 32768
 s_add_u32 s77, s87, 1572864
 s_and_b32 s77, s77, 0x7fffff
 s_add_u32 s77, s77, s73
 MV 44,12,32
 RW 96,16,49152
 MV 48,16,32
 DL 8,64,77,0
 MV 52,20,32
 RW 98,16,51200
 MV 56,24,32
 MV 60,28,32
 RC 68,13,34816
 MV 92,28,36
 MV 88,24,36
 RW 100,17,49152
 MV 84,20,36
 DL 9,64,77,1024
 MV 80,16,36
 RW 102,17,51200
 MV 76,12,36
 MV 72,8,36
 RC 72,13,36864
 MV 68,4,36
 MV 64,0,36
 RW 104,18,49152
 MV 96,0,40
 DL 10,64,77,2048
 MV 100,4,40
 RW 106,18,51200
 MV 104,8,40
 MV 108,12,40
 RC 76,13,38912
 MV 112,16,40
 MV 116,20,40
 RW 108,19,49152
 MV 120,24,40
 DL 11,64,77,3072
 MV 124,28,40
 RW 110,19,51200
 MV 156,28,44
 MV 152,24,44
 RC 80,13,40960
 MV 148,20,44
 MV 144,16,44
 RW 112,20,49152
 MV 140,12,44
 s_add_u32 m0, s74, 4096
 s_add_u32 s76, s86, 384
 s_and_b32 s76, s76, 2047
 s_add_u32 s76, s76, s72
 s_add_u32 s76, s76, 65536
 MV 136,8,44
 RW 114,20,51200
 MV 132,4,44
 DL 4,60,76,0
 MV 128,0,44
 RC 84,13,43008
 MV 160,0,48
 MV 164,4,48
 RW 116,21,49152
 MV 168,8,48
 MV 172,12,48
 RW 118,21,51200
 MV 176,16,48
 DL 5,60,76,1024
 MV 180,20,48
 RC 88,13,45056
 MV 184,24,48
 MV 188,28,48
 RW 120,22,49152
 MV 220,28,52
 MV 216,24,52
 RW 122,22,51200
 MV 212,20,52
 DL 6,60,76,2048
 MV 208,16,52
 RC 92,13,47104
 MV 204,12,52
 MV 200,8,52
 RW 124,23,49152
 MV 196,4,52
 MV 192,0,52
 RW 126,23,51200
 MV 224,0,56
 DL 7,60,76,3072
 MV 228,4,56
 MV 232,8,56
 MV 236,12,56
 MV 240,16,56
 MV 244,20,56
 MV 248,24,56
 MV 252,28,56
 MA 156,28,60
 MA 152,24,60
 MA 148,20,60
 MA 144,16,60
 MA 140,12,60
 MA 136,8,60
 MA 132,4,60
 MA 128,0,60
 s_waitcnt vmcnt(16) lgkmcnt(0)
 s_barrier
 s_lshr_b32 s41, s3, 4
 s_cmp_eq_u32 s20, 0
 s_cbranch_scc0 mk_sg_11
 s_lshl_b32 s44, s41, 2
 v_mov_b32 v29, s44
 v_mov_b32 v30, 1
 s_mov_b64 exec, 1
 global_atomic_add v29, v30, s[16:17] sc1
 s_mov_b64 exec, -1
mk_sg_11:
 MV 32,64,96
 MV 36,68,96
 RC 0,14,0
 MV 40,72,96
 s_add_u32 m0, s75, 49152
 s_add_u32 s77, s87, 1835008
 s_and_b32 s77, s77, 0x7fffff
 s_add_u32 s77, s77, s73
 MV 44,76,96
 RW 32,16,0
 MV 48,80,96
 DL 8,64,77,0
 MV 52,84,96
 RW 34,16,2048
 MV 56,88,96
 MV 60,92,96
 RC 4,14,2048
 MV 92,92,100
 MV 88,88,100
 RW 36,17,0
 MV 84,84,100
 DL 9,64,77,1024
 MV 80,80,100
 RW 38,17,2048
 MV 76,76,100
 MV 72,72,100
 RC 8,14,4096
 MV 68,68,100
 MV 64,64,100
 RW 40,18,0
 MV 96,64,104
 DL 10,64,77,2048
 MV 100,68,104
 RW 42,18,2048
 MV 104,72,104
 MV 108,76,104
 RC 12,14,6144
 MV 112,80,104
 MV 116,84,104
 RW 44,19,0
 MV 120,88,104
 DL 11,64,77,3072
 MV 124,92,104
 RW 46,19,2048
 MV 156,92,108
 MV 152,88,108
 RC 16,14,8192
 MV 148,84,108
 MV 144,80,108
 RW 48,20,0
 MV 140,76,108
 s_add_u32 m0, s74, 32768
 s_add_u32 s76, s86, 512
 s_and_b32 s76, s76, 2047
 s_add_u32 s76, s76, s72
 MV 136,72,108
 RW 50,20,2048
 MV 132,68,108
 DL 4,60,76,0
 MV 128,64,108
 RC 20,14,10240
 MV 160,64,112
 MV 164,68,112
 RW 52,21,0
 MV 168,72,112
 MV 172,76,112
 RW 54,21,2048
 MV 176,80,112
 DL 5,60,76,1024
 MV 180,84,112
 RC 24,14,12288
 MV 184,88,112
 MV 188,92,112
 RW 56,22,0
 MV 220,92,116
 MV 216,88,116
 RW 58,22,2048
 MV 212,84,116
 DL 6,60,76,2048
 MV 208,80,116
 RC 28,14,14336
 MV 204,76,116
 MV 200,72,116
 RW 60,23,0
 MV 196,68,116
 MV 192,64,116
 RW 62,23,2048
 MV 224,64,120
 DL 7,60,76,3072
 MV 228,68,120
 MV 232,72,120
 MV 236,76,120
 MV 240,80,120
 MV 244,84,120
 MV 248,88,120
 MV 252,92,120
 MA 156,92,124
 MA 152,88,124
 MA 148,84,124
 MA 144,80,124
 MA 140,76,124
 MA 136,72,124
 MA 132,68,124
 MA 128,64,124
 s_waitcnt vmcnt(20) lgkmcnt(0)
 s_barrier
 MV 32,0,32
 MV 36,4,32
 RC 64,15,0
 MV 40,8,32
 s_add_u32 m0, s75, 0
 s_add_u32 s77, s87, 2097152
 s_and_b32 s77, s77, 0x7fffff
 s_add_u32 s77, s77, s73
 MV 44,12,32
 RW 96,16,16384
 MV 48,16,32
 DL 8,64,77,0
 MV 52,20,32
 RW 98,16,18432
 MV 56,24,32
 MV 60,28,32
 RC 68,15,2048
 MV 92,28,36
 MV 88,24,36
 RW 100,17,16384
 MV 84,20,36
 DL 9,64,77,1024
 MV 80,16,36
 RW 102,17,18432
 MV 76,12,36
 MV 72,8,36
 RC 72,15,4096
 MV 68,4,36
 MV 64,0,36
 RW 104,18,16384
 MV 96,0,40
 DL 10,64,77,2048
 MV 100,4,40
 RW 106,18,18432
 MV 104,8,40
 MV 108,12,40
 RC 76,15,6144
 MV 112,16,40
 MV 116,20,40
 RW 108,19,16384
 MV 120,24,40
 DL 11,64,77,3072
 MV 124,28,40
 RW 110,19,18432
 MV 156,28,44
 MV 152,24,44
 RC 80,15,8192
 MV 148,20,44
 MV 144,16,44
 RW 112,20,16384
 MV 140,12,44
 s_add_u32 m0, s74, 36864
 s_add_u32 s76, s86, 512
 s_and_b32 s76, s76, 2047
 s_add_u32 s76, s76, s72
 s_add_u32 s76, s76, 65536
 MV 136,8,44
 RW 114,20,18432
 MV 132,4,44
 DL 4,60,76,0
 MV 128,0,44
 RC 84,15,10240
 MV 160,0,48
 MV 164,4,48
 RW 116,21,16384
 MV 168,8,48
 MV 172,12,48
 RW 118,21,18432
 MV 176,16,48
 DL 5,60,76,1024
 MV 180,20,48
 RC 88,15,12288
 MV 184,24,48
 MV 188,28,48
 RW 120,22,16384
 MV 220,28,52
 MV 216,24,52
 RW 122,22,18432
 MV 212,20,52
 DL 6,60,76,2048
 MV 208,16,52
 RC 92,15,14336
 MV 204,12,52
 MV 200,8,52
 RW 124,23,16384
 MV 196,4,52
 MV 192,0,52
 RW 126,23,18432
 MV 224,0,56
 DL 7,60,76,3072
 MV 228,4,56
 MV 232,8,56
 MV 236,12,56
 MV 240,16,56
 MV 244,20,56
 MV 248,24,56
 MV 252,28,56
 MA 156,28,60
 MA 152,24,60
 MA 148,20,60
 MA 144,16,60
 MA 140,12,60
 MA 136,8,60
 MA 132,4,60
 MA 128,0,60
 s_waitcnt vmcnt(16) lgkmcnt(0)
 s_barrier
 MV 32,64,96
 MV 36,68,96
 RC 0,12,0
 MV 40,72,96
 s_add_u32 m0, s75, 16384
 s_add_u32 s77, s87, 2359296
 s_and_b32 s77, s77, 0x7fffff
 s_add_u32 s77, s77, s73
 MV 44,76,96
 RW 32,16,32768
 MV 48,80,96
 DL 8,64,77,0
 MV 52,84,96
 RW 34,16,34816
 MV 56,88,96
 MV 60,92,96
 RC 4,12,2048
 MV 92,92,100
 MV 88,88,100
 RW 36,17,32768
 MV 84,84,100
 DL 9,64,77,1024
 MV 80,80,100
 RW 38,17,34816
 MV 76,76,100
 MV 72,72,100
 RC 8,12,4096
 MV 68,68,100
 MV 64,64,100
 RW 40,18,32768
 MV 96,64,104
 DL 10,64,77,2048
 MV 100,68,104
 RW 42,18,34816
 MV 104,72,104
 MV 108,76,104
 RC 12,12,6144
 MV 112,80,104
 MV 116,84,104
 RW 44,19,32768
 MV 120,88,104
 DL 11,64,77,3072
 MV 124,92,104
 RW 46,19,34816
 MV 156,92,108
 MV 152,88,108
 RC 16,12,8192
 MV 148,84,108
 MV 144,80,108
 RW 48,20,32768
 MV 140,76,108
 s_add_u32 m0, s74, 65536
 s_add_u32 s76, s86, 640
 s_and_b32 s76, s76, 2047
 s_add_u32 s76, s76, s72
 MV 136,72,108
 RW 50,20,34816
 MV 132,68,108
 DL 4,60,76,0
 MV 128,64,108
 RC 20,12,10240
 MV 160,64,112
 MV 164,68,112
 RW 52,21,32768
 MV 168,72,112
 MV 172,76,112
 RW 54,21,34816
 MV 176,80,112
 DL 5,60,76,1024
 MV 180,84,112
 RC 24,12,12288
 MV 184,88,112
 MV 188,92,112
 RW 56,22,32768
 MV 220,92,116
 MV 216,88,116
 RW 58,22,34816
 MV 212,84,116
 DL 6,60,76,2048
 MV 208,80,116
 RC 28,12,14336
 MV 204,76,116
 MV 200,72,116
 RW 60,23,32768
 MV 196,68,116
 MV 192,64,116
 RW 62,23,34816
 MV 224,64,120
 DL 7,60,76,3072
 MV 228,68,120
 MV 232,72,120
 MV 236,76,120
 MV 240,80,120
 MV 244,84,120
 MV 248,88,120
 MV 252,92,120
 MA 156,92,124
 MA 152,88,124
 MA 148,84,124
 MA 144,80,124
 MA 140,76,124
 MA 136,72,124
 MA 132,68,124
 MA 128,64,124
 s_waitcnt vmcnt(20) lgkmcnt(0)
 s_barrier
 MV 32,0,32
 MV 36,4,32
 RC 64,13,0
 MV 40,8,32
 s_add_u32 m0, s75, 32768
 s_add_u32 s77, s87, 2621440
 s_and_b32 s77, s77, 0x7fffff
 s_add_u32 s77, s77, s73
 MV 44,12,32
 RW 96,16,49152
 MV 48,16,32
 DL 8,64,77,0
 MV 52,20,32
 RW 98,16,51200
 MV 56,24,32
 MV 60,28,32
 RC 68,13,2048
 MV 92,28,36
 MV 88,24,36
 RW 100,17,49152
 MV 84,20,36
 DL 9,64,77,1024
 MV 80,16,36
 RW 102,17,51200
 MV 76,12,36
 MV 72,8,36
 RC 72,13,4096
 MV 68,4,36
 MV 64,0,36
 RW 104,18,49152
 MV 96,0,40
 DL 10,64,77,2048
 MV 100,4,40
 RW 106,18,51200
 MV 104,8,40
 MV 108,12,40
 RC 76,13,6144
 MV 112,16,40
 MV 116,20,40
 RW 108,19,49152
 MV 120,24,40
 DL 11,64,77,3072
 MV 124,28,40
 RW 110,19,51200
 MV 156,28,44
 MV 152,24,44
 RC 80,13,8192
 MV 148,20,44
 MV 144,16,44
 RW 112,20,49152
 MV 140,12,44
 s_add_u32 m0, s74, 69632
 s_add_u32 s76, s86, 640
 s_and_b32 s76, s76, 2047
 s_add_u32 s76, s76, s72
 s_add_u32 s76, s76, 65536
 MV 136,8,44
 RW 114,20,51200
 MV 132,4,44
 DL 4,60,76,0
 MV 128,0,44
 RC 84,13,10240
 MV 160,0,48
 MV 164,4,48
 RW 116,21,49152
 MV 168,8,48
 MV 172,12,48
 RW 118,21,51200
 MV 176,16,48
 DL 5,60,76,1024
 MV 180,20,48
 RC 88,13,12288
 MV 184,24,48
 MV 188,28,48
 RW 120,22,49152
 MV 220,28,52
 MV 216,24,52
 RW 122,22,51200
 MV 212,20,52
 DL 6,60,76,2048
 MV 208,16,52
 RC 92,13,14336
 MV 204,12,52
 MV 200,8,52
 RW 124,23,49152
 MV 196,4,52
 MV 192,0,52
 RW 126,23,51200
 MV 224,0,56
 DL 7,60,76,3072
 MV 228,4,56
 MV 232,8,56
 MV 236,12,56
 MV 240,16,56
 MV 244,20,56
 MV 248,24,56
 MV 252,28,56
 MA 156,28,60
 MA 152,24,60
 MA 148,20,60
 MA 144,16,60
 MA 140,12,60
 MA 136,8,60
 MA 132,4,60
 MA 128,0,60
 s_waitcnt vmcnt(16) lgkmcnt(0)
 s_barrier
 MV 32,64,96
 MV 36,68,96
 RC 0,12,32768
 MV 40,72,96
 s_add_u32 m0, s75, 49152
 s_add_u32 s77, s87, 2883584
 s_and_b32 s77, s77, 0x7fffff
 s_add_u32 s77, s77, s73
 MV 44,76,96
 RW 32,16,0
 MV 48,80,96
 DL 8,64,77,0
 MV 52,84,96
 RW 34,16,2048
 MV 56,88,96
 MV 60,92,96
 RC 4,12,34816
 MV 92,92,100
 MV 88,88,100
 RW 36,17,0
 MV 84,84,100
 DL 9,64,77,1024
 MV 80,80,100
 RW 38,17,2048
 MV 76,76,100
 MV 72,72,100
 RC 8,12,36864
 MV 68,68,100
 MV 64,64,100
 RW 40,18,0
 MV 96,64,104
 DL 10,64,77,2048
 MV 100,68,104
 RW 42,18,2048
 MV 104,72,104
 MV 108,76,104
 RC 12,12,38912
 MV 112,80,104
 MV 116,84,104
 RW 44,19,0
 MV 120,88,104
 DL 11,64,77,3072
 MV 124,92,104
 RW 46,19,2048
 MV 156,92,108
 MV 152,88,108
 RC 16,12,40960
 MV 148,84,108
 MV 144,80,108
 RW 48,20,0
 MV 140,76,108
 s_add_u32 m0, s74, 0
 s_add_u32 s76, s86, 768
 s_and_b32 s76, s76, 2047
 s_add_u32 s76, s76, s72
 MV 136,72,108
 RW 50,20,2048
 MV 132,68,108
 DL 4,60,76,0
 MV 128,64,108
 RC 20,12,43008
 MV 160,64,112
 MV 164,68,112
 RW 52,21,0
 MV 168,72,112
 MV 172,76,112
 RW 54,21,2048
 MV 176,80,112
 DL 5,60,76,1024
 MV 180,84,112
 RC 24,12,45056
 MV 184,88,112
 MV 188,92,112
 RW 56,22,0
 MV 220,92,116
 MV 216,88,116
 RW 58,22,2048
 MV 212,84,116
 DL 6,60,76,2048
 MV 208,80,116
 RC 28,12,47104
 MV 204,76,116
 MV 200,72,116
 RW 60,23,0
 MV 196,68,116
 MV 192,64,116
 RW 62,23,2048
 MV 224,64,120
 DL 7,60,76,3072
 MV 228,68,120
 MV 232,72,120
 MV 236,76,120
 MV 240,80,120
 MV 244,84,120
 MV 248,88,120
 MV 252,92,120
 MA 156,92,124
 MA 152,88,124
 MA 148,84,124
 MA 144,80,124
 MA 140,76,124
 MA 136,72,124
 MA 132,68,124
 MA 128,64,124
 s_waitcnt vmcnt(20) lgkmcnt(0)
 s_barrier
 s_cmp_eq_u32 s20, 0
 s_cbranch_scc0 mk_pl_12
 v_and_b32 v29, 31, v2
 v_lshlrev_b32 v29, 2, v29
 global_load_dword v30, v29, s[16:17] sc1
mk_pl_12:
 MV 32,0,32
 MV 36,4,32
 RC 64,13,32768
 MV 40,8,32
 s_add_u32 m0, s75, 0
 s_add_u32 s77, s87, 3145728
 s_and_b32 s77, s77, 0x7fffff
 s_add_u32 s77, s77, s73
 MV 44,12,32
 RW 96,16,16384
 MV 48,16,32
 DL 8,64,77,0
 MV 52,20,32
 RW 98,16,18432
 MV 56,24,32
 MV 60,28,32
 RC 68,13,34816
 MV 92,28,36
 MV 88,24,36
 RW 100,17,16384
 MV 84,20,36
 DL 9,64,77,1024
 MV 80,16,36
 RW 102,17,18432
 MV 76,12,36
 MV 72,8,36
 RC 72,13,36864
 MV 68,4,36
 MV 64,0,36
 RW 104,18,16384
 MV 96,0,40
 DL 10,64,77,2048
 MV 100,4,40
 RW 106,18,18432
 MV 104,8,40
 MV 108,12,40
 RC 76,13,38912
 MV 112,16,40
 MV 116,20,40
 RW 108,19,16384
 MV 120,24,40
 DL 11,64,77,3072
 MV 124,28,40
 RW 110,19,18432
 MV 156,28,44
 MV 152,24,44
 RC 80,13,40960
 MV 148,20,44
 MV 144,16,44
 RW 112,20,16384
 MV 140,12,44
 s_add_u32 m0, s74, 4096
 s_add_u32 s76, s86, 768
 s_and_b32 s76, s76, 2047
 s_add_u32 s76, s76, s72
 s_add_u32 s76, s76, 65536
 MV 136,8,44
 RW 114,20,18432
 MV 132,4,44
 DL 4,60,76,0
 MV 128,0,44
 RC 84,13,43008
 MV 160,0,48
 MV 164,4,48
 RW 116,21,16384
 MV 168,8,48
 MV 172,12,48
 RW 118,21,18432
 MV 176,16,48
 DL 5,60,76,1024
 MV 180,20,48
 RC 88,13,45056
 MV 184,24,48
 MV 188,28,48
 RW 120,22,16384
 MV 220,28,52
 MV 216,24,52
 RW 122,22,18432
 MV 212,20,52
 DL 6,60,76,2048
 MV 208,16,52
 RC 92,13,47104
 MV 204,12,52
 MV 200,8,52
 RW 124,23,16384
 MV 196,4,52
 MV 192,0,52
 RW 126,23,18432
 MV 224,0,56
 DL 7,60,76,3072
 MV 228,4,56
 MV 232,8,56
 MV 236,12,56
 MV 240,16,56
 MV 244,20,56
 MV 248,24,56
 MV 252,28,56
 MA 156,28,60
 MA 152,24,60
 MA 148,20,60
 MA 144,16,60
 MA 140,12,60
 MA 136,8,60
 MA 132,4,60
 MA 128,0,60
 s_waitcnt vmcnt(16) lgkmcnt(0)
 s_barrier
 MV 32,64,96
 MV 36,68,96
 RC 0,14,0
 MV 40,72,96
 s_add_u32 m0, s75, 16384
 s_add_u32 s77, s87, 3407872
 s_and_b32 s77, s77, 0x7fffff
 s_add_u32 s77, s77, s73
 MV 44,76,96
 RW 32,16,32768
 MV 48,80,96
 DL 8,64,77,0
 MV 52,84,96
 RW 34,16,34816
 MV 56,88,96
 MV 60,92,96
 RC 4,14,2048
 MV 92,92,100
 MV 88,88,100
 RW 36,17,32768
 MV 84,84,100
 DL 9,64,77,1024
 MV 80,80,100
 RW 38,17,34816
 MV 76,76,100
 MV 72,72,100
 RC 8,14,4096
 MV 68,68,100
 MV 64,64,100
 RW 40,18,32768
 MV 96,64,104
 DL 10,64,77,2048
 MV 100,68,104
 RW 42,18,34816
 MV 104,72,104
 MV 108,76,104
 RC 12,14,6144
 MV 112,80,104
 MV 116,84,104
 RW 44,19,32768
 MV 120,88,104
 DL 11,64,77,3072
 MV 124,92,104
 RW 46,19,34816
 MV 156,92,108
 MV 152,88,108
 RC 16,14,8192
 MV 148,84,108
 MV 144,80,108
 RW 48,20,32768
 MV 140,76,108
 s_add_u32 m0, s74, 32768
 s_add_u32 s76, s86, 896
 s_and_b32 s76, s76, 2047
 s_add_u32 s76, s76, s72
 MV 136,72,108
 RW 50,20,34816
 MV 132,68,108
 DL 4,60,76,0
 MV 128,64,108
 RC 20,14,10240
 MV 160,64,112
 MV 164,68,112
 RW 52,21,32768
 MV 168,72,112
 MV 172,76,112
 RW 54,21,34816
 MV 176,80,112
 DL 5,60,76,1024
 MV 180,84,112
 RC 24,14,12288
 MV 184,88,112
 MV 188,92,112
 RW 56,22,32768
 MV 220,92,116
 MV 216,88,116
 RW 58,22,34816
 MV 212,84,116
 DL 6,60,76,2048
 MV 208,80,116
 RC 28,14,14336
 MV 204,76,116
 MV 200,72,116
 RW 60,23,32768
 MV 196,68,116
 MV 192,64,116
 RW 62,23,34816
 MV 224,64,120
 DL 7,60,76,3072
 MV 228,68,120
 MV 232,72,120
 MV 236,76,120
 MV 240,80,120
 MV 244,84,120
 MV 248,88,120
 MV 252,92,120
 MA 156,92,124
 MA 152,88,124
 MA 148,84,124
 MA 144,80,124
 MA 140,76,124
 MA 136,72,124
 MA 132,68,124
 MA 128,64,124
 s_waitcnt vmcnt(20) lgkmcnt(0)
 s_barrier
 MV 32,0,32
 MV 36,4,32
 RC 64,15,0
 MV 40,8,32
 s_add_u32 m0, s75, 32768
 s_add_u32 s77, s87, 3670016
 s_and_b32 s77, s77, 0x7fffff
 s_add_u32 s77, s77, s73
 MV 44,12,32
 RW 96,16,49152
 MV 48,16,32
 DL 8,64,77,0
 MV 52,20,32
 RW 98,16,51200
 MV 56,24,32
 MV 60,28,32
 RC 68,15,2048
 MV 92,28,36
 MV 88,24,36
 RW 100,17,49152
 MV 84,20,36
 DL 9,64,77,1024
 MV 80,16,36
 RW 102,17,51200
 MV 76,12,36
 MV 72,8,36
 RC 72,15,4096
 MV 68,4,36
 MV 64,0,36
 RW 104,18,49152
 MV 96,0,40
 DL 10,64,77,2048
 MV 100,4,40
 RW 106,18,51200
 MV 104,8,40
 MV 108,12,40
 RC 76,15,6144
 MV 112,16,40
 MV 116,20,40
 RW 108,19,49152
 MV 120,24,40
 DL 11,64,77,3072
 MV 124,28,40
 RW 110,19,51200
 MV 156,28,44
 MV 152,24,44
 RC 80,15,8192
 MV 148,20,44
 MV 144,16,44
 RW 112,20,49152
 MV 140,12,44
 s_add_u32 m0, s74, 36864
 s_add_u32 s76, s86, 896
 s_and_b32 s76, s76, 2047
 s_add_u32 s76, s76, s72
 s_add_u32 s76, s76, 65536
 MV 136,8,44
 RW 114,20,51200
 MV 132,4,44
 DL 4,60,76,0
 MV 128,0,44
 RC 84,15,10240
 MV 160,0,48
 MV 164,4,48
 RW 116,21,49152
 MV 168,8,48
 MV 172,12,48
 RW 118,21,51200
 MV 176,16,48
 DL 5,60,76,1024
 MV 180,20,48
 RC 88,15,12288
 MV 184,24,48
 MV 188,28,48
 RW 120,22,49152
 MV 220,28,52
 MV 216,24,52
 RW 122,22,51200
 MV 212,20,52
 DL 6,60,76,2048
 MV 208,16,52
 RC 92,15,14336
 MV 204,12,52
 MV 200,8,52
 RW 124,23,49152
 MV 196,4,52
 MV 192,0,52
 RW 126,23,51200
 MV 224,0,56
 DL 7,60,76,3072
 MV 228,4,56
 MV 232,8,56
 MV 236,12,56
 MV 240,16,56
 MV 244,20,56
 MV 248,24,56
 MV 252,28,56
 MA 156,28,60
 MA 152,24,60
 MA 148,20,60
 MA 144,16,60
 MA 140,12,60
 MA 136,8,60
 MA 132,4,60
 MA 128,0,60
 s_waitcnt vmcnt(16) lgkmcnt(0)
 s_barrier
 MV 32,64,96
 MV 36,68,96
 RC 0,12,0
 MV 40,72,96
 s_add_u32 m0, s75, 49152
 s_add_u32 s77, s87, 3932160
 s_and_b32 s77, s77, 0x7fffff
 s_add_u32 s77, s77, s73
 MV 44,76,96
 RW 32,16,0
 MV 48,80,96
 DL 8,64,77,0
 MV 52,84,96
 RW 34,16,2048
 MV 56,88,96
 MV 60,92,96
 RC 4,12,2048
 MV 92,92,100
 MV 88,88,100
 RW 36,17,0
 MV 84,84,100
 DL 9,64,77,1024
 MV 80,80,100
 RW 38,17,2048
 MV 76,76,100
 MV 72,72,100
 RC 8,12,4096
 MV 68,68,100
 MV 64,64,100
 RW 40,18,0
 MV 96,64,104
 DL 10,64,77,2048
 MV 100,68,104
 RW 42,18,2048
 MV 104,72,104
 MV 108,76,104
 RC 12,12,6144
 MV 112,80,104
 MV 116,84,104
 RW 44,19,0
 MV 120,88,104
 DL 11,64,77,3072
 MV 124,92,104
 RW 46,19,2048
 MV 156,92,108
 MV 152,88,108
 RC 16,12,8192
 MV 148,84,108
 MV 144,80,108
 RW 48,20,0
 MV 140,76,108
 s_add_u32 m0, s74, 65536
 s_add_u32 s76, s86, 1024
 s_and_b32 s76, s76, 2047
 s_add_u32 s76, s76, s72
 MV 136,72,108
 RW 50,20,2048
 MV 132,68,108
 DL 4,60,76,0
 MV 128,64,108
 RC 20,12,10240
 MV 160,64,112
 MV 164,68,112
 RW 52,21,0
 MV 168,72,112
 MV 172,76,112
 RW 54,21,2048
 MV 176,80,112
 DL 5,60,76,1024
 MV 180,84,112
 RC 24,12,12288
 MV 184,88,112
 MV 188,92,112
 RW 56,22,0
 MV 220,92,116
 MV 216,88,116
 RW 58,22,2048
 MV 212,84,116
 DL 6,60,76,2048
 MV 208,80,116
 RC 28,12,14336
 MV 204,76,116
 MV 200,72,116
 RW 60,23,0
 MV 196,68,116
 MV 192,64,116
 RW 62,23,2048
 MV 224,64,120
 DL 7,60,76,3072
 MV 228,68,120
 MV 232,72,120
 MV 236,76,120
 MV 240,80,120
 MV 244,84,120
 MV 248,88,120
 MV 252,92,120
 MA 156,92,124
 MA 152,88,124
 MA 148,84,124
 MA 144,80,124
 MA 140,76,124
 MA 136,72,124
 MA 132,68,124
 MA 128,64,124
 s_waitcnt vmcnt(20) lgkmcnt(0)
 s_barrier
 MV 32,0,32
 MV 36,4,32
 RC 64,13,0
 MV 40,8,32
 s_add_u32 m0, s75, 0
 s_add_u32 s77, s87, 4194304
 s_and_b32 s77, s77, 0x7fffff
 s_add_u32 s77, s77, s73
 MV 44,12,32
 RW 96,16,16384
 MV 48,16,32
 DL 8,64,77,0
 MV 52,20,32
 RW 98,16,18432
 MV 56,24,32
 MV 60,28,32
 RC 68,13,2048
 MV 92,28,36
 MV 88,24,36
 RW 100,17,16384
 MV 84,20,36
 DL 9,64,77,1024
 MV 80,16,36
 RW 102,17,18432
 MV 76,12,36
 MV 72,8,36
 RC 72,13,4096
 MV 68,4,36
 MV 64,0,36
 RW 104,18,16384
 MV 96,0,40
 DL 10,64,77,2048
 MV 100,4,40
 RW 106,18,18432
 MV 104,8,40
 MV 108,12,40
 RC 76,13,6144
 MV 112,16,40
 MV 116,20,40
 RW 108,19,16384
 MV 120,24,40
 DL 11,64,77,3072
 MV 124,28,40
 RW 110,19,18432
 MV 156,28,44
 MV 152,24,44
 RC 80,13,8192
 MV 148,20,44
 MV 144,16,44
 RW 112,20,16384
 MV 140,12,44
 s_add_u32 m0, s74, 69632
 s_add_u32 s76, s86, 1024
 s_and_b32 s76, s76, 2047
 s_add_u32 s76, s76, s72
 s_add_u32 s76, s76, 65536
 MV 136,8,44
 RW 114,20,18432
 MV 132,4,44
 DL 4,60,76,0
 MV 128,0,44
 RC 84,13,10240
 MV 160,0,48
 MV 164,4,48
 RW 116,21,16384
 MV 168,8,48
 MV 172,12,48
 RW 118,21,18432
 MV 176,16,48
 DL 5,60,76,1024
 MV 180,20,48
 RC 88,13,12288
 MV 184,24,48
 MV 188,28,48
 RW 120,22,16384
 MV 220,28,52
 MV 216,24,52
 RW 122,22,18432
 MV 212,20,52
 DL 6,60,76,2048
 MV 208,16,52
 RC 92,13,14336
 MV 204,12,52
 MV 200,8,52
 RW 124,23,16384
 MV 196,4,52
 MV 192,0,52
 RW 126,23,18432
 MV 224,0,56
 DL 7,60,76,3072
 MV 228,4,56
 MV 232,8,56
 MV 236,12,56
 MV 240,16,56
 MV 244,20,56
 MV 248,24,56
 MV 252,28,56
 MA 156,28,60
 MA 152,24,60
 MA 148,20,60
 MA 144,16,60
 MA 140,12,60
 MA 136,8,60
 MA 132,4,60
 MA 128,0,60
 s_waitcnt vmcnt(16) lgkmcnt(0)
 s_barrier
 MV 32,64,96
 MV 36,68,96
 RC 0,12,32768
 MV 40,72,96
 s_add_u32 m0, s75, 16384
 s_add_u32 s77, s87, 4456448
 s_and_b32 s77, s77, 0x7fffff
 s_add_u32 s77, s77, s73
 MV 44,76,96
 RW 32,16,32768
 MV 48,80,96
 DL 8,64,77,0
 MV 52,84,96
 RW 34,16,34816
 MV 56,88,96
 MV 60,92,96
 RC 4,12,34816
 MV 92,92,100
 MV 88,88,100
 RW 36,17,32768
 MV 84,84,100
 DL 9,64,77,1024
 MV 80,80,100
 RW 38,17,34816
 MV 76,76,100
 MV 72,72,100
 RC 8,12,36864
 MV 68,68,100
 MV 64,64,100
 RW 40,18,32768
 MV 96,64,104
 DL 10,64,77,2048
 MV 100,68,104
 RW 42,18,34816
 MV 104,72,104
 MV 108,76,104
 RC 12,12,38912
 MV 112,80,104
 MV 116,84,104
 RW 44,19,32768
 MV 120,88,104
 DL 11,64,77,3072
 MV 124,92,104
 RW 46,19,34816
 MV 156,92,108
 MV 152,88,108
 RC 16,12,40960
 MV 148,84,108
 MV 144,80,108
 RW 48,20,32768
 MV 140,76,108
 s_add_u32 m0, s74, 0
 s_add_u32 s76, s86, 1152
 s_and_b32 s76, s76, 2047
 s_add_u32 s76, s76, s72
 MV 136,72,108
 RW 50,20,34816
 MV 132,68,108
 DL 4,60,76,0
 MV 128,64,108
 RC 20,12,43008
 MV 160,64,112
 MV 164,68,112
 RW 52,21,32768
 MV 168,72,112
 MV 172,76,112
 RW 54,21,34816
 MV 176,80,112
 DL 5,60,76,1024
 MV 180,84,112
 RC 24,12,45056
 MV 184,88,112
 MV 188,92,112
 RW 56,22,32768
 MV 220,92,116
 MV 216,88,116
 RW 58,22,34816
 MV 212,84,116
 DL 6,60,76,2048
 MV 208,80,116
 RC 28,12,47104
 MV 204,76,116
 MV 200,72,116
 RW 60,23,32768
 MV 196,68,116
 MV 192,64,116
 RW 62,23,34816
 MV 224,64,120
 DL 7,60,76,3072
 MV 228,68,120
 MV 232,72,120
 MV 236,76,120
 MV 240,80,120
 MV 244,84,120
 MV 248,88,120
 MV 252,92,120
 MA 156,92,124
 MA 152,88,124
 MA 148,84,124
 MA 144,80,124
 MA 140,76,124
 MA 136,72,124
 MA 132,68,124
 MA 128,64,124
 s_waitcnt vmcnt(20) lgkmcnt(0)
 s_cmp_eq_u32 s20, 0
 s_cbranch_scc0 mk_x0_13
 s_mov_b32 s41, 0xffff
 s_mov_b32 s42, 0xffff
 s_mov_b32 s44, 0
 s_branch mk_xw_14_t
mk_xw_14:
 s_sleep 2
 global_load_dword v30, v29, s[16:17] sc1
 s_waitcnt vmcnt(0)
mk_xw_14_t:
 v_cmp_gt_u32 vcc, 16, v30
 s_add_u32 s44, s44, 1
 s_nop 3
 s_and_b32 vcc_lo, vcc_lo, s41
 s_and_b32 vcc_hi, vcc_hi, s42
 s_cbranch_vccz mk_xw_14_ok
 s_cmp_lt_u32 s44, 0x40000
 s_cbranch_scc1 mk_xw_14
mk_xw_14_ok:
mk_x0_13:
 s_barrier
 s_lshl_b32 s59, s39, 2
 s_add_u32 s59, s59, s20
 s_mul_i32 s59, s59, 28672
 s_add_u32 s59, s59, 0x2000000
 MV 32,0,32
 MV 36,4,32
 RC 64,13,32768
 MV 40,8,32
 s_add_u32 m0, s75, 32768
 s_add_u32 s77, s87, 4718592
 s_and_b32 s77, s77, 0x7fffff
 s_add_u32 s77, s77, s73
 MV 44,12,32
 RW 96,16,49152
 MV 48,16,32
 DL 8,64,77,0
 MV 52,20,32
 RW 98,16,51200
 MV 56,24,32
 MV 60,28,32
 RC 68,13,34816
 MV 92,28,36
 MV 88,24,36
 RW 100,17,49152
 MV 84,20,36
 DL 9,64,77,1024
 MV 80,16,36
 RW 102,17,51200
 MV 76,12,36
 MV 72,8,36
 RC 72,13,36864
 MV 68,4,36
 MV 64,0,36
 RW 104,18,49152
 MV 96,0,40
 DL 10,64,77,2048
 MV 100,4,40
 RW 106,18,51200
 MV 104,8,40
 MV 108,12,40
 RC 76,13,38912
 MV 112,16,40
 MV 116,20,40
 RW 108,19,49152
 MV 120,24,40
 DL 11,64,77,3072
 MV 124,28,40
 RW 110,19,51200
 MV 156,28,44
 MV 152,24,44
 RC 80,13,40960
 MV 148,20,44
 MV 144,16,44
 RW 112,20,49152
 MV 140,12,44
 s_add_u32 m0, s74, 4096
 s_add_u32 s76, s86, 1152
 s_and_b32 s76, s76, 2047
 s_add_u32 s76, s76, s72
 s_add_u32 s76, s76, 65536
 MV 136,8,44
 RW 114,20,51200
 MV 132,4,44
 DL 4,60,76,0
 MV 128,0,44
 RC 84,13,43008
 MV 160,0,48
 MV 164,4,48
 RW 116,21,49152
 MV 168,8,48
 MV 172,12,48
 RW 118,21,51200
 MV 176,16,48
 DL 5,60,76,1024
 MV 180,20,48
 RC 88,13,45056
 MV 184,24,48
 MV 188,28,48
 RW 120,22,49152
 MV 220,28,52
 MV 216,24,52
 RW 122,22,51200
 MV 212,20,52
 DL 6,60,76,2048
 MV 208,16,52
 RC 92,13,47104
 MV 204,12,52
 MV 200,8,52
 RW 124,23,49152
 MV 196,4,52
 MV 192,0,52
 RW 126,23,51200
 MV 224,0,56
 DL 7,60,76,3072
 MV 228,4,56
 MV 232,8,56
 MV 236,12,56
 MV 240,16,56
 MV 244,20,56
 MV 248,24,56
 s_add_u32 s42, s59, 8192
 buffer_load_dwordx4 a[208:211], v1, s[4:7], s42 offen offset:0
 MV 252,28,56
 MA 156,28,60
 MA 152,24,60
 MA 148,20,60
 MA 144,16,60
 MA 140,12,60
 s_add_u32 s42, s59, 8192
 buffer_load_dwordx4 a[212:215], v1, s[4:7], s42 offen offset:1024
 MA 136,8,60
 MA 132,4,60
 MA 128,0,60
 s_waitcnt vmcnt(18) lgkmcnt(0)
 s_barrier
 MV 32,64,96
 MV 36,68,96
 RC 0,14,0
 MV 40,72,96
 s_add_u32 m0, s75, 49152
 s_add_u32 s77, s87, 4980736
 s_and_b32 s77, s77, 0x7fffff
 s_add_u32 s77, s77, s73
 MV 44,76,96
 RW 32,16,0
 MV 48,80,96
 DL 8,64,77,0
 MV 52,84,96
 RW 34,16,2048
 MV 56,88,96
 MV 60,92,96
 RC 4,14,2048
 MV 92,92,100
 MV 88,88,100
 RW 36,17,0
 MV 84,84,100
 DL 9,64,77,1024
 MV 80,80,100
 RW 38,17,2048
 MV 76,76,100
 MV 72,72,100
 RC 8,14,4096
 MV 68,68,100
 MV 64,64,100
 RW 40,18,0
 MV 96,64,104
 DL 10,64,77,2048
 MV 100,68,104
 RW 42,18,2048
 MV 104,72,104
 MV 108,76,104
 RC 12,14,6144
 MV 112,80,104
 MV 116,84,104
 RW 44,19,0
 MV 120,88,104
 DL 11,64,77,3072
 MV 124,92,104
 RW 46,19,2048
 MV 156,92,108
 MV 152,88,108
 RC 16,14,8192
 MV 148,84,108
 MV 144,80,108
 RW 48,20,0
 MV 140,76,108
 s_add_u32 m0, s74, 32768
 s_add_u32 s76, s86, 1280
 s_and_b32 s76, s76, 2047
 s_add_u32 s76, s76, s72
 MV 136,72,108
 RW 50,20,2048
 MV 132,68,108
 DL 4,60,76,0
 MV 128,64,108
 RC 20,14,10240
 MV 160,64,112
 MV 164,68,112
 RW 52,21,0
 MV 168,72,112
 MV 172,76,112
 RW 54,21,2048
 MV 176,80,112
 DL 5,60,76,1024
 MV 180,84,112
 RC 24,14,12288
 MV 184,88,112
 MV 188,92,112
 RW 56,22,0
 MV 220,92,116
 MV 216,88,116
 RW 58,22,2048
 MV 212,84,116
 DL 6,60,76,2048
 MV 208,80,116
 RC 28,14,14336
 MV 204,76,116
 MV 200,72,116
 RW 60,23,0
 MV 196,68,116
 MV 192,64,116
 RW 62,23,2048
 MV 224,64,120
 DL 7,60,76,3072
 MV 228,68,120
 MV 232,72,120
 MV 236,76,120
 MV 240,80,120
 MV 244,84,120
 MV 248,88,120
 s_add_u32 s42, s59, 8192
 buffer_load_dwordx4 a[216:219], v1, s[4:7], s42 offen offset:2048
 MV 252,92,120
 MA 156,92,124
 MA 152,88,124
 MA 148,84,124
 MA 144,80,124
 MA 140,76,124
 s_add_u32 s42, s59, 8192
 buffer_load_dwordx4 a[220:223], v1, s[4:7], s42 offen offset:3072
 MA 136,72,124
 MA 132,68,124
 MA 128,64,124
 s_waitcnt vmcnt(24) lgkmcnt(0)
 s_barrier
 MV 32,0,32
 MV 36,4,32
 RC 64,15,0
 MV 40,8,32
 s_add_u32 m0, s75, 0
 s_add_u32 s77, s87, 5242880
 s_and_b32 s77, s77, 0x7fffff
 s_add_u32 s77, s77, s73
 MV 44,12,32
 RW 96,16,16384
 MV 48,16,32
 DL 8,64,77,0
 MV 52,20,32
 RW 98,16,18432
 MV 56,24,32
 MV 60,28,32
 RC 68,15,2048
 MV 92,28,36
 MV 88,24,36
 RW 100,17,16384
 MV 84,20,36
 DL 9,64,77,1024
 MV 80,16,36
 RW 102,17,18432
 MV 76,12,36
 MV 72,8,36
 RC 72,15,4096
 MV 68,4,36
 MV 64,0,36
 RW 104,18,16384
 MV 96,0,40
 DL 10,64,77,2048
 MV 100,4,40
 RW 106,18,18432
 MV 104,8,40
 MV 108,12,40
 RC 76,15,6144
 MV 112,16,40
 MV 116,20,40
 RW 108,19,16384
 MV 120,24,40
 DL 11,64,77,3072
 MV 124,28,40
 RW 110,19,18432
 MV 156,28,44
 MV 152,24,44
 RC 80,15,8192
 MV 148,20,44
 MV 144,16,44
 RW 112,20,16384
 MV 140,12,44
 s_add_u32 m0, s74, 36864
 s_add_u32 s76, s86, 1280
 s_and_b32 s76, s76, 2047
 s_add_u32 s76, s76, s72
 s_add_u32 s76, s76, 65536
 MV 136,8,44
 RW 114,20,18432
 MV 132,4,44
 DL 4,60,76,0
 MV 128,0,44
 RC 84,15,10240
 MV 160,0,48
 MV 164,4,48
 RW 116,21,16384
 MV 168,8,48
 MV 172,12,48
 RW 118,21,18432
 MV 176,16,48
 DL 5,60,76,1024
 MV 180,20,48
 RC 88,15,12288
 MV 184,24,48
 MV 188,28,48
 RW 120,22,16384
 MV 220,28,52
 MV 216,24,52
 RW 122,22,18432
 MV 212,20,52
 DL 6,60,76,2048
 MV 208,16,52
 RC 92,15,14336
 MV 204,12,52
 MV 200,8,52
 RW 124,23,16384
 MV 196,4,52
 MV 192,0,52
 RW 126,23,18432
 MV 224,0,56
 DL 7,60,76,3072
 MV 228,4,56
 MV 232,8,56
 MV 236,12,56
 MV 240,16,56
 MV 244,20,56
 MV 248,24,56
 s_add_u32 s42, s59, 12288
 buffer_load_dwordx4 a[224:227], v1, s[4:7], s42 offen offset:0
 MV 252,28,56
 MA 156,28,60
 MA 152,24,60
 MA 148,20,60
 MA 144,16,60
 MA 140,12,60
 s_add_u32 s42, s59, 12288
 buffer_load_dwordx4 a[228:231], v1, s[4:7], s42 offen offset:1024
 MA 136,8,60
 MA 132,4,60
 MA 128,0,60
 s_waitcnt vmcnt(22) lgkmcnt(0)
 s_barrier
 MV 32,64,96
 MV 36,68,96
 RC 0,12,0
 MV 40,72,96
 s_add_u32 m0, s75, 16384
 s_add_u32 s77, s87, 5505024
 s_and_b32 s77, s77, 0x7fffff
 s_add_u32 s77, s77, s73
 MV 44,76,96
 RW 32,16,32768
 MV 48,80,96
 DL 8,64,77,0
 MV 52,84,96
 RW 34,16,34816
 MV 56,88,96
 MV 60,92,96
 RC 4,12,2048
 MV 92,92,100
 MV 88,88,100
 RW 36,17,32768
 MV 84,84,100
 DL 9,64,77,1024
 MV 80,80,100
 RW 38,17,34816
 MV 76,76,100
 MV 72,72,100
 RC 8,12,4096
 MV 68,68,100
 MV 64,64,100
 RW 40,18,32768
 MV 96,64,104
 DL 10,64,77,2048
 MV 100,68,104
 RW 42,18,34816
 MV 104,72,104
 MV 108,76,104
 RC 12,12,6144
 MV 112,80,104
 MV 116,84,104
 RW 44,19,32768
 MV 120,88,104
 DL 11,64,77,3072
 MV 124,92,104
 RW 46,19,34816
 MV 156,92,108
 MV 152,88,108
 RC 16,12,8192
 MV 148,84,108
 MV 144,80,108
 RW 48,20,32768
 MV 140,76,108
 s_add_u32 m0, s74, 65536
 s_add_u32 s76, s86, 1408
 s_and_b32 s76, s76, 2047
 s_add_u32 s76, s76, s72
 MV 136,72,108
 RW 50,20,34816
 MV 132,68,108
 DL 4,60,76,0
 MV 128,64,108
 RC 20,12,10240
 MV 160,64,112
 MV 164,68,112
 RW 52,21,32768
 MV 168,72,112
 MV 172,76,112
 RW 54,21,34816
 MV 176,80,112
 DL 5,60,76,1024
 MV 180,84,112
 RC 24,12,12288
 MV 184,88,112
 MV 188,92,112
 RW 56,22,32768
 MV 220,92,116
 MV 216,88,116
 RW 58,22,34816
 MV 212,84,116
 DL 6,60,76,2048
 MV 208,80,116
 RC 28,12,14336
 MV 204,76,116
 MV 200,72,116
 RW 60,23,32768
 MV 196,68,116
 MV 192,64,116
 RW 62,23,34816
 MV 224,64,120
 DL 7,60,76,3072
 MV 228,68,120
 MV 232,72,120
 MV 236,76,120
 MV 240,80,120
 MV 244,84,120
 MV 248,88,120
 s_add_u32 s42, s59, 12288
 buffer_load_dwordx4 a[232:235], v1, s[4:7], s42 offen offset:2048
 MV 252,92,120
 MA 156,92,124
 MA 152,88,124
 MA 148,84,124
 MA 144,80,124
 MA 140,76,124
 s_add_u32 s42, s59, 12288
 buffer_load_dwordx4 a[236:239], v1, s[4:7], s42 offen offset:3072
 MA 136,72,124
 MA 132,68,124
 MA 128,64,124
 s_waitcnt vmcnt(26) lgkmcnt(0)
 s_barrier
 MV 32,0,32
 MV 36,4,32
 RC 64,13,0
 MV 40,8,32
 s_add_u32 m0, s75, 32768
 s_add_u32 s77, s87, 5767168
 s_and_b32 s77, s77, 0x7fffff
 s_add_u32 s77, s77, s73
 MV 44,12,32
 RW 96,16,49152
 MV 48,16,32
 DL 8,64,77,0
 MV 52,20,32
 RW 98,16,51200
 MV 56,24,32
 MV 60,28,32
 RC 68,13,2048
 MV 92,28,36
 MV 88,24,36
 RW 100,17,49152
 MV 84,20,36
 DL 9,64,77,1024
 MV 80,16,36
 RW 102,17,51200
 MV 76,12,36
 MV 72,8,36
 RC 72,13,4096
 MV 68,4,36
 MV 64,0,36
 RW 104,18,49152
 MV 96,0,40
 DL 10,64,77,2048
 MV 100,4,40
 RW 106,18,51200
 MV 104,8,40
 MV 108,12,40
 RC 76,13,6144
 MV 112,16,40
 MV 116,20,40
 RW 108,19,49152
 MV 120,24,40
 DL 11,64,77,3072
 MV 124,28,40
 RW 110,19,51200
 MV 156,28,44
 MV 152,24,44
 RC 80,13,8192
 MV 148,20,44
 MV 144,16,44
 RW 112,20,49152
 MV 140,12,44
 s_add_u32 m0, s74, 69632
 s_add_u32 s76, s86, 1408
 s_and_b32 s76, s76, 2047
 s_add_u32 s76, s76, s72
 s_add_u32 s76, s76, 65536
 MV 136,8,44
 RW 114,20,51200
 MV 132,4,44
 DL 4,60,76,0
 MV 128,0,44
 RC 84,13,10240
 MV 160,0,48
 MV 164,4,48
 RW 116,21,49152
 MV 168,8,48
 MV 172,12,48
 RW 118,21,51200
 MV 176,16,48
 DL 5,60,76,1024
 MV 180,20,48
 RC 88,13,12288
 MV 184,24,48
 MV 188,28,48
 RW 120,22,49152
 MV 220,28,52
 MV 216,24,52
 RW 122,22,51200
 MV 212,20,52
 DL 6,60,76,2048
 MV 208,16,52
 RC 92,13,14336
 MV 204,12,52
 MV 200,8,52
 RW 124,23,49152
 MV 196,4,52
 MV 192,0,52
 RW 126,23,51200
 MV 224,0,56
 DL 7,60,76,3072
 MV 228,4,56
 MV 232,8,56
 MV 236,12,56
 MV 240,16,56
 MV 244,20,56
 MV 248,24,56
 s_add_u32 s42, s59, 16384
 buffer_load_dwordx4 a[160:163], v1, s[4:7], s42 offen offset:0
 MV 252,28,56
 MA 156,28,60
 MA 152,24,60
 MA 148,20,60
 MA 144,16,60
 MA 140,12,60
 s_add_u32 s42, s59, 16384
 buffer_load_dwordx4 a[164:167], v1, s[4:7], s42 offen offset:1024
 MA 136,8,60
 MA 132,4,60
 MA 128,0,60
 s_waitcnt vmcnt(22) lgkmcnt(0)
 s_barrier
 MV 32,64,96
 MV 36,68,96
 RC 0,12,32768
 MV 40,72,96
 s_add_u32 m0, s75, 49152
 s_add_u32 s77, s87, 6029312
 s_and_b32 s77, s77, 0x7fffff
 s_add_u32 s77, s77, s73
 MV 44,76,96
 RW 32,16,0
 MV 48,80,96
 DL 8,64,77,0
 MV 52,84,96
 RW 34,16,2048
 MV 56,88,96
 MV 60,92,96
 RC 4,12,34816
 MV 92,92,100
 MV 88,88,100
 RW 36,17,0
 MV 84,84,100
 DL 9,64,77,1024
 MV 80,80,100
 RW 38,17,2048
 MV 76,76,100
 MV 72,72,100
 RC 8,12,36864
 MV 68,68,100
 MV 64,64,100
 RW 40,18,0
 MV 96,64,104
 DL 10,64,77,2048
 MV 100,68,104
 RW 42,18,2048
 MV 104,72,104
 MV 108,76,104
 RC 12,12,38912
 MV 112,80,104
 MV 116,84,104
 RW 44,19,0
 MV 120,88,104
 DL 11,64,77,3072
 MV 124,92,104
 RW 46,19,2048
 MV 156,92,108
 MV 152,88,108
 RC 16,12,40960
 MV 148,84,108
 MV 144,80,108
 RW 48,20,0
 MV 140,76,108
 s_add_u32 m0, s74, 0
 s_add_u32 s76, s86, 1536
 s_and_b32 s76, s76, 2047
 s_add_u32 s76, s76, s72
 MV 136,72,108
 RW 50,20,2048
 MV 132,68,108
 DL 4,60,76,0
 MV 128,64,108
 RC 20,12,43008
 MV 160,64,112
 MV 164,68,112
 RW 52,21,0
 MV 168,72,112
 MV 172,76,112
 RW 54,21,2048
 MV 176,80,112
 DL 5,60,76,1024
 MV 180,84,112
 RC 24,12,45056
 MV 184,88,112
 MV 188,92,112
 RW 56,22,0
 MV 220,92,116
 MV 216,88,116
 RW 58,22,2048
 MV 212,84,116
 DL 6,60,76,2048
 MV 208,80,116
 RC 28,12,47104
 MV 204,76,116
 MV 200,72,116
 RW 60,23,0
 MV 196,68,116
 MV 192,64,116
 RW 62,23,2048
 MV 224,64,120
 DL 7,60,76,3072
 MV 228,68,120
 MV 232,72,120
 MV 236,76,120
 MV 240,80,120
 MV 244,84,120
 MV 248,88,120
 s_add_u32 s42, s59, 16384
 buffer_load_dwordx4 a[168:171], v1, s[4:7], s42 offen offset:2048
 MV 252,92,120
 MA 156,92,124
 MA 152,88,124
 MA 148,84,124
 MA 144,80,124
 MA 140,76,124
 s_add_u32 s42, s59, 16384
 buffer_load_dwordx4 a[172:175], v1, s[4:7], s42 offen offset:3072
 MA 136,72,124
 MA 132,68,124
 MA 128,64,124
 s_waitcnt vmcnt(26) lgkmcnt(0)
 s_barrier
 MV 32,0,32
 MV 36,4,32
 RC 64,13,32768
 MV 40,8,32
 s_add_u32 m0, s75, 0
 s_add_u32 s77, s87, 6291456
 s_and_b32 s77, s77, 0x7fffff
 s_add_u32 s77, s77, s73
 MV 44,12,32
 RW 96,16,16384
 MV 48,16,32
 DL 8,64,77,0
 MV 52,20,32
 RW 98,16,18432
 MV 56,24,32
 MV 60,28,32
 RC 68,13,34816
 MV 92,28,36
 MV 88,24,36
 RW 100,17,16384
 MV 84,20,36
 DL 9,64,77,1024
 MV 80,16,36
 RW 102,17,18432
 MV 76,12,36
 MV 72,8,36
 RC 72,13,36864
 MV 68,4,36
 MV 64,0,36
 RW 104,18,16384
 MV 96,0,40
 DL 10,64,77,2048
 MV 100,4,40
 RW 106,18,18432
 MV 104,8,40
 MV 108,12,40
 RC 76,13,38912
 MV 112,16,40
 MV 116,20,40
 RW 108,19,16384
 MV 120,24,40
 DL 11,64,77,3072
 MV 124,28,40
 RW 110,19,18432
 MV 156,28,44
 MV 152,24,44
 RC 80,13,40960
 MV 148,20,44
 MV 144,16,44
 RW 112,20,16384
 MV 140,12,44
 s_add_u32 m0, s74, 4096
 s_add_u32 s76, s86, 1536
 s_and_b32 s76, s76, 2047
 s_add_u32 s76, s76, s72
 s_add_u32 s76, s76, 65536
 MV 136,8,44
 RW 114,20,18432
 MV 132,4,44
 DL 4,60,76,0
 MV 128,0,44
 RC 84,13,43008
 MV 160,0,48
 MV 164,4,48
 RW 116,21,16384
 MV 168,8,48
 MV 172,12,48
 RW 118,21,18432
 MV 176,16,48
 DL 5,60,76,1024
 MV 180,20,48
 RC 88,13,45056
 MV 184,24,48
 MV 188,28,48
 RW 120,22,16384
 MV 220,28,52
 MV 216,24,52
 RW 122,22,18432
 MV 212,20,52
 DL 6,60,76,2048
 MV 208,16,52
 RC 92,13,47104
 MV 204,12,52
 MV 200,8,52
 RW 124,23,16384
 MV 196,4,52
 MV 192,0,52
 RW 126,23,18432
 MV 224,0,56
 DL 7,60,76,3072
 MV 228,4,56
 MV 232,8,56
 MV 236,12,56
 MV 240,16,56
 MV 244,20,56
 MV 248,24,56
 s_add_u32 s42, s59, 20480
 buffer_load_dwordx4 a[176:179], v1, s[4:7], s42 offen offset:0
 MV 252,28,56
 MA 156,28,60
 MA 152,24,60
 MA 148,20,60
 MA 144,16,60
 MA 140,12,60
 MA 136,8,60
 MA 132,4,60
 MA 128,0,60
 s_waitcnt vmcnt(21) lgkmcnt(0)
 s_barrier
 MV 32,64,96
 MV 36,68,96
 RC 0,14,0
 MV 40,72,96
 s_add_u32 m0, s75, 16384
 s_add_u32 s77, s87, 6553600
 s_and_b32 s77, s77, 0x7fffff
 s_add_u32 s77, s77, s73
 MV 44,76,96
 RW 32,16,32768
 MV 48,80,96
 DL 8,64,77,0
 MV 52,84,96
 RW 34,16,34816
 MV 56,88,96
 MV 60,92,96
 RC 4,14,2048
 MV 92,92,100
 MV 88,88,100
 RW 36,17,32768
 MV 84,84,100
 DL 9,64,77,1024
 MV 80,80,100
 RW 38,17,34816
 MV 76,76,100
 MV 72,72,100
 RC 8,14,4096
 MV 68,68,100
 MV 64,64,100
 RW 40,18,32768
 MV 96,64,104
 DL 10,64,77,2048
 MV 100,68,104
 RW 42,18,34816
 MV 104,72,104
 MV 108,76,104
 RC 12,14,6144
 MV 112,80,104
 MV 116,84,104
 RW 44,19,32768
 MV 120,88,104
 DL 11,64,77,3072
 MV 124,92,104
 RW 46,19,34816
 MV 156,92,108
 MV 152,88,108
 RC 16,14,8192
 MV 148,84,108
 MV 144,80,108
 RW 48,20,32768
 MV 140,76,108
 s_add_u32 m0, s74, 32768
 s_add_u32 s76, s86, 1664
 s_and_b32 s76, s76, 2047
 s_add_u32 s76, s76, s72
 MV 136,72,108
 RW 50,20,34816
 MV 132,68,108
 DL 4,60,76,0
 MV 128,64,108
 RC 20,14,10240
 MV 160,64,112
 MV 164,68,112
 RW 52,21,32768
 MV 168,72,112
 MV 172,76,112
 RW 54,21,34816
 MV 176,80,112
 DL 5,60,76,1024
 MV 180,84,112
 RC 24,14,12288
 MV 184,88,112
 MV 188,92,112
 RW 56,22,32768
 MV 220,92,116
 MV 216,88,116
 RW 58,22,34816
 MV 212,84,116
 DL 6,60,76,2048
 MV 208,80,116
 RC 28,14,14336
 MV 204,76,116
 MV 200,72,116
 RW 60,23,32768
 MV 196,68,116
 MV 192,64,116
 RW 62,23,34816
 MV 224,64,120
 DL 7,60,76,3072
 MV 228,68,120
 MV 232,72,120
 MV 236,76,120
 MV 240,80,120
 MV 244,84,120
 MV 248,88,120
 s_add_u32 s42, s59, 20480
 buffer_load_dwordx4 a[180:183], v1, s[4:7], s42 offen offset:1024
 MV 252,92,120
 MA 156,92,124
 MA 152,88,124
 MA 148,84,124
 MA 144,80,124
 MA 140,76,124
 MA 136,72,124
 MA 132,68,124
 MA 128,64,124
 s_waitcnt vmcnt(24) lgkmcnt(0)
 s_barrier
 MV 32,0,32
 MV 36,4,32
 RC 64,15,0
 MV 40,8,32
 s_add_u32 m0, s75, 32768
 s_add_u32 s77, s87, 6815744
 s_and_b32 s77, s77, 0x7fffff
 s_add_u32 s77, s77, s73
 MV 44,12,32
 RW 96,16,49152
 MV 48,16,32
 DL 8,64,77,0
 MV 52,20,32
 RW 98,16,51200
 MV 56,24,32
 MV 60,28,32
 RC 68,15,2048
 MV 92,28,36
 MV 88,24,36
 RW 100,17,49152
 MV 84,20,36
 DL 9,64,77,1024
 MV 80,16,36
 RW 102,17,51200
 MV 76,12,36
 MV 72,8,36
 RC 72,15,4096
 MV 68,4,36
 MV 64,0,36
 RW 104,18,49152
 MV 96,0,40
 DL 10,64,77,2048
 MV 100,4,40
 RW 106,18,51200
 MV 104,8,40
 MV 108,12,40
 RC 76,15,6144
 MV 112,16,40
 MV 116,20,40
 RW 108,19,49152
 MV 120,24,40
 DL 11,64,77,3072
 MV 124,28,40
 RW 110,19,51200
 MV 156,28,44
 MV 152,24,44
 RC 80,15,8192
 MV 148,20,44
 MV 144,16,44
 RW 112,20,49152
 MV 140,12,44
 s_add_u32 m0, s74, 36864
 s_add_u32 s76, s86, 1664
 s_and_b32 s76, s76, 2047
 s_add_u32 s76, s76, s72
 s_add_u32 s76, s76, 65536
 MV 136,8,44
 RW 114,20,51200
 MV 132,4,44
 DL 4,60,76,0
 MV 128,0,44
 RC 84,15,10240
 MV 160,0,48
 MV 164,4,48
 RW 116,21,49152
 MV 168,8,48
 MV 172,12,48
 RW 118,21,51200
 MV 176,16,48
 DL 5,60,76,1024
 MV 180,20,48
 RC 88,15,12288
 MV 184,24,48
 MV 188,28,48
 RW 120,22,49152
 MV 220,28,52
 MV 216,24,52
 RW 122,22,51200
 MV 212,20,52
 DL 6,60,76,2048
 MV 208,16,52
 RC 92,15,14336
 MV 204,12,52
 MV 200,8,52
 RW 124,23,49152
 MV 196,4,52
 MV 192,0,52
 RW 126,23,51200
 MV 224,0,56
 DL 7,60,76,3072
 MV 228,4,56
 MV 232,8,56
 MV 236,12,56
 MV 240,16,56
 MV 244,20,56
 MV 248,24,56
 s_add_u32 s42, s59, 20480
 buffer_load_dwordx4 a[184:187], v1, s[4:7], s42 offen offset:2048
 MV 252,28,56
 MA 156,28,60
 MA 152,24,60
 MA 148,20,60
 MA 144,16,60
 MA 140,12,60
 MA 136,8,60
 MA 132,4,60
 MA 128,0,60
 s_waitcnt vmcnt(19) lgkmcnt(0)
 s_barrier
 MV 32,64,96
 MV 36,68,96
 RC 0,12,0
 MV 40,72,96
 s_add_u32 m0, s75, 49152
 s_add_u32 s77, s87, 7077888
 s_and_b32 s77, s77, 0x7fffff
 s_add_u32 s77, s77, s73
 MV 44,76,96
 RW 32,16,0
 MV 48,80,96
 DL 8,64,77,0
 MV 52,84,96
 RW 34,16,2048
 MV 56,88,96
 MV 60,92,96
 RC 4,12,2048
 MV 92,92,100
 MV 88,88,100
 RW 36,17,0
 MV 84,84,100
 DL 9,64,77,1024
 MV 80,80,100
 RW 38,17,2048
 MV 76,76,100
 MV 72,72,100
 RC 8,12,4096
 MV 68,68,100
 MV 64,64,100
 RW 40,18,0
 MV 96,64,104
 DL 10,64,77,2048
 MV 100,68,104
 RW 42,18,2048
 MV 104,72,104
 MV 108,76,104
 RC 12,12,6144
 MV 112,80,104
 MV 116,84,104
 RW 44,19,0
 MV 120,88,104
 DL 11,64,77,3072
 MV 124,92,104
 RW 46,19,2048
 MV 156,92,108
 MV 152,88,108
 RC 16,12,8192
 MV 148,84,108
 MV 144,80,108
 RW 48,20,0
 MV 140,76,108
 s_add_u32 m0, s74, 65536
 s_add_u32 s76, s86, 1792
 s_and_b32 s76, s76, 2047
 s_add_u32 s76, s76, s72
 MV 136,72,108
 RW 50,20,2048
 MV 132,68,108
 DL 4,60,76,0
 MV 128,64,108
 RC 20,12,10240
 MV 160,64,112
 MV 164,68,112
 RW 52,21,0
 MV 168,72,112
 MV 172,76,112
 RW 54,21,2048
 MV 176,80,112
 DL 5,60,76,1024
 MV 180,84,112
 RC 24,12,12288
 MV 184,88,112
 MV 188,92,112
 RW 56,22,0
 MV 220,92,116
 MV 216,88,116
 RW 58,22,2048
 MV 212,84,116
 DL 6,60,76,2048
 MV 208,80,116
 RC 28,12,14336
 MV 204,76,116
 MV 200,72,116
 RW 60,23,0
 MV 196,68,116
 MV 192,64,116
 RW 62,23,2048
 MV 224,64,120
 DL 7,60,76,3072
 MV 228,68,120
 MV 232,72,120
 MV 236,76,120
 MV 240,80,120
 MV 244,84,120
 MV 248,88,120
 s_add_u32 s42, s59, 20480
 buffer_load_dwordx4 a[188:191], v1, s[4:7], s42 offen offset:3072
 MV 252,92,120
 MA 156,92,124
 MA 152,88,124
 MA 148,84,124
 MA 144,80,124
 MA 140,76,124
 MA 136,72,124
 MA 132,68,124
 MA 128,64,124
 s_waitcnt vmcnt(23) lgkmcnt(0)
 s_barrier
 MV 32,0,32
 MV 36,4,32
 RC 64,13,0
 MV 40,8,32
 s_add_u32 m0, s75, 0
 s_add_u32 s77, s87, 7340032
 s_and_b32 s77, s77, 0x7fffff
 s_add_u32 s77, s77, s73
 MV 44,12,32
 RW 96,16,16384
 MV 48,16,32
 DL 8,64,77,0
 MV 52,20,32
 RW 98,16,18432
 MV 56,24,32
 MV 60,28,32
 RC 68,13,2048
 MV 92,28,36
 MV 88,24,36
 RW 100,17,16384
 MV 84,20,36
 DL 9,64,77,1024
 MV 80,16,36
 RW 102,17,18432
 MV 76,12,36
 MV 72,8,36
 RC 72,13,4096
 MV 68,4,36
 MV 64,0,36
 RW 104,18,16384
 MV 96,0,40
 DL 10,64,77,2048
 MV 100,4,40
 RW 106,18,18432
 MV 104,8,40
 MV 108,12,40
 RC 76,13,6144
 MV 112,16,40
 MV 116,20,40
 RW 108,19,16384
 MV 120,24,40
 DL 11,64,77,3072
 MV 124,28,40
 RW 110,19,18432
 MV 156,28,44
 MV 152,24,44
 RC 80,13,8192
 MV 148,20,44
 MV 144,16,44
 RW 112,20,16384
 MV 140,12,44
 s_add_u32 m0, s74, 69632
 s_add_u32 s76, s86, 1792
 s_and_b32 s76, s76, 2047
 s_add_u32 s76, s76, s72
 s_add_u32 s76, s76, 65536
 MV 136,8,44
 RW 114,20,18432
 MV 132,4,44
 DL 4,60,76,0
 MV 128,0,44
 RC 84,13,10240
 MV 160,0,48
 MV 164,4,48
 RW 116,21,16384
 MV 168,8,48
 MV 172,12,48
 RW 118,21,18432
 MV 176,16,48
 DL 5,60,76,1024
 MV 180,20,48
 RC 88,13,12288
 MV 184,24,48
 MV 188,28,48
 RW 120,22,16384
 MV 220,28,52
 MV 216,24,52
 RW 122,22,18432
 MV 212,20,52
 DL 6,60,76,2048
 MV 208,16,52
 RC 92,13,14336
 MV 204,12,52
 MV 200,8,52
 RW 124,23,16384
 MV 196,4,52
 MV 192,0,52
 RW 126,23,18432
 MV 224,0,56
 DL 7,60,76,3072
 MV 228,4,56
 MV 232,8,56
 MV 236,12,56
 MV 240,16,56
 MV 244,20,56
 MV 248,24,56
 s_add_u32 s42, s59, 24576
 buffer_load_dwordx4 a[192:195], v1, s[4:7], s42 offen offset:0
 MV 252,28,56
 MA 156,28,60
 MA 152,24,60
 MA 148,20,60
 MA 144,16,60
 MA 140,12,60
 MA 136,8,60
 MA 132,4,60
 MA 128,0,60
 s_waitcnt vmcnt(19) lgkmcnt(0)
 s_barrier
 MV 32,64,96
 MV 36,68,96
 RC 0,12,32768
 MV 40,72,96
 s_add_u32 m0, s75, 16384
 s_add_u32 s77, s87, 7602176
 s_and_b32 s77, s77, 0x7fffff
 s_add_u32 s77, s77, s73
 MV 44,76,96
 RW 32,16,32768
 MV 48,80,96
 DL 8,64,77,0
 MV 52,84,96
 RW 34,16,34816
 MV 56,88,96
 MV 60,92,96
 RC 4,12,34816
 MV 92,92,100
 MV 88,88,100
 RW 36,17,32768
 MV 84,84,100
 DL 9,64,77,1024
 MV 80,80,100
 RW 38,17,34816
 MV 76,76,100
 MV 72,72,100
 RC 8,12,36864
 MV 68,68,100
 MV 64,64,100
 RW 40,18,32768
 MV 96,64,104
 DL 10,64,77,2048
 MV 100,68,104
 RW 42,18,34816
 MV 104,72,104
 MV 108,76,104
 RC 12,12,38912
 MV 112,80,104
 MV 116,84,104
 RW 44,19,32768
 MV 120,88,104
 DL 11,64,77,3072
 MV 124,92,104
 RW 46,19,34816
 MV 156,92,108
 MV 152,88,108
 RC 16,12,40960
 MV 148,84,108
 MV 144,80,108
 RW 48,20,32768
 MV 140,76,108
 s_add_u32 m0, s74, 0
 s_add_u32 s76, s86, 1920
 s_and_b32 s76, s76, 2047
 s_add_u32 s76, s76, s72
 MV 136,72,108
 RW 50,20,34816
 MV 132,68,108
 DL 4,60,76,0
 MV 128,64,108
 RC 20,12,43008
 MV 160,64,112
 MV 164,68,112
 RW 52,21,32768
 MV 168,72,112
 MV 172,76,112
 RW 54,21,34816
 MV 176,80,112
 DL 5,60,76,1024
 MV 180,84,112
 RC 24,12,45056
 MV 184,88,112
 MV 188,92,112
 RW 56,22,32768
 MV 220,92,116
 MV 216,88,116
 RW 58,22,34816
 MV 212,84,116
 DL 6,60,76,2048
 MV 208,80,116
 RC 28,12,47104
 MV 204,76,116
 MV 200,72,116
 RW 60,23,32768
 MV 196,68,116
 MV 192,64,116
 RW 62,23,34816
 MV 224,64,120
 DL 7,60,76,3072
 MV 228,68,120
 MV 232,72,120
 MV 236,76,120
 MV 240,80,120
 MV 244,84,120
 MV 248,88,120
 s_add_u32 s42, s59, 24576
 buffer_load_dwordx4 a[196:199], v1, s[4:7], s42 offen offset:1024
 MV 252,92,120
 MA 156,92,124
 MA 152,88,124
 MA 148,84,124
 MA 144,80,124
 MA 140,76,124
 MA 136,72,124
 MA 132,68,124
 MA 128,64,124
 s_waitcnt vmcnt(23) lgkmcnt(0)
 s_barrier
 MV 32,0,32
 MV 36,4,32
 RC 64,13,32768
 MV 40,8,32
 s_add_u32 m0, s75, 32768
 s_add_u32 s77, s87, 7864320
 s_and_b32 s77, s77, 0x7fffff
 s_add_u32 s77, s77, s73
 MV 44,12,32
 RW 96,16,49152
 MV 48,16,32
 DL 8,64,77,0
 MV 52,20,32
 RW 98,16,51200
 MV 56,24,32
 MV 60,28,32
 RC 68,13,34816
 MV 92,28,36
 MV 88,24,36
 RW 100,17,49152
 MV 84,20,36
 DL 9,64,77,1024
 MV 80,16,36
 RW 102,17,51200
 MV 76,12,36
 MV 72,8,36
 RC 72,13,36864
 MV 68,4,36
 MV 64,0,36
 RW 104,18,49152
 MV 96,0,40
 DL 10,64,77,2048
 MV 100,4,40
 RW 106,18,51200
 MV 104,8,40
 MV 108,12,40
 RC 76,13,38912
 MV 112,16,40
 MV 116,20,40
 RW 108,19,49152
 MV 120,24,40
 DL 11,64,77,3072
 MV 124,28,40
 RW 110,19,51200
 MV 156,28,44
 MV 152,24,44
 RC 80,13,40960
 MV 148,20,44
 MV 144,16,44
 RW 112,20,49152
 MV 140,12,44
 s_add_u32 m0, s74, 4096
 s_add_u32 s76, s86, 1920
 s_and_b32 s76, s76, 2047
 s_add_u32 s76, s76, s72
 s_add_u32 s76, s76, 65536
 MV 136,8,44
 RW 114,20,51200
 MV 132,4,44
 DL 4,60,76,0
 MV 128,0,44
 RC 84,13,43008
 MV 160,0,48
 MV 164,4,48
 RW 116,21,49152
 MV 168,8,48
 MV 172,12,48
 RW 118,21,51200
 MV 176,16,48
 DL 5,60,76,1024
 MV 180,20,48
 RC 88,13,45056
 MV 184,24,48
 MV 188,28,48
 RW 120,22,49152
 MV 220,28,52
 MV 216,24,52
 RW 122,22,51200
 MV 212,20,52
 DL 6,60,76,2048
 MV 208,16,52
 RC 92,13,47104
 MV 204,12,52
 MV 200,8,52
 RW 124,23,49152
 MV 196,4,52
 MV 192,0,52
 RW 126,23,51200
 MV 224,0,56
 DL 7,60,76,3072
 MV 228,4,56
 MV 232,8,56
 MV 236,12,56
 MV 240,16,56
 MV 244,20,56
 MV 248,24,56
 s_add_u32 s42, s59, 24576
 buffer_load_dwordx4 a[200:203], v1, s[4:7], s42 offen offset:2048
 MV 252,28,56
 MA 156,28,60
 MA 152,24,60
 MA 148,20,60
 MA 144,16,60
 MA 140,12,60
 MA 136,8,60
 MA 132,4,60
 MA 128,0,60
 s_waitcnt vmcnt(19) lgkmcnt(0)
 s_barrier
 MV 32,64,96
 MV 36,68,96
 RC 0,14,0
 MV 40,72,96
 s_add_u32 m0, s75, 49152
 s_add_u32 s77, s87, 8126464
 s_and_b32 s77, s77, 0x7fffff
 s_add_u32 s77, s77, s73
 MV 44,76,96
 RW 32,16,0
 MV 48,80,96
 DL 8,64,77,0
 MV 52,84,96
 RW 34,16,2048
 MV 56,88,96
 MV 60,92,96
 RC 4,14,2048
 MV 92,92,100
 MV 88,88,100
 RW 36,17,0
 MV 84,84,100
 DL 9,64,77,1024
 MV 80,80,100
 RW 38,17,2048
 MV 76,76,100
 MV 72,72,100
 RC 8,14,4096
 MV 68,68,100
 MV 64,64,100
 RW 40,18,0
 MV 96,64,104
 DL 10,64,77,2048
 MV 100,68,104
 RW 42,18,2048
 MV 104,72,104
 MV 108,76,104
 RC 12,14,6144
 MV 112,80,104
 MV 116,84,104
 RW 44,19,0
 MV 120,88,104
 DL 11,64,77,3072
 MV 124,92,104
 RW 46,19,2048
 MV 156,92,108
 MV 152,88,108
 RC 16,14,8192
 MV 148,84,108
 MV 144,80,108
 RW 48,20,0
 MV 140,76,108
 MV 136,72,108
 RW 50,20,2048
 MV 132,68,108
 MV 128,64,108
 RC 20,14,10240
 MV 160,64,112
 MV 164,68,112
 RW 52,21,0
 MV 168,72,112
 MV 172,76,112
 RW 54,21,2048
 MV 176,80,112
 MV 180,84,112
 RC 24,14,12288
 MV 184,88,112
 MV 188,92,112
 RW 56,22,0
 MV 220,92,116
 MV 216,88,116
 RW 58,22,2048
 MV 212,84,116
 MV 208,80,116
 RC 28,14,14336
 MV 204,76,116
 MV 200,72,116
 RW 60,23,0
 MV 196,68,116
 MV 192,64,116
 RW 62,23,2048
 MV 224,64,120
 MV 228,68,120
 MV 232,72,120
 MV 236,76,120
 MV 240,80,120
 MV 244,84,120
 MV 248,88,120
 s_add_u32 s42, s59, 24576
 buffer_load_dwordx4 a[204:207], v1, s[4:7], s42 offen offset:3072
 MV 252,92,120
 MA 156,92,124
 MA 152,88,124
 MA 148,84,124
 MA 144,80,124
 MA 140,76,124
 MA 136,72,124
 MA 132,68,124
 MA 128,64,124
 s_waitcnt vmcnt(19) lgkmcnt(0)
 s_barrier
 v_lshrrev_b32 v25, 3, v2
 v_lshrrev_b32 v26, 4, v2
 v_lshlrev_b32 v26, 1, v26
 v_and_b32 v27, 7, v2
 v_xor_b32 v26, v26, v27
 v_lshlrev_b32 v26, 4, v26
 v_lshl_add_u32 v4, v25, 13, v26
 v_add_u32 v5, 64512, v4
 v_add_u32 v6, 129024, v4
 v_add_u32 v7, 193536, v4
 s_mov_b32 s8, s12
 s_mov_b32 s9, s13
 s_mov_b32 s10, 3670016
 s_mov_b32 s11, 0x20000
 s_lshl_b32 s36, s21, 9
 s_lshl_b32 s41, s20, 7
 s_add_u32 s36, s36, s41
 s_mov_b32 s37, 262144
 s_mov_b32 s38, 524288
 s_getpc_b64 s[98:99]
mk_ct_15:
 s_add_u32 s98, s98, mk_p1done-mk_ct_15
 s_addc_u32 s99, s99, 0
 s_lshr_b32 s41, s2, 3
 s_lshl_b32 s41, s41, 2
 s_add_u32 s41, s41, s20
 s_lshl_b32 s41, s41, 7
 v_lshrrev_b32 v29, 4, v1
 v_min_u32 v29, 2, v29
 v_lshlrev_b32 v29, 14, v29
 v_add_u32 v29, s41, v29
 v_min_u32 v29, (mk_oproj-mk_p1done)-4, v29
 v_and_b32 v29, 0xfffffffc, v29
 global_load_dword v30, v29, s[98:99]
 s_lshl_b32 s98, s39, 2
 s_add_u32 s98, s98, s20
 s_mul_i32 s98, s98, 28672
 s_add_u32 s98, s98, 0x2000000
 MV 32,0,32
 MV 36,4,32
 RC 64,15,0
 s_add_u32 m0, s27, 32768
 MV 40,8,32
 MV 44,12,32
 RW 96,16,16384
 MV 48,16,32
 MV 52,20,32
 RW 98,16,18432
 s_add_u32 s41, s36, s37
 MV 56,24,32
 MV 60,28,32
 RC 68,15,2048
 MV 92,28,36
 MV 88,24,36
 RW 100,17,16384
 MV 84,20,36
 DL 4,8,36,0
 MV 80,16,36
 RW 102,17,18432
 MV 76,12,36
 MV 72,8,36
 RC 72,15,4096
 MV 68,4,36
 MV 64,0,36
 RW 104,18,16384
 DL 5,8,36,1024
 MV 96,0,40
 MV 100,4,40
 RW 106,18,18432
 MV 104,8,40
 MV 108,12,40
 RC 76,15,6144
 MV 112,16,40
 DL 6,8,36,2048
 MV 116,20,40
 RW 108,19,16384
 MV 120,24,40
 MV 124,28,40
 RW 110,19,18432
 MV 156,28,44
 MV 152,24,44
 RC 80,15,8192
 DL 7,8,36,3072
 MV 148,20,44
 MV 144,16,44
 RW 112,20,16384
 MV 140,12,44
 MV 136,8,44
 RW 114,20,18432
 MV 132,4,44
 s_add_u32 m0, m0, 0x1000
 MV 128,0,44
 RC 84,15,10240
 MV 160,0,48
 MV 164,4,48
 RW 116,21,16384
 MV 168,8,48
 MV 172,12,48
 RW 118,21,18432
 DL 4,8,41,0
 MV 176,16,48
 MV 180,20,48
 RC 88,15,12288
 MV 184,24,48
 MV 188,28,48
 RW 120,22,16384
 MV 220,28,52
 DL 5,8,41,1024
 MV 216,24,52
 RW 122,22,18432
 MV 212,20,52
 MV 208,16,52
 RC 92,15,14336
 MV 204,12,52
 MV 200,8,52
 RW 124,23,16384
 DL 6,8,41,2048
 MV 196,4,52
 MV 192,0,52
 RW 126,23,18432
 MV 224,0,56
 MV 228,4,56
 MV 232,8,56
 DL 7,8,41,3072
 MV 236,12,56
 MV 240,16,56
 MV 244,20,56
 MV 248,24,56
 MV 252,28,56
 s_add_u32 s36, s36, s38
 MA 156,28,60
 MA 152,24,60
 MA 148,20,60
 MA 144,16,60
 MA 140,12,60
 MA 136,8,60
 MA 132,4,60
 MA 128,0,60
 s_waitcnt vmcnt(15) lgkmcnt(0)
 s_barrier
 MV 32,64,96
 MV 36,68,96
 RC 0,12,0
 s_add_u32 m0, s27, 65536
 MV 40,72,96
 MV 44,76,96
 RW 32,16,32768
 MV 48,80,96
 MV 52,84,96
 RW 34,16,34816
 s_add_u32 s41, s36, s37
 MV 56,88,96
 MV 60,92,96
 RC 4,12,2048
 MV 92,92,100
 MV 88,88,100
 RW 36,17,32768
 MV 84,84,100
 DL 4,8,36,0
 MV 80,80,100
 RW 38,17,34816
 MV 76,76,100
 MV 72,72,100
 RC 8,12,4096
 MV 68,68,100
 MV 64,64,100
 RW 40,18,32768
 DL 5,8,36,1024
 MV 96,64,104
 MV 100,68,104
 RW 42,18,34816
 MV 104,72,104
 MV 108,76,104
 RC 12,12,6144
 MV 112,80,104
 DL 6,8,36,2048
 MV 116,84,104
 RW 44,19,32768
 MV 120,88,104
 MV 124,92,104
 RW 46,19,34816
 MV 156,92,108
 MV 152,88,108
 RC 16,12,8192
 DL 7,8,36,3072
 MV 148,84,108
 MV 144,80,108
 RW 48,20,32768
 MV 140,76,108
 MV 136,72,108
 RW 50,20,34816
 MV 132,68,108
 s_add_u32 m0, m0, 0x1000
 MV 128,64,108
 RC 20,12,10240
 MV 160,64,112
 MV 164,68,112
 RW 52,21,32768
 MV 168,72,112
 MV 172,76,112
 RW 54,21,34816
 DL 4,8,41,0
 MV 176,80,112
 MV 180,84,112
 RC 24,12,12288
 MV 184,88,112
 MV 188,92,112
 RW 56,22,32768
 MV 220,92,116
 DL 5,8,41,1024
 MV 216,88,116
 RW 58,22,34816
 MV 212,84,116
 MV 208,80,116
 RC 28,12,14336
 MV 204,76,116
 MV 200,72,116
 RW 60,23,32768
 DL 6,8,41,2048
 MV 196,68,116
 MV 192,64,116
 RW 62,23,34816
 MV 224,64,120
 MV 228,68,120
 MV 232,72,120
 DL 7,8,41,3072
 MV 236,76,120
 MV 240,80,120
 MV 244,84,120
 MV 248,88,120
 MV 252,92,120
 s_add_u32 s36, s36, s38
 MA 156,92,124
 MA 152,88,124
 MA 148,84,124
 MA 144,80,124
 MA 140,76,124
 MA 136,72,124
 MA 132,68,124
 MA 128,64,124
 s_waitcnt vmcnt(18) lgkmcnt(0)
 s_barrier
 MV 32,0,32
 MV 36,4,32
 RC 64,13,0
 s_add_u32 m0, s27, 98304
 MV 40,8,32
 MV 44,12,32
 RW 96,16,49152
 MV 48,16,32
 MV 52,20,32
 RW 98,16,51200
 s_add_u32 s41, s36, s37
 MV 56,24,32
 MV 60,28,32
 RC 68,13,2048
 MV 92,28,36
 MV 88,24,36
 RW 100,17,49152
 MV 84,20,36
 DL 4,8,36,0
 MV 80,16,36
 RW 102,17,51200
 MV 76,12,36
 MV 72,8,36
 RC 72,13,4096
 MV 68,4,36
 MV 64,0,36
 RW 104,18,49152
 DL 5,8,36,1024
 MV 96,0,40
 MV 100,4,40
 RW 106,18,51200
 MV 104,8,40
 MV 108,12,40
 RC 76,13,6144
 MV 112,16,40
 DL 6,8,36,2048
 MV 116,20,40
 RW 108,19,49152
 MV 120,24,40
 MV 124,28,40
 RW 110,19,51200
 MV 156,28,44
 MV 152,24,44
 RC 80,13,8192
 DL 7,8,36,3072
 MV 148,20,44
 MV 144,16,44
 RW 112,20,49152
 MV 140,12,44
 MV 136,8,44
 RW 114,20,51200
 MV 132,4,44
 s_add_u32 m0, m0, 0x1000
 MV 128,0,44
 RC 84,13,10240
 MV 160,0,48
 MV 164,4,48
 RW 116,21,49152
 MV 168,8,48
 MV 172,12,48
 RW 118,21,51200
 DL 4,8,41,0
 MV 176,16,48
 MV 180,20,48
 RC 88,13,12288
 MV 184,24,48
 MV 188,28,48
 RW 120,22,49152
 MV 220,28,52
 DL 5,8,41,1024
 MV 216,24,52
 RW 122,22,51200
 MV 212,20,52
 MV 208,16,52
 RC 92,13,14336
 MV 204,12,52
 MV 200,8,52
 RW 124,23,49152
 DL 6,8,41,2048
 MV 196,4,52
 MV 192,0,52
 RW 126,23,51200
 MV 224,0,56
 MV 228,4,56
 MV 232,8,56
 DL 7,8,41,3072
 MV 236,12,56
 MV 240,16,56
 MV 244,20,56
 MV 248,24,56
 MV 252,28,56
 s_add_u32 s36, s36, s38
 MA 156,28,60
 MA 152,24,60
 MA 148,20,60
 MA 144,16,60
 MA 140,12,60
 MA 136,8,60
 MA 132,4,60
 MA 128,0,60
 s_waitcnt lgkmcnt(0)
 s_barrier
 v_mov_b32 v3, v2
 v_lshrrev_b32 v24, 3, v3
 v_lshrrev_b32 v25, 4, v3
 v_lshlrev_b32 v25, 1, v25
 v_and_b32 v26, 7, v3
 v_xor_b32 v25, v25, v26
 v_lshlrev_b32 v25, 4, v25
 v_lshl_add_u32 v15, v24, 13, v25
 v_mul_u32_u24 v26, 896, v24
 v_add_u32 v19, v26, v25
 v_add_u32 v16, 64512, v15
 v_add_u32 v20, 6144, v19
 v_add_u32 v17, 129024, v15
 v_add_u32 v21, 12288, v19
 v_add_u32 v18, 193536, v15
 v_add_u32 v22, 18432, v19
 v_and_b32 v24, 15, v3
 v_lshrrev_b32 v25, 4, v3
 v_lshlrev_b32 v26, 2, v25
 v_sub_u32 v29, v24, v26
 v_mov_b32 v31, v29
 v_and_b32 v26, 1, v25
 v_lshrrev_b32 v27, 2, v24
 v_lshl_add_u32 v27, v26, 2, v27
 v_lshlrev_b32 v27, 7, v27
 v_lshrrev_b32 v28, 1, v25
 v_lshl_add_u32 v27, v28, 10, v27
 v_and_b32 v28, 3, v24
 v_lshl_add_u32 v27, v28, 3, v27
 v_lshrrev_b32 v28, 3, v24
 v_lshl_add_u32 v28, v26, 1, v28
 v_xor_b32 v29, 0, v28
 v_lshl_add_u32 v7, v29, 5, v27
 v_xor_b32 v29, 1, v28
 v_lshl_add_u32 v8, v29, 5, v27
 v_xor_b32 v29, 2, v28
 v_lshl_add_u32 v9, v29, 5, v27
 v_xor_b32 v29, 3, v28
 v_lshl_add_u32 v10, v29, 5, v27
 v_mov_b32 v28, 0xff800000
 v_mov_b32 v11, v15
 v_mov_b32 v12, v16
 v_mov_b32 v13, v17
 v_mov_b32 v14, v18
 s_mov_b32 s24, 0x8000
 MV 32,64,96
 MV 36,68,96
 s_add_u32 s42, s59, 0
 MV 40,72,96
 MV 44,76,96
 MV 48,80,96
 MV 52,84,96
 MV 56,88,96
 buffer_load_dwordx4 a[0:3], v1, s[4:7], s42 offen offset:0
 MV 60,92,96
 MV 92,92,100
 MV 88,88,100
 MV 84,84,100
 MV 80,80,100
 MV 76,76,100
 buffer_load_dwordx4 a[4:7], v1, s[4:7], s42 offen offset:1024
 MV 72,72,100
 MV 68,68,100
 MV 64,64,100
 MV 96,64,104
 MV 100,68,104
 MV 104,72,104
 buffer_load_dwordx4 a[8:11], v1, s[4:7], s42 offen offset:2048
 MV 108,76,104
 MV 112,80,104
 MV 116,84,104
 MV 120,88,104
 MV 124,92,104
 MV 156,92,108
 buffer_load_dwordx4 a[12:15], v1, s[4:7], s42 offen offset:3072
 MV 152,88,108
 MV 148,84,108
 MV 144,80,108
 MV 140,76,108
 MV 136,72,108
 MV 132,68,108
 s_add_u32 s42, s59, 4096
 MV 128,64,108
 MV 160,64,112
 MV 164,68,112
 MV 168,72,112
 MV 172,76,112
 MV 176,80,112
 buffer_load_dwordx4 a[16:19], v1, s[4:7], s42 offen offset:0
 MV 180,84,112
 MV 184,88,112
 MV 188,92,112
 MV 220,92,116
 MV 216,88,116
 MV 212,84,116
 buffer_load_dwordx4 a[20:23], v1, s[4:7], s42 offen offset:1024
 MV 208,80,116
 MV 204,76,116
 MV 200,72,116
 MV 196,68,116
 MV 192,64,116
 MV 224,64,120
 buffer_load_dwordx4 a[24:27], v1, s[4:7], s42 offen offset:2048
 MV 228,68,120
 MV 232,72,120
 MV 236,76,120
 MV 240,80,120
 MV 244,84,120
 MV 248,88,120
 buffer_load_dwordx4 a[28:31], v1, s[4:7], s42 offen offset:3072
 MV 252,92,120
 MA 156,92,124
 MA 152,88,124
 MA 148,84,124
 MA 144,80,124
 MA 140,76,124
 MA 136,72,124
 MA 132,68,124
 MA 128,64,124
 s_nop 7
 v_cvt_pk_bf16_f32 v32, v32, v33
 v_cvt_pk_bf16_f32 v33, v34, v35
 v_cvt_pk_bf16_f32 v34, v36, v37
 v_cvt_pk_bf16_f32 v35, v38, v39
 s_add_u32 s76, s78, 0
 buffer_store_dwordx4 v[32:35], v1, s[4:7], s76 offen offset:0 sc1
 v_cvt_pk_bf16_f32 v40, v40, v41
 v_cvt_pk_bf16_f32 v41, v42, v43
 v_cvt_pk_bf16_f32 v42, v44, v45
 v_cvt_pk_bf16_f32 v43, v46, v47
 s_add_u32 s76, s78, 16384
 buffer_store_dwordx4 v[40:43], v1, s[4:7], s76 offen offset:0 sc1
 v_cvt_pk_bf16_f32 v48, v48, v49
 v_cvt_pk_bf16_f32 v49, v50, v51
 v_cvt_pk_bf16_f32 v50, v52, v53
 v_cvt_pk_bf16_f32 v51, v54, v55
 s_add_u32 s76, s78, 32768
 buffer_store_dwordx4 v[48:51], v1, s[4:7], s76 offen offset:0 sc1
 v_cvt_pk_bf16_f32 v56, v56, v57
 v_cvt_pk_bf16_f32 v57, v58, v59
 v_cvt_pk_bf16_f32 v58, v60, v61
 v_cvt_pk_bf16_f32 v59, v62, v63
 s_add_u32 s76, s78, 49152
 buffer_store_dwordx4 v[56:59], v1, s[4:7], s76 offen offset:0 sc1
 v_cvt_pk_bf16_f32 v64, v64, v65
 v_cvt_pk_bf16_f32 v65, v66, v67
 v_cvt_pk_bf16_f32 v66, v68, v69
 v_cvt_pk_bf16_f32 v67, v70, v71
 s_add_u32 s76, s78, 0
 buffer_store_dwordx4 v[64:67], v1, s[4:7], s76 offen offset:1024 sc1
 v_cvt_pk_bf16_f32 v72, v72, v73
 v_cvt_pk_bf16_f32 v73, v74, v75
 v_cvt_pk_bf16_f32 v74, v76, v77
 v_cvt_pk_bf16_f32 v75, v78, v79
 s_add_u32 s76, s78, 16384
 buffer_store_dwordx4 v[72:75], v1, s[4:7], s76 offen offset:1024 sc1
 v_cvt_pk_bf16_f32 v80, v80, v81
 v_cvt_pk_bf16_f32 v81, v82, v83
 v_cvt_pk_bf16_f32 v82, v84, v85
 v_cvt_pk_bf16_f32 v83, v86, v87
 s_add_u32 s76, s78, 32768
 buffer_store_dwordx4 v[80:83], v1, s[4:7], s76 offen offset:1024 sc1
 v_cvt_pk_bf16_f32 v88, v88, v89
 v_cvt_pk_bf16_f32 v89, v90, v91
 v_cvt_pk_bf16_f32 v90, v92, v93
 v_cvt_pk_bf16_f32 v91, v94, v95
 s_add_u32 s76, s78, 49152
 buffer_store_dwordx4 v[88:91], v1, s[4:7], s76 offen offset:1024 sc1
 v_cvt_pk_bf16_f32 v96, v96, v97
 v_cvt_pk_bf16_f32 v97, v98, v99
 v_cvt_pk_bf16_f32 v98, v100, v101
 v_cvt_pk_bf16_f32 v99, v102, v103
 s_add_u32 s76, s78, 0
 buffer_store_dwordx4 v[96:99], v1, s[4:7], s76 offen offset:2048 sc1
 v_cvt_pk_bf16_f32 v104, v104, v105
 v_cvt_pk_bf16_f32 v105, v106, v107
 v_cvt_pk_bf16_f32 v106, v108, v109
 v_cvt_pk_bf16_f32 v107, v110, v111
 s_add_u32 s76, s78, 16384
 buffer_store_dwordx4 v[104:107], v1, s[4:7], s76 offen offset:2048 sc1
 v_cvt_pk_bf16_f32 v112, v112, v113
 v_cvt_pk_bf16_f32 v113, v114, v115
 v_cvt_pk_bf16_f32 v114, v116, v117
 v_cvt_pk_bf16_f32 v115, v118, v119
 s_add_u32 s76, s78, 32768
 buffer_store_dwordx4 v[112:115], v1, s[4:7], s76 offen offset:2048 sc1
 v_cvt_pk_bf16_f32 v120, v120, v121
 v_cvt_pk_bf16_f32 v121, v122, v123
 v_cvt_pk_bf16_f32 v122, v124, v125
 v_cvt_pk_bf16_f32 v123, v126, v127
 s_add_u32 s76, s78, 49152
 buffer_store_dwordx4 v[120:123], v1, s[4:7], s76 offen offset:2048 sc1
 v_cvt_pk_bf16_f32 v128, v128, v129
 v_cvt_pk_bf16_f32 v129, v130, v131
 v_cvt_pk_bf16_f32 v130, v132, v133
 v_cvt_pk_bf16_f32 v131, v134, v135
 s_add_u32 s76, s78, 0
 buffer_store_dwordx4 v[128:131], v1, s[4:7], s76 offen offset:3072 sc1
 v_cvt_pk_bf16_f32 v136, v136, v137
 v_cvt_pk_bf16_f32 v137, v138, v139
 v_cvt_pk_bf16_f32 v138, v140, v141
 v_cvt_pk_bf16_f32 v139, v142, v143
 s_add_u32 s76, s78, 16384
 buffer_store_dwordx4 v[136:139], v1, s[4:7], s76 offen offset:3072 sc1
 v_cvt_pk_bf16_f32 v144, v144, v145
 v_cvt_pk_bf16_f32 v145, v146, v147
 v_cvt_pk_bf16_f32 v146, v148, v149
 v_cvt_pk_bf16_f32 v147, v150, v151
 s_add_u32 s76, s78, 32768
 buffer_store_dwordx4 v[144:147], v1, s[4:7], s76 offen offset:3072 sc1
 v_cvt_pk_bf16_f32 v152, v152, v153
 v_cvt_pk_bf16_f32 v153, v154, v155
 v_cvt_pk_bf16_f32 v154, v156, v157
 v_cvt_pk_bf16_f32 v155, v158, v159
 s_add_u32 s76, s78, 49152
 buffer_store_dwordx4 v[152:155], v1, s[4:7], s76 offen offset:3072 sc1
 v_cvt_pk_bf16_f32 v160, v160, v161
 v_cvt_pk_bf16_f32 v161, v162, v163
 v_cvt_pk_bf16_f32 v162, v164, v165
 v_cvt_pk_bf16_f32 v163, v166, v167
 s_add_u32 s76, s78, 4096
 buffer_store_dwordx4 v[160:163], v1, s[4:7], s76 offen offset:0 sc1
 v_cvt_pk_bf16_f32 v168, v168, v169
 v_cvt_pk_bf16_f32 v169, v170, v171
 v_cvt_pk_bf16_f32 v170, v172, v173
 v_cvt_pk_bf16_f32 v171, v174, v175
 s_add_u32 s76, s78, 20480
 buffer_store_dwordx4 v[168:171], v1, s[4:7], s76 offen offset:0 sc1
 v_cvt_pk_bf16_f32 v176, v176, v177
 v_cvt_pk_bf16_f32 v177, v178, v179
 v_cvt_pk_bf16_f32 v178, v180, v181
 v_cvt_pk_bf16_f32 v179, v182, v183
 s_add_u32 s76, s78, 36864
 buffer_store_dwordx4 v[176:179], v1, s[4:7], s76 offen offset:0 sc1
 v_cvt_pk_bf16_f32 v184, v184, v185
 v_cvt_pk_bf16_f32 v185, v186, v187
 v_cvt_pk_bf16_f32 v186, v188, v189
 v_cvt_pk_bf16_f32 v187, v190, v191
 s_add_u32 s76, s78, 53248
 buffer_store_dwordx4 v[184:187], v1, s[4:7], s76 offen offset:0 sc1
 v_cvt_pk_bf16_f32 v192, v192, v193
 v_cvt_pk_bf16_f32 v193, v194, v195
 v_cvt_pk_bf16_f32 v194, v196, v197
 v_cvt_pk_bf16_f32 v195, v198, v199
 s_add_u32 s76, s78, 4096
 buffer_store_dwordx4 v[192:195], v1, s[4:7], s76 offen offset:1024 sc1
 v_cvt_pk_bf16_f32 v200, v200, v201
 v_cvt_pk_bf16_f32 v201, v202, v203
 v_cvt_pk_bf16_f32 v202, v204, v205
 v_cvt_pk_bf16_f32 v203, v206, v207
 s_add_u32 s76, s78, 20480
 buffer_store_dwordx4 v[200:203], v1, s[4:7], s76 offen offset:1024 sc1
 v_cvt_pk_bf16_f32 v208, v208, v209
 v_cvt_pk_bf16_f32 v209, v210, v211
 v_cvt_pk_bf16_f32 v210, v212, v213
 v_cvt_pk_bf16_f32 v211, v214, v215
 s_add_u32 s76, s78, 36864
 buffer_store_dwordx4 v[208:211], v1, s[4:7], s76 offen offset:1024 sc1
 v_cvt_pk_bf16_f32 v216, v216, v217
 v_cvt_pk_bf16_f32 v217, v218, v219
 v_cvt_pk_bf16_f32 v218, v220, v221
 v_cvt_pk_bf16_f32 v219, v222, v223
 s_add_u32 s76, s78, 53248
 buffer_store_dwordx4 v[216:219], v1, s[4:7], s76 offen offset:1024 sc1
 v_cvt_pk_bf16_f32 v224, v224, v225
 v_cvt_pk_bf16_f32 v225, v226, v227
 v_cvt_pk_bf16_f32 v226, v228, v229
 v_cvt_pk_bf16_f32 v227, v230, v231
 s_add_u32 s76, s78, 4096
 buffer_store_dwordx4 v[224:227], v1, s[4:7], s76 offen offset:2048 sc1
 v_cvt_pk_bf16_f32 v232, v232, v233
 v_cvt_pk_bf16_f32 v233, v234, v235
 v_cvt_pk_bf16_f32 v234, v236, v237
 v_cvt_pk_bf16_f32 v235, v238, v239
 s_add_u32 s76, s78, 20480
 buffer_store_dwordx4 v[232:235], v1, s[4:7], s76 offen offset:2048 sc1
 v_cvt_pk_bf16_f32 v240, v240, v241
 v_cvt_pk_bf16_f32 v241, v242, v243
 v_cvt_pk_bf16_f32 v242, v244, v245
 v_cvt_pk_bf16_f32 v243, v246, v247
 s_add_u32 s76, s78, 36864
 buffer_store_dwordx4 v[240:243], v1, s[4:7], s76 offen offset:2048 sc1
 v_cvt_pk_bf16_f32 v248, v248, v249
 v_cvt_pk_bf16_f32 v249, v250, v251
 v_cvt_pk_bf16_f32 v250, v252, v253
 v_cvt_pk_bf16_f32 v251, v254, v255
 s_add_u32 s76, s78, 53248
 buffer_store_dwordx4 v[248:251], v1, s[4:7], s76 offen offset:2048 sc1
 v_accvgpr_read_b32 v26, a128
 v_accvgpr_read_b32 v27, a129
 v_cvt_pk_bf16_f32 v32, v26, v27
 v_accvgpr_read_b32 v26, a130
 v_accvgpr_read_b32 v27, a131
 v_cvt_pk_bf16_f32 v33, v26, v27
 v_accvgpr_read_b32 v26, a132
 v_accvgpr_read_b32 v27, a133
 v_cvt_pk_bf16_f32 v34, v26, v27
 v_accvgpr_read_b32 v26, a134
 v_accvgpr_read_b32 v27, a135
 v_cvt_pk_bf16_f32 v35, v26, v27
 s_add_u32 s76, s78, 4096
 buffer_store_dwordx4 v[32:35], v1, s[4:7], s76 offen offset:3072 sc1
 v_accvgpr_read_b32 v26, a136
 v_accvgpr_read_b32 v27, a137
 v_cvt_pk_bf16_f32 v40, v26, v27
 v_accvgpr_read_b32 v26, a138
 v_accvgpr_read_b32 v27, a139
 v_cvt_pk_bf16_f32 v41, v26, v27
 v_accvgpr_read_b32 v26, a140
 v_accvgpr_read_b32 v27, a141
 v_cvt_pk_bf16_f32 v42, v26, v27
 v_accvgpr_read_b32 v26, a142
 v_accvgpr_read_b32 v27, a143
 v_cvt_pk_bf16_f32 v43, v26, v27
 s_add_u32 s76, s78, 20480
 buffer_store_dwordx4 v[40:43], v1, s[4:7], s76 offen offset:3072 sc1
 v_accvgpr_read_b32 v26, a144
 v_accvgpr_read_b32 v27, a145
 v_cvt_pk_bf16_f32 v48, v26, v27
 v_accvgpr_read_b32 v26, a146
 v_accvgpr_read_b32 v27, a147
 v_cvt_pk_bf16_f32 v49, v26, v27
 v_accvgpr_read_b32 v26, a148
 v_accvgpr_read_b32 v27, a149
 v_cvt_pk_bf16_f32 v50, v26, v27
 v_accvgpr_read_b32 v26, a150
 v_accvgpr_read_b32 v27, a151
 v_cvt_pk_bf16_f32 v51, v26, v27
 s_add_u32 s76, s78, 36864
 buffer_store_dwordx4 v[48:51], v1, s[4:7], s76 offen offset:3072 sc1
 v_accvgpr_read_b32 v26, a152
 v_accvgpr_read_b32 v27, a153
 v_cvt_pk_bf16_f32 v56, v26, v27
 v_accvgpr_read_b32 v26, a154
 v_accvgpr_read_b32 v27, a155
 v_cvt_pk_bf16_f32 v57, v26, v27
 v_accvgpr_read_b32 v26, a156
 v_accvgpr_read_b32 v27, a157
 v_cvt_pk_bf16_f32 v58, v26, v27
 v_accvgpr_read_b32 v26, a158
 v_accvgpr_read_b32 v27, a159
 v_cvt_pk_bf16_f32 v59, v26, v27
 s_add_u32 s76, s78, 53248
 buffer_store_dwordx4 v[56:59], v1, s[4:7], s76 offen offset:3072 sc1
 s_branch mk_p1done
mk_p1done:
 s_lshl_b32 s28, s21, 20
 s_lshl_b32 s42, s19, 14
 s_add_u32 s28, s28, s42
 s_add_u32 s28, s28, s26
 s_add_u32 s29, s28, 0x1000000
 s_waitcnt vmcnt(32)
 s_barrier
 v_add_u32 v3, s24, v7
 v_add_u32 v4, s24, v8
 v_add_u32 v5, s24, v9
 v_add_u32 v6, s24, v10
 RW 64,3,0
 RW 66,3,2048
 RW 68,4,0
 RW 70,4,2048
 RW 72,5,0
 RW 74,5,2048
 RW 76,6,0
 RW 78,6,2048
 RW 80,3,8192
 RW 82,3,10240
 RW 84,4,8192
 RW 86,4,10240
 RW 88,5,8192
 RW 90,5,10240
 s_waitcnt lgkmcnt(10)
 GAZ 128,64,0
 s_add_u32 s25, s24, 0x18000
 RW 92,6,8192
 s_and_b32 s25, s25, 0x1ffff
 GAZ 132,64,232
 s_add_u32 s24, s24, 0x8000
 RW 94,6,10240
 s_and_b32 s24, s24, 0x1ffff
 GAZ 140,68,232
 RW 96,3,16384
 GAZ 136,68,0
 s_waitcnt lgkmcnt(9)
 RW 98,3,18432
 GAZ 144,72,0
 s_add_u32 m0, s25, s27
 RW 100,4,16384
 GAZ 148,72,232
 RW 102,4,18432
 GAZ 156,76,232
 RW 104,5,16384
 GAZ 152,76,0
 s_waitcnt lgkmcnt(9)
 RW 106,5,18432
 GAZ 160,80,0
 s_add_u32 s41, s36, s37
 RW 108,6,16384
 GAZ 164,80,232
 RW 110,6,18432
 GAZ 172,84,232
 RW 112,3,24576
 GAZ 168,84,0
 s_waitcnt lgkmcnt(9)
 RW 114,3,26624
 GAZ 176,88,0
 RW 116,4,24576
 GAZ 180,88,232
 RW 118,4,26624
 GAZ 188,92,232
 RW 120,5,24576
 GAZ 184,92,0
 s_waitcnt lgkmcnt(9)
 RW 122,5,26624
 GAZ 192,96,0
 RW 124,6,24576
 GAZ 196,96,232
 RW 126,6,26624
 GAZ 204,100,232
 RW 64,3,4096
 GAZ 200,100,0
 s_waitcnt lgkmcnt(9)
 RW 66,3,6144
 DL 11,8,36,0
 GAZ 208,104,0
 RW 68,4,4096
 GAZ 212,104,232
 RW 70,4,6144
 GAZ 220,108,232
 RW 72,5,4096
 GAZ 216,108,0
 s_waitcnt lgkmcnt(9)
 RW 74,5,6144
 DL 12,8,36,1024
 GAZ 224,112,0
 RW 76,6,4096
 GAZ 228,112,232
 RW 78,6,6144
 GAZ 236,116,232
 RW 80,3,12288
 GAZ 232,116,0
 s_waitcnt lgkmcnt(9)
 RW 82,3,14336
 GAZ 240,120,0
 RW 84,4,12288
 DL 13,8,36,2048
 GAZ 244,120,232
 RW 86,4,14336
 GAZ 252,124,232
 RW 88,5,12288
 GAZ 248,124,0
 s_waitcnt lgkmcnt(9)
 RW 90,5,14336
 GA 128,64,4
 RW 92,6,12288
 DL 14,8,36,3072
 GA 132,64,236
 s_add_u32 m0, m0, 0x1000
 RW 94,6,14336
 GA 140,68,236
 RW 96,3,20480
 GA 136,68,4
 s_waitcnt lgkmcnt(9)
 RW 98,3,22528
 GA 144,72,4
 RW 100,4,20480
 GA 148,72,236
 RW 102,4,22528
 GA 156,76,236
 RW 104,5,20480
 GA 152,76,4
 s_waitcnt lgkmcnt(9)
 RW 106,5,22528
 GA 160,80,4
 RW 108,6,20480
 GA 164,80,236
 RW 110,6,22528
 DL 11,8,41,0
 GA 172,84,236
 RW 112,3,28672
 GA 168,84,4
 s_waitcnt lgkmcnt(9)
 RW 114,3,30720
 GA 176,88,4
 RW 116,4,28672
 GA 180,88,236
 RW 118,4,30720
 GA 188,92,236
 RW 120,5,28672
 DL 12,8,41,1024
 GA 184,92,4
 s_waitcnt lgkmcnt(9)
 RW 122,5,30720
 GA 192,96,4
 RW 124,6,28672
 GA 196,96,236
 RW 126,6,30720
 v_add_u32 v3, s24, v7
 GA 204,100,236
 v_add_u32 v4, s24, v8
 v_add_u32 v5, s24, v9
 v_add_u32 v6, s24, v10
 RW 64,3,0
 DL 13,8,41,2048
 GA 200,100,4
 s_waitcnt lgkmcnt(9)
 RW 66,3,2048
 GA 208,104,4
 RW 68,4,0
 GA 212,104,236
 RW 70,4,2048
 GA 220,108,236
 RW 72,5,0
 GA 216,108,4
 s_waitcnt lgkmcnt(9)
 RW 74,5,2048
 DL 14,8,41,3072
 GA 224,112,4
 s_add_u32 s36, s36, s38
 RW 76,6,0
 GA 228,112,236
 RW 78,6,2048
 GA 236,116,236
 RW 80,3,8192
 GA 232,116,4
 s_waitcnt lgkmcnt(9)
 RW 82,3,10240
 GA 240,120,4
 RW 84,4,8192
 GA 244,120,236
 RW 86,4,10240
 GA 252,124,236
 RW 88,5,8192
 GA 248,124,4
 RW 90,5,10240
 s_waitcnt vmcnt(40)
 s_barrier
 s_waitcnt lgkmcnt(10)
 GA 128,64,8
 s_add_u32 s25, s24, 0x18000
 RW 92,6,8192
 s_and_b32 s25, s25, 0x1ffff
 GA 132,64,160
 s_add_u32 s24, s24, 0x8000
 RW 94,6,10240
 s_and_b32 s24, s24, 0x1ffff
 GA 140,68,160
 RW 96,3,16384
 GA 136,68,8
 s_waitcnt lgkmcnt(9)
 RW 98,3,18432
 GA 144,72,8
 s_add_u32 m0, s25, s27
 RW 100,4,16384
 GA 148,72,160
 RW 102,4,18432
 GA 156,76,160
 RW 104,5,16384
 GA 152,76,8
 s_waitcnt lgkmcnt(9)
 RW 106,5,18432
 GA 160,80,8
 s_add_u32 s41, s36, s37
 RW 108,6,16384
 GA 164,80,160
 RW 110,6,18432
 GA 172,84,160
 RW 112,3,24576
 GA 168,84,8
 s_waitcnt lgkmcnt(9)
 RW 114,3,26624
 GA 176,88,8
 RW 116,4,24576
 GA 180,88,160
 RW 118,4,26624
 GA 188,92,160
 RW 120,5,24576
 GA 184,92,8
 s_waitcnt lgkmcnt(9)
 RW 122,5,26624
 GA 192,96,8
 RW 124,6,24576
 GA 196,96,160
 RW 126,6,26624
 GA 204,100,160
 RW 64,3,4096
 GA 200,100,8
 s_waitcnt lgkmcnt(9)
 RW 66,3,6144
 DL 11,8,36,0
 GA 208,104,8
 RW 68,4,4096
 GA 212,104,160
 RW 70,4,6144
 GA 220,108,160
 RW 72,5,4096
 GA 216,108,8
 s_waitcnt lgkmcnt(9)
 RW 74,5,6144
 DL 12,8,36,1024
 GA 224,112,8
 RW 76,6,4096
 GA 228,112,160
 RW 78,6,6144
 GA 236,116,160
 RW 80,3,12288
 GA 232,116,8
 s_waitcnt lgkmcnt(9)
 RW 82,3,14336
 GA 240,120,8
 RW 84,4,12288
 DL 13,8,36,2048
 GA 244,120,160
 RW 86,4,14336
 GA 252,124,160
 RW 88,5,12288
 GA 248,124,8
 s_waitcnt lgkmcnt(9)
 RW 90,5,14336
 GA 128,64,12
 RW 92,6,12288
 DL 14,8,36,3072
 GA 132,64,164
 s_add_u32 m0, m0, 0x1000
 RW 94,6,14336
 GA 140,68,164
 RW 96,3,20480
 GA 136,68,12
 s_waitcnt lgkmcnt(9)
 RW 98,3,22528
 GA 144,72,12
 RW 100,4,20480
 GA 148,72,164
 RW 102,4,22528
 GA 156,76,164
 RW 104,5,20480
 GA 152,76,12
 s_waitcnt lgkmcnt(9)
 RW 106,5,22528
 GA 160,80,12
 RW 108,6,20480
 GA 164,80,164
 RW 110,6,22528
 DL 11,8,41,0
 GA 172,84,164
 RW 112,3,28672
 GA 168,84,12
 s_waitcnt lgkmcnt(9)
 RW 114,3,30720
 GA 176,88,12
 RW 116,4,28672
 GA 180,88,164
 RW 118,4,30720
 GA 188,92,164
 RW 120,5,28672
 DL 12,8,41,1024
 GA 184,92,12
 s_waitcnt lgkmcnt(9)
 RW 122,5,30720
 GA 192,96,12
 RW 124,6,28672
 GA 196,96,164
 RW 126,6,30720
 v_add_u32 v3, s24, v7
 GA 204,100,164
 v_add_u32 v4, s24, v8
 v_add_u32 v5, s24, v9
 v_add_u32 v6, s24, v10
 RW 64,3,0
 DL 13,8,41,2048
 GA 200,100,12
 s_waitcnt lgkmcnt(9)
 RW 66,3,2048
 GA 208,104,12
 RW 68,4,0
 GA 212,104,164
 RW 70,4,2048
 GA 220,108,164
 RW 72,5,0
 GA 216,108,12
 s_waitcnt lgkmcnt(9)
 RW 74,5,2048
 DL 14,8,41,3072
 GA 224,112,12
 s_add_u32 s36, s36, s38
 RW 76,6,0
 GA 228,112,164
 RW 78,6,2048
 GA 236,116,164
 RW 80,3,8192
 GA 232,116,12
 s_waitcnt lgkmcnt(9)
 RW 82,3,10240
 GA 240,120,12
 RW 84,4,8192
 GA 244,120,164
 RW 86,4,10240
 GA 252,124,164
 RW 88,5,8192
 GA 248,124,12
 RW 90,5,10240
 s_waitcnt vmcnt(8)
 s_barrier
 s_add_u32 s41, s21, 0
 s_cmp_eq_u32 s20, 0
 s_cbranch_scc0 mk_sg_16
 s_lshl_b32 s44, s41, 8
 v_mov_b32 v29, s44
 v_mov_b32 v30, 1
 s_mov_b64 exec, 1
 global_atomic_add v29, v30, s[96:97] sc1
 s_mov_b64 exec, -1
mk_sg_16:
 s_waitcnt lgkmcnt(10)
 GA 128,64,16
 s_add_u32 s25, s24, 0x18000
 RW 92,6,8192
 s_and_b32 s25, s25, 0x1ffff
 GA 132,64,168
 s_add_u32 s24, s24, 0x8000
 RW 94,6,10240
 s_and_b32 s24, s24, 0x1ffff
 GA 140,68,168
 RW 96,3,16384
 GA 136,68,16
 s_waitcnt lgkmcnt(9)
 RW 98,3,18432
 GA 144,72,16
 s_add_u32 m0, s25, s27
 RW 100,4,16384
 GA 148,72,168
 RW 102,4,18432
 GA 156,76,168
 RW 104,5,16384
 GA 152,76,16
 s_waitcnt lgkmcnt(9)
 RW 106,5,18432
 GA 160,80,16
 s_add_u32 s41, s36, s37
 RW 108,6,16384
 GA 164,80,168
 RW 110,6,18432
 GA 172,84,168
 RW 112,3,24576
 GA 168,84,16
 s_waitcnt lgkmcnt(9)
 RW 114,3,26624
 GA 176,88,16
 RW 116,4,24576
 GA 180,88,168
 RW 118,4,26624
 GA 188,92,168
 RW 120,5,24576
 GA 184,92,16
 s_waitcnt lgkmcnt(9)
 RW 122,5,26624
 GA 192,96,16
 RW 124,6,24576
 GA 196,96,168
 RW 126,6,26624
 GA 204,100,168
 RW 64,3,4096
 GA 200,100,16
 s_waitcnt lgkmcnt(9)
 RW 66,3,6144
 DL 11,8,36,0
 GA 208,104,16
 RW 68,4,4096
 GA 212,104,168
 RW 70,4,6144
 GA 220,108,168
 RW 72,5,4096
 GA 216,108,16
 s_waitcnt lgkmcnt(9)
 RW 74,5,6144
 DL 12,8,36,1024
 GA 224,112,16
 RW 76,6,4096
 GA 228,112,168
 RW 78,6,6144
 GA 236,116,168
 RW 80,3,12288
 GA 232,116,16
 s_waitcnt lgkmcnt(9)
 RW 82,3,14336
 GA 240,120,16
 RW 84,4,12288
 DL 13,8,36,2048
 GA 244,120,168
 RW 86,4,14336
 GA 252,124,168
 RW 88,5,12288
 GA 248,124,16
 s_waitcnt lgkmcnt(9)
 RW 90,5,14336
 GA 128,64,20
 RW 92,6,12288
 DL 14,8,36,3072
 GA 132,64,172
 s_add_u32 m0, m0, 0x1000
 RW 94,6,14336
 GA 140,68,172
 RW 96,3,20480
 GA 136,68,20
 s_waitcnt lgkmcnt(9)
 RW 98,3,22528
 GA 144,72,20
 RW 100,4,20480
 GA 148,72,172
 RW 102,4,22528
 GA 156,76,172
 RW 104,5,20480
 GA 152,76,20
 s_waitcnt lgkmcnt(9)
 RW 106,5,22528
 GA 160,80,20
 RW 108,6,20480
 GA 164,80,172
 RW 110,6,22528
 DL 11,8,41,0
 GA 172,84,172
 RW 112,3,28672
 GA 168,84,20
 s_waitcnt lgkmcnt(9)
 RW 114,3,30720
 GA 176,88,20
 RW 116,4,28672
 GA 180,88,172
 RW 118,4,30720
 GA 188,92,172
 RW 120,5,28672
 DL 12,8,41,1024
 GA 184,92,20
 s_waitcnt lgkmcnt(9)
 RW 122,5,30720
 GA 192,96,20
 RW 124,6,28672
 GA 196,96,172
 RW 126,6,30720
 v_add_u32 v3, s24, v7
 GA 204,100,172
 v_add_u32 v4, s24, v8
 v_add_u32 v5, s24, v9
 v_add_u32 v6, s24, v10
 RW 64,3,0
 DL 13,8,41,2048
 GA 200,100,20
 s_waitcnt lgkmcnt(9)
 RW 66,3,2048
 GA 208,104,20
 RW 68,4,0
 GA 212,104,172
 RW 70,4,2048
 GA 220,108,172
 RW 72,5,0
 GA 216,108,20
 s_waitcnt lgkmcnt(9)
 RW 74,5,2048
 DL 14,8,41,3072
 GA 224,112,20
 s_add_u32 s36, s36, s38
 RW 76,6,0
 GA 228,112,172
 RW 78,6,2048
 GA 236,116,172
 RW 80,3,8192
 GA 232,116,20
 s_waitcnt lgkmcnt(9)
 RW 82,3,10240
 GA 240,120,20
 RW 84,4,8192
 GA 244,120,172
 RW 86,4,10240
 GA 252,124,172
 RW 88,5,8192
 GA 248,124,20
 RW 90,5,10240
 s_waitcnt vmcnt(8)
 s_barrier
 s_cmp_eq_u32 s20, 0
 s_cbranch_scc0 mk_kp_17
 s_add_u32 s41, s21, 0
 s_lshl_b32 s41, s41, 8
 v_mov_b32 v29, s41
 global_load_dword v30, v29, s[96:97] sc1
mk_kp_17:
 s_waitcnt lgkmcnt(10)
 GA 128,64,24
 s_add_u32 s25, s24, 0x18000
 RW 92,6,8192
 s_and_b32 s25, s25, 0x1ffff
 GA 132,64,176
 s_add_u32 s24, s24, 0x8000
 RW 94,6,10240
 s_and_b32 s24, s24, 0x1ffff
 GA 140,68,176
 RW 96,3,16384
 GA 136,68,24
 s_waitcnt lgkmcnt(9)
 RW 98,3,18432
 GA 144,72,24
 s_add_u32 m0, s25, s27
 RW 100,4,16384
 GA 148,72,176
 RW 102,4,18432
 GA 156,76,176
 RW 104,5,16384
 GA 152,76,24
 s_waitcnt lgkmcnt(9)
 RW 106,5,18432
 GA 160,80,24
 s_add_u32 s41, s36, s37
 RW 108,6,16384
 GA 164,80,176
 RW 110,6,18432
 GA 172,84,176
 RW 112,3,24576
 GA 168,84,24
 s_waitcnt lgkmcnt(9)
 RW 114,3,26624
 GA 176,88,24
 RW 116,4,24576
 GA 180,88,176
 RW 118,4,26624
 GA 188,92,176
 RW 120,5,24576
 GA 184,92,24
 s_waitcnt lgkmcnt(9)
 RW 122,5,26624
 GA 192,96,24
 RW 124,6,24576
 GA 196,96,176
 RW 126,6,26624
 GA 204,100,176
 RW 64,3,4096
 GA 200,100,24
 s_waitcnt lgkmcnt(9)
 RW 66,3,6144
 DL 11,8,36,0
 GA 208,104,24
 RW 68,4,4096
 GA 212,104,176
 RW 70,4,6144
 GA 220,108,176
 RW 72,5,4096
 GA 216,108,24
 s_waitcnt lgkmcnt(9)
 RW 74,5,6144
 DL 12,8,36,1024
 GA 224,112,24
 RW 76,6,4096
 GA 228,112,176
 RW 78,6,6144
 GA 236,116,176
 RW 80,3,12288
 GA 232,116,24
 s_waitcnt lgkmcnt(9)
 RW 82,3,14336
 GA 240,120,24
 RW 84,4,12288
 DL 13,8,36,2048
 GA 244,120,176
 RW 86,4,14336
 GA 252,124,176
 RW 88,5,12288
 GA 248,124,24
 s_waitcnt lgkmcnt(9)
 RW 90,5,14336
 GA 128,64,28
 RW 92,6,12288
 DL 14,8,36,3072
 GA 132,64,180
 s_add_u32 m0, m0, 0x1000
 RW 94,6,14336
 GA 140,68,180
 RW 96,3,20480
 GA 136,68,28
 s_waitcnt lgkmcnt(9)
 RW 98,3,22528
 GA 144,72,28
 RW 100,4,20480
 GA 148,72,180
 RW 102,4,22528
 GA 156,76,180
 RW 104,5,20480
 GA 152,76,28
 s_waitcnt lgkmcnt(9)
 RW 106,5,22528
 GA 160,80,28
 RW 108,6,20480
 GA 164,80,180
 RW 110,6,22528
 DL 11,8,41,0
 GA 172,84,180
 RW 112,3,28672
 GA 168,84,28
 s_waitcnt lgkmcnt(9)
 RW 114,3,30720
 GA 176,88,28
 RW 116,4,28672
 GA 180,88,180
 RW 118,4,30720
 GA 188,92,180
 RW 120,5,28672
 DL 12,8,41,1024
 GA 184,92,28
 s_waitcnt lgkmcnt(9)
 RW 122,5,30720
 GA 192,96,28
 RW 124,6,28672
 GA 196,96,180
 RW 126,6,30720
 v_add_u32 v3, s24, v7
 GA 204,100,180
 v_add_u32 v4, s24, v8
 v_add_u32 v5, s24, v9
 v_add_u32 v6, s24, v10
 RW 64,3,0
 DL 13,8,41,2048
 GA 200,100,28
 s_waitcnt lgkmcnt(9)
 RW 66,3,2048
 GA 208,104,28
 RW 68,4,0
 GA 212,104,180
 RW 70,4,2048
 GA 220,108,180
 RW 72,5,0
 GA 216,108,28
 s_waitcnt lgkmcnt(9)
 RW 74,5,2048
 DL 14,8,41,3072
 GA 224,112,28
 s_add_u32 s36, s36, s38
 RW 76,6,0
 GA 228,112,180
 RW 78,6,2048
 GA 236,116,180
 RW 80,3,8192
 GA 232,116,28
 s_waitcnt lgkmcnt(9)
 RW 82,3,10240
 GA 240,120,28
 RW 84,4,8192
 GA 244,120,180
 RW 86,4,10240
 GA 252,124,180
 RW 88,5,8192
 GA 248,124,28
 RW 90,5,10240
 s_cmp_eq_u32 s20, 0
 s_cbranch_scc0 mk_kvw_18
 s_waitcnt vmcnt(8)
 v_readfirstlane_b32 s43, v30
 s_nop 0
 s_cmp_ge_u32 s43, 16
 s_cbranch_scc1 mk_kvw_18
 s_add_u32 s41, s21, 0
 s_lshl_b32 s44, s41, 8
 v_mov_b32 v29, s44
 s_mov_b32 s44, 0
mk_sp_19:
 global_load_dword v30, v29, s[96:97] sc1
 s_waitcnt vmcnt(0)
 v_readfirstlane_b32 s43, v30
 s_add_u32 s44, s44, 1
 s_bfe_u32 s43, s43, 0x100000
 s_cmp_ge_u32 s43, 16
 s_cbranch_scc1 mk_sp_19_ok
 s_sleep 2
 s_cmp_lt_u32 s44, 0x40000
 s_cbranch_scc1 mk_sp_19
mk_sp_19_ok:
mk_kvw_18:
 s_waitcnt vmcnt(8)
 s_barrier
 s_waitcnt lgkmcnt(10)
 GA 128,64,208
 s_add_u32 s25, s24, 0x18000
 RW 92,6,8192
 s_and_b32 s25, s25, 0x1ffff
 GA 132,64,184
 s_add_u32 s24, s24, 0x8000
 RW 94,6,10240
 s_and_b32 s24, s24, 0x1ffff
 GA 140,68,184
 RW 96,3,16384
 GA 136,68,208
 s_waitcnt lgkmcnt(9)
 RW 98,3,18432
 GA 144,72,208
 s_add_u32 m0, s25, s26
 RW 100,4,16384
 GA 148,72,184
 RW 102,4,18432
 GA 156,76,184
 RW 104,5,16384
 GA 152,76,208
 s_waitcnt lgkmcnt(9)
 RW 106,5,18432
 GA 160,80,208
 RW 108,6,16384
 GA 164,80,184
 RW 110,6,18432
 GA 172,84,184
 RW 112,3,24576
 GA 168,84,208
 s_waitcnt lgkmcnt(9)
 RW 114,3,26624
 GA 176,88,208
 RW 116,4,24576
 GA 180,88,184
 RW 118,4,26624
 GA 188,92,184
 RW 120,5,24576
 DL 1,4,28,0
 GA 184,92,208
 s_waitcnt lgkmcnt(9)
 RW 122,5,26624
 GA 192,96,208
 RW 124,6,24576
 GA 196,96,184
 RW 126,6,26624
 GA 204,100,184
 RW 64,3,4096
 GA 200,100,208
 s_waitcnt lgkmcnt(9)
 RW 66,3,6144
 DL 1,4,28,1024
 GA 208,104,208
 RW 68,4,4096
 GA 212,104,184
 RW 70,4,6144
 GA 220,108,184
 RW 72,5,4096
 GA 216,108,208
 s_waitcnt lgkmcnt(9)
 RW 74,5,6144
 DL 1,4,28,2048
 GA 224,112,208
 RW 76,6,4096
 GA 228,112,184
 RW 78,6,6144
 GA 236,116,184
 RW 80,3,12288
 GA 232,116,208
 s_waitcnt lgkmcnt(9)
 RW 82,3,14336
 GA 240,120,208
 RW 84,4,12288
 DL 1,4,28,3072
 GA 244,120,184
 s_add_u32 s28, s28, 0x4000
 RW 86,4,14336
 GA 252,124,184
 RW 88,5,12288
 GA 248,124,208
 s_waitcnt lgkmcnt(9)
 RW 90,5,14336
 GA 128,64,212
 RW 92,6,12288
 GA 132,64,188
 RW 94,6,14336
 GA 140,68,188
 RW 96,3,20480
 GA 136,68,212
 s_waitcnt lgkmcnt(9)
 RW 98,3,22528
 GA 144,72,212
 RW 100,4,20480
 GA 148,72,188
 RW 102,4,22528
 GA 156,76,188
 RW 104,5,20480
 GA 152,76,212
 s_waitcnt lgkmcnt(9)
 RW 106,5,22528
 GA 160,80,212
 RW 108,6,20480
 GA 164,80,188
 RW 110,6,22528
 GA 172,84,188
 RW 112,3,28672
 GA 168,84,212
 s_waitcnt lgkmcnt(9)
 RW 114,3,30720
 GA 176,88,212
 RW 116,4,28672
 GA 180,88,188
 RW 118,4,30720
 GA 188,92,188
 RW 120,5,28672
 GA 184,92,212
 s_waitcnt lgkmcnt(9)
 RW 122,5,30720
 GA 192,96,212
 RW 124,6,28672
 GA 196,96,188
 RW 126,6,30720
 v_add_u32 v3, s24, v7
 GA 204,100,188
 v_add_u32 v4, s24, v8
 v_add_u32 v5, s24, v9
 v_add_u32 v6, s24, v10
 RW 64,3,0
 GA 200,100,212
 s_waitcnt lgkmcnt(9)
 RW 66,3,2048
 GA 208,104,212
 RW 68,4,0
 GA 212,104,188
 RW 70,4,2048
 GA 220,108,188
 RW 72,5,0
 GA 216,108,212
 s_waitcnt lgkmcnt(9)
 RW 74,5,2048
 GA 224,112,212
 RW 76,6,0
 GA 228,112,188
 RW 78,6,2048
 GA 236,116,188
 RW 80,3,8192
 GA 232,116,212
 s_waitcnt lgkmcnt(9)
 RW 82,3,10240
 GA 240,120,212
 RW 84,4,8192
 GA 244,120,188
 RW 86,4,10240
 GA 252,124,188
 RW 88,5,8192
 GA 248,124,212
 RW 90,5,10240
 s_waitcnt vmcnt(4)
 s_barrier
 s_waitcnt lgkmcnt(10)
 GA 128,64,216
 s_add_u32 s25, s24, 0x18000
 RW 92,6,8192
 s_and_b32 s25, s25, 0x1ffff
 GA 132,64,192
 s_add_u32 s24, s24, 0x8000
 RW 94,6,10240
 s_and_b32 s24, s24, 0x1ffff
 GA 140,68,192
 RW 96,3,16384
 GA 136,68,216
 s_waitcnt lgkmcnt(9)
 RW 98,3,18432
 GA 144,72,216
 s_add_u32 m0, s25, s26
 RW 100,4,16384
 GA 148,72,192
 RW 102,4,18432
 GA 156,76,192
 RW 104,5,16384
 GA 152,76,216
 s_waitcnt lgkmcnt(9)
 RW 106,5,18432
 GA 160,80,216
 RW 108,6,16384
 GA 164,80,192
 RW 110,6,18432
 GA 172,84,192
 RW 112,3,24576
 GA 168,84,216
 s_waitcnt lgkmcnt(9)
 RW 114,3,26624
 GA 176,88,216
 RW 116,4,24576
 GA 180,88,192
 RW 118,4,26624
 GA 188,92,192
 RW 120,5,24576
 DL 1,4,28,0
 GA 184,92,216
 s_waitcnt lgkmcnt(9)
 RW 122,5,26624
 GA 192,96,216
 RW 124,6,24576
 GA 196,96,192
 RW 126,6,26624
 GA 204,100,192
 RW 64,3,4096
 GA 200,100,216
 s_waitcnt lgkmcnt(9)
 RW 66,3,6144
 DL 1,4,28,1024
 GA 208,104,216
 RW 68,4,4096
 GA 212,104,192
 RW 70,4,6144
 GA 220,108,192
 RW 72,5,4096
 GA 216,108,216
 s_waitcnt lgkmcnt(9)
 RW 74,5,6144
 DL 1,4,28,2048
 GA 224,112,216
 RW 76,6,4096
 GA 228,112,192
 RW 78,6,6144
 GA 236,116,192
 RW 80,3,12288
 GA 232,116,216
 s_waitcnt lgkmcnt(9)
 RW 82,3,14336
 GA 240,120,216
 RW 84,4,12288
 DL 1,4,28,3072
 GA 244,120,192
 s_add_u32 s28, s28, 0x4000
 RW 86,4,14336
 GA 252,124,192
 RW 88,5,12288
 GA 248,124,216
 s_waitcnt lgkmcnt(9)
 RW 90,5,14336
 s_add_u32 m0, s25, s18
 GA 128,64,220
 RW 92,6,12288
 GA 132,64,196
 RW 94,6,14336
 GA 140,68,196
 RW 96,3,20480
 GA 136,68,220
 s_waitcnt lgkmcnt(9)
 RW 98,3,22528
 GA 144,72,220
 RW 100,4,20480
 GA 148,72,196
 RW 102,4,22528
 GA 156,76,196
 RW 104,5,20480
 GA 152,76,220
 s_waitcnt lgkmcnt(9)
 RW 106,5,22528
 GA 160,80,220
 RW 108,6,20480
 GA 164,80,196
 RW 110,6,22528
 DL 1,4,29,0
 GA 172,84,196
 RW 112,3,28672
 GA 168,84,220
 s_waitcnt lgkmcnt(9)
 RW 114,3,30720
 GA 176,88,220
 RW 116,4,28672
 GA 180,88,196
 RW 118,4,30720
 GA 188,92,196
 RW 120,5,28672
 DL 1,4,29,1024
 GA 184,92,220
 s_waitcnt lgkmcnt(9)
 RW 122,5,30720
 GA 192,96,220
 RW 124,6,28672
 GA 196,96,196
 RW 126,6,30720
 v_add_u32 v3, s24, v7
 GA 204,100,196
 v_add_u32 v4, s24, v8
 v_add_u32 v5, s24, v9
 v_add_u32 v6, s24, v10
 RW 64,3,0
 DL 1,4,29,2048
 GA 200,100,220
 s_waitcnt lgkmcnt(9)
 RW 66,3,2048
 GA 208,104,220
 RW 68,4,0
 GA 212,104,196
 RW 70,4,2048
 GA 220,108,196
 RW 72,5,0
 GA 216,108,220
 s_waitcnt lgkmcnt(9)
 RW 74,5,2048
 DL 1,4,29,3072
 GA 224,112,220
 s_add_u32 s29, s29, 0x4000
 RW 76,6,0
 GA 228,112,196
 RW 78,6,2048
 GA 236,116,196
 RW 80,3,8192
 GA 232,116,220
 s_waitcnt lgkmcnt(9)
 RW 82,3,10240
 GA 240,120,220
 RW 84,4,8192
 GA 244,120,196
 RW 86,4,10240
 GA 252,124,196
 RW 88,5,8192
 GA 248,124,220
 RW 90,5,10240
 s_waitcnt vmcnt(8)
 s_barrier
 s_waitcnt lgkmcnt(10)
 GA 128,64,224
 s_add_u32 s25, s24, 0x18000
 RW 92,6,8192
 s_and_b32 s25, s25, 0x1ffff
 GA 132,64,200
 s_add_u32 s24, s24, 0x8000
 RW 94,6,10240
 s_and_b32 s24, s24, 0x1ffff
 GA 140,68,200
 RW 96,3,16384
 GA 136,68,224
 s_waitcnt lgkmcnt(9)
 RW 98,3,18432
 GA 144,72,224
 s_add_u32 m0, s25, s26
 RW 100,4,16384
 GA 148,72,200
 RW 102,4,18432
 GA 156,76,200
 RW 104,5,16384
 GA 152,76,224
 s_waitcnt lgkmcnt(9)
 RW 106,5,18432
 GA 160,80,224
 RW 108,6,16384
 GA 164,80,200
 RW 110,6,18432
 GA 172,84,200
 RW 112,3,24576
 GA 168,84,224
 s_waitcnt lgkmcnt(9)
 RW 114,3,26624
 GA 176,88,224
 RW 116,4,24576
 GA 180,88,200
 RW 118,4,26624
 GA 188,92,200
 RW 120,5,24576
 DL 1,4,28,0
 GA 184,92,224
 s_waitcnt lgkmcnt(9)
 RW 122,5,26624
 GA 192,96,224
 RW 124,6,24576
 GA 196,96,200
 RW 126,6,26624
 GA 204,100,200
 RW 64,3,4096
 GA 200,100,224
 s_waitcnt lgkmcnt(9)
 RW 66,3,6144
 DL 1,4,28,1024
 GA 208,104,224
 RW 68,4,4096
 GA 212,104,200
 RW 70,4,6144
 GA 220,108,200
 RW 72,5,4096
 GA 216,108,224
 s_waitcnt lgkmcnt(9)
 RW 74,5,6144
 DL 1,4,28,2048
 GA 224,112,224
 RW 76,6,4096
 GA 228,112,200
 RW 78,6,6144
 GA 236,116,200
 RW 80,3,12288
 GA 232,116,224
 s_waitcnt lgkmcnt(9)
 RW 82,3,14336
 GA 240,120,224
 RW 84,4,12288
 DL 1,4,28,3072
 GA 244,120,200
 s_add_u32 s28, s28, 0x4000
 RW 86,4,14336
 GA 252,124,200
 RW 88,5,12288
 GA 248,124,224
 s_waitcnt lgkmcnt(9)
 RW 90,5,14336
 s_add_u32 m0, s25, s18
 GA 128,64,228
 RW 92,6,12288
 GA 132,64,204
 RW 94,6,14336
 GA 140,68,204
 RW 96,3,20480
 GA 136,68,228
 s_waitcnt lgkmcnt(9)
 RW 98,3,22528
 GA 144,72,228
 RW 100,4,20480
 GA 148,72,204
 RW 102,4,22528
 GA 156,76,204
 RW 104,5,20480
 GA 152,76,228
 s_waitcnt lgkmcnt(9)
 RW 106,5,22528
 GA 160,80,228
 RW 108,6,20480
 GA 164,80,204
 RW 110,6,22528
 DL 1,4,29,0
 GA 172,84,204
 RW 112,3,28672
 GA 168,84,228
 s_waitcnt lgkmcnt(9)
 RW 114,3,30720
 GA 176,88,228
 RW 116,4,28672
 GA 180,88,204
 RW 118,4,30720
 GA 188,92,204
 RW 120,5,28672
 DL 1,4,29,1024
 GA 184,92,228
 s_waitcnt lgkmcnt(9)
 RW 122,5,30720
 GA 192,96,228
 RW 124,6,28672
 GA 196,96,204
 RW 126,6,30720
 v_add_u32 v2, s24, v1
 GA 204,100,204
 RC 64,2,0
 DL 1,4,29,2048
 GA 200,100,228
 s_waitcnt lgkmcnt(9)
 DL 1,4,29,3072
 GA 208,104,228
 RC 68,2,8192
 GA 212,104,204
 s_add_u32 s29, s29, 0x4000
 GA 220,108,204
 RC 72,2,1024
 GA 216,108,228
 s_waitcnt lgkmcnt(7)
 GA 224,112,228
 RC 76,2,9216
 GA 228,112,204
 GA 236,116,204
 RC 80,2,2048
 GA 232,116,228
 s_waitcnt lgkmcnt(5)
 GA 240,120,228
 RC 84,2,10240
 GA 244,120,204
 GA 252,124,204
 RC 88,2,3072
 RC 92,2,11264
 RC 96,2,4096
 RC 100,2,12288
 RC 104,2,5120
 RC 108,2,13312
 RC 112,2,6144
 RC 116,2,14336
 GA 248,124,228
mk_att:
 s_cmp_eq_u32 s35, 0
 s_cmp_eq_u32 s99, 0x7fffffff
 s_cbranch_scc1 mk_tl_20
 s_lshl_b32 s41, s2, 2
 s_add_u32 s41, s41, s20
 s_mul_i32 s98, s41, 3584
 s_mul_i32 s99, s41, 1664
 s_mov_b32 s91, 0x20000
 v_min_u32 v29, 432, v1
 v_lshlrev_b32 v29, 3, v29
 s_mov_b32 s88, s14
 s_mov_b32 s89, s15
 s_mov_b32 s90, 3670016
 buffer_load_dword v95, v29, s[88:91], s98 offen
 v_min_u32 v29, 192, v1
 v_lshlrev_b32 v29, 3, v29
 s_mov_b32 s88, s80
 s_mov_b32 s89, s81
 s_mov_b32 s90, 1605632
 buffer_load_dword v95, v29, s[88:91], s99 offen
 v_min_u32 v29, 192, v1
 v_lshlrev_b32 v29, 3, v29
 s_mov_b32 s88, s82
 s_mov_b32 s89, s83
 s_mov_b32 s90, 1605632
 buffer_load_dword v95, v29, s[88:91], s99 offen
 v_min_u32 v29, 192, v1
 v_lshlrev_b32 v29, 3, v29
 s_mov_b32 s88, s84
 s_mov_b32 s89, s85
 s_mov_b32 s90, 1605632
 buffer_load_dword v95, v29, s[88:91], s99 offen
 s_mov_b32 s99, 0x7fffffff
mk_tl_20:
 v_mov_b32 v32, 0
 v_mov_b32 v33, 0
 v_mov_b32 v34, 0
 v_mov_b32 v35, 0
 v_mov_b32 v36, 0
 v_mov_b32 v37, 0
 v_mov_b32 v38, 0
 v_mov_b32 v39, 0
 v_mov_b32 v24, 0
 v_mov_b32 v25, 0
 s_mov_b64 s[32:33], -1
 s_mov_b32 s34, 0xff800000
 s_cmp_eq_u32 s35, 1
 s_cselect_b32 s31, 3, s20
 s_cselect_b32 s41, 1000, 0
 v_add_u32 v23, s41, v31
 s_sub_u32 s30, s40, 4
 s_lshr_b32 s30, s30, 1
 s_cmp_eq_u32 s35, 2
 s_cbranch_scc1 mk_nq
 s_mov_b32 s8, s14
 s_mov_b32 s9, s15
 s_lshl_b32 s36, s21, 2
 s_add_u32 s36, s36, s20
 s_mul_i32 s36, s36, 57344
 s_mov_b32 s37, 28672
 s_mov_b32 s38, 128
 v_mov_b32 v11, v19
 v_mov_b32 v12, v20
 v_mov_b32 v13, v21
 v_mov_b32 v14, v22
 s_branch mk_nd
mk_nq:
 s_mov_b32 s8, s12
 s_mov_b32 s9, s13
 s_lshl_b32 s36, s21, 9
 s_lshl_b32 s41, s20, 7
 s_add_u32 s36, s36, s41
 s_mov_b32 s37, 262144
 s_mov_b32 s38, 524288
 v_mov_b32 v11, v15
 v_mov_b32 v12, v16
 v_mov_b32 v13, v17
 v_mov_b32 v14, v18
mk_nd:
 s_nop 4
 v_cvt_pk_bf16_f32 v64, v128, v129
 v_cvt_pk_bf16_f32 v65, v130, v131
 v_cvt_pk_bf16_f32 v66, v136, v137
 v_cvt_pk_bf16_f32 v67, v138, v139
 ZZ 128,32
 v_accvgpr_write_b32 a0, v64
 v_accvgpr_write_b32 a1, v65
 v_accvgpr_write_b32 a2, v66
 v_accvgpr_write_b32 a3, v67
 ZZ 136,32
 v_cvt_pk_bf16_f32 v68, v132, v133
 v_cvt_pk_bf16_f32 v69, v134, v135
 v_cvt_pk_bf16_f32 v70, v140, v141
 v_cvt_pk_bf16_f32 v71, v142, v143
 ZZ 132,32
 v_accvgpr_write_b32 a32, v68
 v_accvgpr_write_b32 a33, v69
 v_accvgpr_write_b32 a34, v70
 v_accvgpr_write_b32 a35, v71
 ZZ 140,32
 v_cvt_pk_bf16_f32 v72, v144, v145
 v_cvt_pk_bf16_f32 v73, v146, v147
 v_cvt_pk_bf16_f32 v74, v152, v153
 v_cvt_pk_bf16_f32 v75, v154, v155
 ZZ 144,32
 v_accvgpr_write_b32 a4, v72
 v_accvgpr_write_b32 a5, v73
 v_accvgpr_write_b32 a6, v74
 v_accvgpr_write_b32 a7, v75
 ZZ 152,32
 v_cvt_pk_bf16_f32 v76, v148, v149
 v_cvt_pk_bf16_f32 v77, v150, v151
 v_cvt_pk_bf16_f32 v78, v156, v157
 v_cvt_pk_bf16_f32 v79, v158, v159
 ZZ 148,32
 v_accvgpr_write_b32 a36, v76
 v_accvgpr_write_b32 a37, v77
 v_accvgpr_write_b32 a38, v78
 v_accvgpr_write_b32 a39, v79
 ZZ 156,32
 v_cvt_pk_bf16_f32 v64, v160, v161
 v_cvt_pk_bf16_f32 v65, v162, v163
 v_cvt_pk_bf16_f32 v66, v168, v169
 v_cvt_pk_bf16_f32 v67, v170, v171
 ZZ 160,32
 v_accvgpr_write_b32 a8, v64
 v_accvgpr_write_b32 a9, v65
 v_accvgpr_write_b32 a10, v66
 v_accvgpr_write_b32 a11, v67
 ZZ 168,32
 v_cvt_pk_bf16_f32 v68, v164, v165
 v_cvt_pk_bf16_f32 v69, v166, v167
 v_cvt_pk_bf16_f32 v70, v172, v173
 v_cvt_pk_bf16_f32 v71, v174, v175
 ZZ 164,32
 v_accvgpr_write_b32 a40, v68
 v_accvgpr_write_b32 a41, v69
 v_accvgpr_write_b32 a42, v70
 v_accvgpr_write_b32 a43, v71
 ZZ 172,32
 v_cvt_pk_bf16_f32 v72, v176, v177
 v_cvt_pk_bf16_f32 v73, v178, v179
 v_cvt_pk_bf16_f32 v74, v184, v185
 v_cvt_pk_bf16_f32 v75, v186, v187
 ZZ 176,32
 v_accvgpr_write_b32 a12, v72
 v_accvgpr_write_b32 a13, v73
 v_accvgpr_write_b32 a14, v74
 v_accvgpr_write_b32 a15, v75
 ZZ 184,32
 v_cvt_pk_bf16_f32 v76, v180, v181
 v_cvt_pk_bf16_f32 v77, v182, v183
 v_cvt_pk_bf16_f32 v78, v188, v189
 v_cvt_pk_bf16_f32 v79, v190, v191
 ZZ 180,32
 v_accvgpr_write_b32 a44, v76
 v_accvgpr_write_b32 a45, v77
 v_accvgpr_write_b32 a46, v78
 v_accvgpr_write_b32 a47, v79
 ZZ 188,32
 v_cvt_pk_bf16_f32 v64, v192, v193
 v_cvt_pk_bf16_f32 v65, v194, v195
 v_cvt_pk_bf16_f32 v66, v200, v201
 v_cvt_pk_bf16_f32 v67, v202, v203
 ZZ 192,32
 v_accvgpr_write_b32 a16, v64
 v_accvgpr_write_b32 a17, v65
 v_accvgpr_write_b32 a18, v66
 v_accvgpr_write_b32 a19, v67
 ZZ 200,32
 v_cvt_pk_bf16_f32 v68, v196, v197
 v_cvt_pk_bf16_f32 v69, v198, v199
 v_cvt_pk_bf16_f32 v70, v204, v205
 v_cvt_pk_bf16_f32 v71, v206, v207
 ZZ 196,32
 v_accvgpr_write_b32 a48, v68
 v_accvgpr_write_b32 a49, v69
 v_accvgpr_write_b32 a50, v70
 v_accvgpr_write_b32 a51, v71
 ZZ 204,32
 v_cvt_pk_bf16_f32 v72, v208, v209
 v_cvt_pk_bf16_f32 v73, v210, v211
 v_cvt_pk_bf16_f32 v74, v216, v217
 v_cvt_pk_bf16_f32 v75, v218, v219
 ZZ 208,32
 v_accvgpr_write_b32 a20, v72
 v_accvgpr_write_b32 a21, v73
 v_accvgpr_write_b32 a22, v74
 v_accvgpr_write_b32 a23, v75
 ZZ 216,32
 v_cvt_pk_bf16_f32 v76, v212, v213
 v_cvt_pk_bf16_f32 v77, v214, v215
 v_cvt_pk_bf16_f32 v78, v220, v221
 v_cvt_pk_bf16_f32 v79, v222, v223
 ZZ 212,32
 v_accvgpr_write_b32 a52, v76
 v_accvgpr_write_b32 a53, v77
 v_accvgpr_write_b32 a54, v78
 v_accvgpr_write_b32 a55, v79
 ZZ 220,32
 v_cvt_pk_bf16_f32 v64, v224, v225
 v_cvt_pk_bf16_f32 v65, v226, v227
 v_cvt_pk_bf16_f32 v66, v232, v233
 v_cvt_pk_bf16_f32 v67, v234, v235
 ZZ 224,32
 v_accvgpr_write_b32 a24, v64
 v_accvgpr_write_b32 a25, v65
 v_accvgpr_write_b32 a26, v66
 v_accvgpr_write_b32 a27, v67
 ZZ 232,32
 v_cvt_pk_bf16_f32 v68, v228, v229
 v_cvt_pk_bf16_f32 v69, v230, v231
 v_cvt_pk_bf16_f32 v70, v236, v237
 v_cvt_pk_bf16_f32 v71, v238, v239
 ZZ 228,32
 v_accvgpr_write_b32 a56, v68
 v_accvgpr_write_b32 a57, v69
 v_accvgpr_write_b32 a58, v70
 v_accvgpr_write_b32 a59, v71
 ZZ 236,32
 v_cvt_pk_bf16_f32 v72, v240, v241
 v_cvt_pk_bf16_f32 v73, v242, v243
 v_cvt_pk_bf16_f32 v74, v248, v249
 v_cvt_pk_bf16_f32 v75, v250, v251
 ZZ 240,32
 v_accvgpr_write_b32 a28, v72
 v_accvgpr_write_b32 a29, v73
 v_accvgpr_write_b32 a30, v74
 v_accvgpr_write_b32 a31, v75
 ZZ 248,32
 v_cvt_pk_bf16_f32 v76, v244, v245
 v_cvt_pk_bf16_f32 v77, v246, v247
 v_cvt_pk_bf16_f32 v78, v252, v253
 v_cvt_pk_bf16_f32 v79, v254, v255
 ZZ 244,32
 v_accvgpr_write_b32 a60, v76
 v_accvgpr_write_b32 a61, v77
 v_accvgpr_write_b32 a62, v78
 v_accvgpr_write_b32 a63, v79
 ZZ 252,32
 s_nop 1
 s_waitcnt vmcnt(12)
 s_barrier
 s_waitcnt lgkmcnt(6)
 QK 96,64,0,32
 s_add_u32 s25, s24, 0x18000
 RC 120,2,7168
 s_and_b32 s25, s25, 0x1ffff
 QK 100,64,32,36
 s_add_u32 s24, s24, 0x8000
 s_and_b32 s24, s24, 0x1ffff
 QK 108,68,32,36
 RC 124,2,15360
 v_add_u32 v2, s24, v1
 QK 104,68,0,32
 QK 96,72,4,96
 s_add_u32 m0, s25, s26
 RC 64,2,0
 QK 100,72,36,100
 QK 108,76,36,108
 RC 68,2,8192
 QK 104,76,4,104
 DL 1,4,28,0
 QK 96,80,8,96
 RC 72,2,1024
 QK 100,80,40,100
 DL 1,4,28,1024
 QK 108,84,40,108
 RC 76,2,9216
 QK 104,84,8,104
 DL 1,4,28,2048
 QK 96,88,12,96
 RC 80,2,2048
 QK 100,88,44,100
 DL 1,4,28,3072
 QK 108,92,44,108
 s_add_u32 s28, s28, 0x4000
 RC 84,2,10240
 QK 104,92,12,104
 s_waitcnt lgkmcnt(6)
 QK 96,96,16,96
 s_add_u32 m0, s25, s18
 RC 88,2,3072
 QK 100,96,48,100
 QK 108,100,48,108
 RC 92,2,11264
 QK 104,100,16,104
 DL 1,4,29,0
 QK 96,104,20,96
 RC 96,2,4096
 QK 100,104,52,100
 DL 1,4,29,1024
 QK 108,108,52,108
 RC 100,2,12288
 QK 104,108,20,104
 DL 1,4,29,2048
 QK 96,112,24,96
 RC 104,2,5120
 QK 100,112,56,100
 DL 1,4,29,3072
 QK 108,116,56,108
 s_add_u32 s29, s29, 0x4000
 RC 108,2,13312
 QK 104,116,24,104
 QK 96,120,28,96
 RC 112,2,6144
 QK 100,120,60,100
 QK 108,124,60,108
 RC 116,2,14336
 QK 104,124,28,104
 s_or_b32 s41, s30, s31
 s_cmp_eq_u32 s41, 0
 s_cbranch_scc1 mk_pre_21
 s_call_b64 s[46:47], mk_rare0
mk_pre_21:
 s_cmp_eq_u32 s30, 0
 s_cbranch_scc1 mk_tail
mk_loop:
 s_waitcnt vmcnt(12)
 s_barrier
 s_waitcnt lgkmcnt(6)
 QK 112,64,0,32
 s_add_u32 s25, s24, 0x18000
 RC 120,2,7168
 s_and_b32 s25, s25, 0x1ffff
 QK 116,64,32,36
 s_add_u32 s24, s24, 0x8000
 v_exp_f32 v52, v100
 QK 124,68,32,36
 s_and_b32 s24, s24, 0x1ffff
 RC 124,2,15360
 v_cvt_pk_bf16_f32 v40, v48, v49
 QK 120,68,0,32
 v_exp_f32 v53, v101
 QK 112,72,4,112
 RC 64,2,16384
 v_cvt_pk_bf16_f32 v41, v50, v51
 QK 116,72,36,116
 s_add_u32 m0, s25, s26
 v_exp_f32 v54, v102
 QK 124,76,36,124
 RC 68,2,17408
 v_cvt_pk_bf16_f32 v42, v56, v57
 QK 120,76,4,120
 v_cvt_pk_bf16_f32 v43, v58, v59
 v_add_f32 v27, v52, v53
 QK 112,80,8,112
 RC 72,2,18432
 v_add_f32 v27, v27, v54
 QK 116,80,40,116
 v_exp_f32 v55, v103
 QK 124,84,40,124
 RC 76,2,19456
 v_add_f32 v27, v27, v55
 QK 120,84,8,120
 v_exp_f32 v60, v108
 QK 112,88,12,112
 RC 80,2,20480
 v_add_f32 v27, v27, v60
 QK 116,88,44,116
 DL 1,4,28,0
 QK 124,92,44,124
 RC 84,2,21504
 v_cvt_pk_bf16_f32 v44, v52, v53
 QK 120,92,12,120
 s_waitcnt lgkmcnt(6)
 v_exp_f32 v61, v109
 QK 112,96,16,112
 RC 88,2,22528
 v_add_f32 v27, v27, v61
 QK 116,96,48,116
 v_exp_f32 v62, v110
 QK 124,100,48,124
 RC 92,2,23552
 v_add_f32 v27, v27, v62
 QK 120,100,16,120
 DL 1,4,28,1024
 QK 112,104,20,112
 RC 96,2,24576
 v_cvt_pk_bf16_f32 v45, v54, v55
 QK 116,104,52,116
 v_exp_f32 v63, v111
 QK 124,108,52,124
 RC 100,2,25600
 v_add_f32 v27, v27, v63
 QK 120,108,20,120
 DL 1,4,28,2048
 QK 112,112,24,112
 RC 104,2,26624
 v_cvt_pk_bf16_f32 v46, v60, v61
 QK 116,112,56,116
 v_cvt_pk_bf16_f32 v47, v62, v63
 v_max_f32 v29, v26, v27
 QK 124,116,56,124
 RC 108,2,27648
 v_cmp_lt_f32 vcc, 0x4f800000, v29
 QK 120,116,24,120
 DL 1,4,28,3072
 QK 112,120,28,112
 s_add_u32 s28, s28, 0x4000
 RC 112,2,28672
 QK 116,120,60,116
 QK 124,124,60,124
 RC 116,2,29696
 QK 120,124,28,120
 s_waitcnt lgkmcnt(6)
 s_cbranch_vccnz mk_rs_22
mk_rs_22_ret:
 PV 128,64,40
 s_add_u32 m0, s25, s18
 RC 120,2,30720
 v_add_f32 v24, v24, v26
 PV 132,64,44
 v_add_f32 v25, v25, v27
 PV 140,68,44
 RC 124,2,31744
 v_add_u32 v2, s24, v1
 PV 136,68,40
 PV 144,72,40
 RC 64,2,0
 PV 148,72,44
 DL 1,4,29,0
 PV 156,76,44
 RC 68,2,8192
 PV 152,76,40
 v_exp_f32 v48, v112
 PV 160,80,40
 RC 72,2,1024
 PV 164,80,44
 DL 1,4,29,1024
 PV 172,84,44
 RC 76,2,9216
 PV 168,84,40
 v_exp_f32 v49, v113
 PV 176,88,40
 RC 80,2,2048
 v_add_f32 v26, v48, v49
 PV 180,88,44
 v_exp_f32 v50, v114
 PV 188,92,44
 RC 84,2,10240
 v_add_f32 v26, v26, v50
 PV 184,92,40
 s_waitcnt lgkmcnt(6)
 DL 1,4,29,2048
 PV 192,96,40
 RC 88,2,3072
 PV 196,96,44
 v_exp_f32 v51, v115
 PV 204,100,44
 RC 92,2,11264
 v_add_f32 v26, v26, v51
 PV 200,100,40
 v_exp_f32 v56, v120
 PV 208,104,40
 RC 96,2,4096
 v_add_f32 v26, v26, v56
 PV 212,104,44
 v_exp_f32 v57, v121
 PV 220,108,44
 RC 100,2,12288
 v_add_f32 v26, v26, v57
 PV 216,108,40
 v_exp_f32 v58, v122
 PV 224,112,40
 RC 104,2,5120
 v_add_f32 v26, v26, v58
 PV 228,112,44
 v_exp_f32 v59, v123
 DL 1,4,29,3072
 PV 236,116,44
 s_add_u32 s29, s29, 0x4000
 RC 108,2,13312
 v_add_f32 v26, v26, v59
 PV 232,116,40
 PV 240,120,40
 RC 112,2,6144
 PV 244,120,44
 PV 252,124,44
 RC 116,2,14336
 PV 248,124,40
 s_waitcnt vmcnt(12)
 s_barrier
 s_waitcnt lgkmcnt(6)
 QK 96,64,0,32
 s_add_u32 s25, s24, 0x18000
 RC 120,2,7168
 s_and_b32 s25, s25, 0x1ffff
 QK 100,64,32,36
 s_add_u32 s24, s24, 0x8000
 v_exp_f32 v52, v116
 QK 108,68,32,36
 s_and_b32 s24, s24, 0x1ffff
 RC 124,2,15360
 v_cvt_pk_bf16_f32 v40, v48, v49
 QK 104,68,0,32
 v_exp_f32 v53, v117
 QK 96,72,4,96
 RC 64,2,16384
 v_cvt_pk_bf16_f32 v41, v50, v51
 QK 100,72,36,100
 s_add_u32 m0, s25, s26
 v_exp_f32 v54, v118
 QK 108,76,36,108
 RC 68,2,17408
 v_cvt_pk_bf16_f32 v42, v56, v57
 QK 104,76,4,104
 v_cvt_pk_bf16_f32 v43, v58, v59
 v_add_f32 v27, v52, v53
 QK 96,80,8,96
 RC 72,2,18432
 v_add_f32 v27, v27, v54
 QK 100,80,40,100
 v_exp_f32 v55, v119
 QK 108,84,40,108
 RC 76,2,19456
 v_add_f32 v27, v27, v55
 QK 104,84,8,104
 v_exp_f32 v60, v124
 QK 96,88,12,96
 RC 80,2,20480
 v_add_f32 v27, v27, v60
 QK 100,88,44,100
 DL 1,4,28,0
 QK 108,92,44,108
 RC 84,2,21504
 v_cvt_pk_bf16_f32 v44, v52, v53
 QK 104,92,12,104
 s_waitcnt lgkmcnt(6)
 v_exp_f32 v61, v125
 QK 96,96,16,96
 RC 88,2,22528
 v_add_f32 v27, v27, v61
 QK 100,96,48,100
 v_exp_f32 v62, v126
 QK 108,100,48,108
 RC 92,2,23552
 v_add_f32 v27, v27, v62
 QK 104,100,16,104
 DL 1,4,28,1024
 QK 96,104,20,96
 RC 96,2,24576
 v_cvt_pk_bf16_f32 v45, v54, v55
 QK 100,104,52,100
 v_exp_f32 v63, v127
 QK 108,108,52,108
 RC 100,2,25600
 v_add_f32 v27, v27, v63
 QK 104,108,20,104
 DL 1,4,28,2048
 QK 96,112,24,96
 RC 104,2,26624
 v_cvt_pk_bf16_f32 v46, v60, v61
 QK 100,112,56,100
 v_cvt_pk_bf16_f32 v47, v62, v63
 v_max_f32 v29, v26, v27
 QK 108,116,56,108
 RC 108,2,27648
 v_cmp_lt_f32 vcc, 0x4f800000, v29
 QK 104,116,24,104
 DL 1,4,28,3072
 QK 96,120,28,96
 s_add_u32 s28, s28, 0x4000
 RC 112,2,28672
 QK 100,120,60,100
 QK 108,124,60,108
 RC 116,2,29696
 QK 104,124,28,104
 s_waitcnt lgkmcnt(6)
 s_cbranch_vccnz mk_rs_23
mk_rs_23_ret:
 PV 128,64,40
 s_add_u32 m0, s25, s18
 RC 120,2,30720
 v_add_f32 v24, v24, v26
 PV 132,64,44
 v_add_f32 v25, v25, v27
 PV 140,68,44
 RC 124,2,31744
 v_add_u32 v2, s24, v1
 PV 136,68,40
 PV 144,72,40
 RC 64,2,0
 PV 148,72,44
 DL 1,4,29,0
 PV 156,76,44
 RC 68,2,8192
 PV 152,76,40
 v_exp_f32 v48, v96
 PV 160,80,40
 RC 72,2,1024
 PV 164,80,44
 DL 1,4,29,1024
 PV 172,84,44
 RC 76,2,9216
 PV 168,84,40
 v_exp_f32 v49, v97
 PV 176,88,40
 RC 80,2,2048
 v_add_f32 v26, v48, v49
 PV 180,88,44
 v_exp_f32 v50, v98
 PV 188,92,44
 RC 84,2,10240
 v_add_f32 v26, v26, v50
 PV 184,92,40
 s_waitcnt lgkmcnt(6)
 DL 1,4,29,2048
 PV 192,96,40
 RC 88,2,3072
 PV 196,96,44
 v_exp_f32 v51, v99
 PV 204,100,44
 RC 92,2,11264
 v_add_f32 v26, v26, v51
 PV 200,100,40
 v_exp_f32 v56, v104
 PV 208,104,40
 RC 96,2,4096
 v_add_f32 v26, v26, v56
 PV 212,104,44
 v_exp_f32 v57, v105
 PV 220,108,44
 RC 100,2,12288
 v_add_f32 v26, v26, v57
 PV 216,108,40
 v_exp_f32 v58, v106
 PV 224,112,40
 RC 104,2,5120
 v_add_f32 v26, v26, v58
 PV 228,112,44
 v_exp_f32 v59, v107
 DL 1,4,29,3072
 PV 236,116,44
 s_add_u32 s29, s29, 0x4000
 RC 108,2,13312
 v_add_f32 v26, v26, v59
 PV 232,116,40
 PV 240,120,40
 RC 112,2,6144
 PV 244,120,44
 PV 252,124,44
 RC 116,2,14336
 PV 248,124,40
 s_sub_u32 s30, s30, 1
 s_cmp_lg_u32 s30, 0
 s_cbranch_scc1 mk_loop
mk_tail:
 s_cmp_eq_u32 s31, 0
 s_cbranch_scc1 mk_t0_diag
 s_waitcnt vmcnt(12)
 s_barrier
 s_waitcnt lgkmcnt(6)
 QK 112,64,0,32
 s_add_u32 s25, s24, 0x18000
 RC 120,2,7168
 s_and_b32 s25, s25, 0x1ffff
 QK 116,64,32,36
 s_add_u32 s24, s24, 0x8000
 v_exp_f32 v52, v100
 QK 124,68,32,36
 s_and_b32 s24, s24, 0x1ffff
 RC 124,2,15360
 v_cvt_pk_bf16_f32 v40, v48, v49
 QK 120,68,0,32
 v_exp_f32 v53, v101
 QK 112,72,4,112
 RC 64,2,16384
 v_cvt_pk_bf16_f32 v41, v50, v51
 QK 116,72,36,116
 s_add_u32 m0, s25, s18
 v_exp_f32 v54, v102
 QK 124,76,36,124
 RC 68,2,17408
 v_cvt_pk_bf16_f32 v42, v56, v57
 QK 120,76,4,120
 v_cvt_pk_bf16_f32 v43, v58, v59
 v_add_f32 v27, v52, v53
 QK 112,80,8,112
 RC 72,2,18432
 v_add_f32 v27, v27, v54
 QK 116,80,40,116
 v_exp_f32 v55, v103
 QK 124,84,40,124
 RC 76,2,19456
 v_add_f32 v27, v27, v55
 QK 120,84,8,120
 v_exp_f32 v60, v108
 QK 112,88,12,112
 RC 80,2,20480
 v_add_f32 v27, v27, v60
 QK 116,88,44,116
 DL 1,4,29,0
 QK 124,92,44,124
 RC 84,2,21504
 v_cvt_pk_bf16_f32 v44, v52, v53
 QK 120,92,12,120
 s_waitcnt lgkmcnt(6)
 v_exp_f32 v61, v109
 QK 112,96,16,112
 RC 88,2,22528
 v_add_f32 v27, v27, v61
 QK 116,96,48,116
 v_exp_f32 v62, v110
 QK 124,100,48,124
 RC 92,2,23552
 v_add_f32 v27, v27, v62
 QK 120,100,16,120
 DL 1,4,29,1024
 QK 112,104,20,112
 RC 96,2,24576
 v_cvt_pk_bf16_f32 v45, v54, v55
 QK 116,104,52,116
 v_exp_f32 v63, v111
 QK 124,108,52,124
 RC 100,2,25600
 v_add_f32 v27, v27, v63
 QK 120,108,20,120
 DL 1,4,29,2048
 QK 112,112,24,112
 RC 104,2,26624
 v_cvt_pk_bf16_f32 v46, v60, v61
 QK 116,112,56,116
 v_cvt_pk_bf16_f32 v47, v62, v63
 v_max_f32 v29, v26, v27
 QK 124,116,56,124
 RC 108,2,27648
 v_cmp_lt_f32 vcc, 0x4f800000, v29
 QK 120,116,24,120
 DL 1,4,29,3072
 QK 112,120,28,112
 s_add_u32 s29, s29, 0x4000
 RC 112,2,28672
 QK 116,120,60,116
 QK 124,124,60,124
 RC 116,2,29696
 QK 120,124,28,120
 s_waitcnt lgkmcnt(6)
 s_cbranch_vccnz mk_rs_24
mk_rs_24_ret:
 PV 128,64,40
 RC 120,2,30720
 v_add_f32 v24, v24, v26
 PV 132,64,44
 v_add_f32 v25, v25, v27
 PV 140,68,44
 RC 124,2,31744
 v_add_u32 v2, s24, v1
 PV 136,68,40
 PV 144,72,40
 RC 64,2,0
 PV 148,72,44
 PV 156,76,44
 RC 68,2,8192
 PV 152,76,40
 v_exp_f32 v48, v112
 PV 160,80,40
 RC 72,2,1024
 PV 164,80,44
 v_exp_f32 v49, v113
 PV 172,84,44
 RC 76,2,9216
 v_add_f32 v26, v48, v49
 PV 168,84,40
 v_exp_f32 v50, v114
 PV 176,88,40
 RC 80,2,2048
 v_add_f32 v26, v26, v50
 PV 180,88,44
 v_exp_f32 v51, v115
 PV 188,92,44
 RC 84,2,10240
 v_add_f32 v26, v26, v51
 PV 184,92,40
 s_waitcnt lgkmcnt(6)
 v_exp_f32 v56, v120
 PV 192,96,40
 RC 88,2,3072
 v_add_f32 v26, v26, v56
 PV 196,96,44
 v_exp_f32 v57, v121
 PV 204,100,44
 RC 92,2,11264
 v_add_f32 v26, v26, v57
 PV 200,100,40
 v_exp_f32 v58, v122
 PV 208,104,40
 RC 96,2,4096
 v_add_f32 v26, v26, v58
 PV 212,104,44
 v_exp_f32 v59, v123
 PV 220,108,44
 RC 100,2,12288
 v_add_f32 v26, v26, v59
 PV 216,108,40
 PV 224,112,40
 RC 104,2,5120
 PV 228,112,44
 PV 236,116,44
 RC 108,2,13312
 PV 232,116,40
 PV 240,120,40
 RC 112,2,6144
 PV 244,120,44
 PV 252,124,44
 RC 116,2,14336
 PV 248,124,40
 s_branch mk_t0_end
mk_t0_diag:
 s_waitcnt vmcnt(12)
 s_barrier
 v_add_u32 v2, s24, v1
 s_add_u32 s25, s24, 0x18000
 s_and_b32 s25, s25, 0x1ffff
 s_add_u32 s24, s24, 0x8000
 s_and_b32 s24, s24, 0x1ffff
 RC 64,2,16384
 RC 68,2,17408
 RC 72,2,18432
 RC 76,2,19456
 RC 80,2,20480
 RC 84,2,21504
 RC 88,2,22528
 RC 92,2,23552
 RC 96,2,24576
 RC 100,2,25600
 s_add_u32 m0, s25, s18
 s_nop 0
 DL 1,4,29,0
 DL 1,4,29,1024
 DL 1,4,29,2048
 DL 1,4,29,3072
 s_add_u32 s29, s29, 0x4000
 v_cmp_gt_i32 s[48:49], 0, v23
 v_cmp_gt_i32 s[50:51], 1, v23
 v_cmp_gt_i32 s[52:53], 2, v23
 v_cmp_gt_i32 s[54:55], 3, v23
 v_cndmask_b32 v96, v96, v28, s[48:49]
 v_cndmask_b32 v97, v97, v28, s[50:51]
 v_cndmask_b32 v98, v98, v28, s[52:53]
 v_cndmask_b32 v99, v99, v28, s[54:55]
 v_cmp_gt_i32 s[48:49], 16, v23
 v_cmp_gt_i32 s[50:51], 17, v23
 v_cmp_gt_i32 s[52:53], 18, v23
 v_cmp_gt_i32 s[54:55], 19, v23
 v_cndmask_b32 v104, v104, v28, s[48:49]
 v_cndmask_b32 v105, v105, v28, s[50:51]
 v_cndmask_b32 v106, v106, v28, s[52:53]
 v_cndmask_b32 v107, v107, v28, s[54:55]
 v_cmp_gt_i32 s[48:49], 0, v23
 v_cmp_gt_i32 s[50:51], 1, v23
 v_cmp_gt_i32 s[52:53], 2, v23
 v_cmp_gt_i32 s[54:55], 3, v23
 v_cndmask_b32 v108, v108, v28, s[48:49]
 v_cndmask_b32 v109, v109, v28, s[50:51]
 v_cndmask_b32 v110, v110, v28, s[52:53]
 v_cndmask_b32 v111, v111, v28, s[54:55]
 v_exp_f32 v48, v96
 v_exp_f32 v49, v97
 v_exp_f32 v50, v98
 v_exp_f32 v51, v99
 v_exp_f32 v56, v104
 v_exp_f32 v57, v105
 v_exp_f32 v58, v106
 v_exp_f32 v59, v107
 v_exp_f32 v52, v100
 v_exp_f32 v53, v101
 v_exp_f32 v54, v102
 v_exp_f32 v55, v103
 v_exp_f32 v60, v108
 v_exp_f32 v61, v109
 v_exp_f32 v62, v110
 v_exp_f32 v63, v111
 s_nop 0
 v_add_f32 v26, v48, v49
 v_add_f32 v26, v26, v50
 v_add_f32 v26, v26, v51
 v_add_f32 v26, v26, v56
 v_add_f32 v26, v26, v57
 v_add_f32 v26, v26, v58
 v_add_f32 v26, v26, v59
 v_cvt_pk_bf16_f32 v40, v48, v49
 v_cvt_pk_bf16_f32 v41, v50, v51
 v_cvt_pk_bf16_f32 v42, v56, v57
 v_cvt_pk_bf16_f32 v43, v58, v59
 v_add_f32 v27, v52, v53
 v_add_f32 v27, v27, v54
 v_add_f32 v27, v27, v55
 v_add_f32 v27, v27, v60
 v_add_f32 v27, v27, v61
 v_add_f32 v27, v27, v62
 v_add_f32 v27, v27, v63
 v_cvt_pk_bf16_f32 v44, v52, v53
 v_cvt_pk_bf16_f32 v45, v54, v55
 v_cvt_pk_bf16_f32 v46, v60, v61
 v_cvt_pk_bf16_f32 v47, v62, v63
 v_max_f32 v29, v26, v27
 v_cmp_lt_f32 vcc, 0x4f800000, v29
 s_nop 1
 s_or_b64 vcc, vcc, s[32:33]
 s_cbranch_vccnz mk_rs_25
mk_rs_25_ret:
 s_waitcnt lgkmcnt(6)
 PV 128,64,40
 RC 104,2,26624
 PV 132,64,44
 v_add_f32 v24, v24, v26
 v_add_f32 v25, v25, v27
 PV 140,68,44
 RC 108,2,27648
 PV 136,68,40
 PV 144,72,40
 RC 112,2,28672
 PV 148,72,44
 PV 156,76,44
 RC 116,2,29696
 PV 152,76,40
 s_waitcnt lgkmcnt(6)
 PV 160,80,40
 RC 120,2,30720
 PV 164,80,44
 PV 172,84,44
 RC 124,2,31744
 PV 168,84,40
 PV 176,88,40
 PV 180,88,44
 PV 188,92,44
 PV 184,92,40
 s_waitcnt lgkmcnt(4)
 PV 192,96,40
 PV 196,96,44
 PV 204,100,44
 PV 200,100,40
 PV 208,104,40
 PV 212,104,44
 PV 220,108,44
 PV 216,108,40
 s_waitcnt lgkmcnt(0)
 PV 224,112,40
 PV 228,112,44
 PV 236,116,44
 PV 232,116,40
 PV 240,120,40
 PV 244,120,44
 PV 252,124,44
 PV 248,124,40
mk_t0_end:
 s_cmp_eq_u32 s31, 1
 s_cbranch_scc1 mk_t1_diag
 s_cmp_lt_u32 s31, 1
 s_cbranch_scc1 mk_t1_skip
 s_waitcnt vmcnt(8)
 s_barrier
 s_waitcnt lgkmcnt(6)
 QK 96,64,0,32
 s_add_u32 s25, s24, 0x18000
 RC 120,2,7168
 s_and_b32 s25, s25, 0x1ffff
 QK 100,64,32,36
 s_add_u32 s24, s24, 0x8000
 v_exp_f32 v52, v116
 QK 108,68,32,36
 s_and_b32 s24, s24, 0x1ffff
 RC 124,2,15360
 v_cvt_pk_bf16_f32 v40, v48, v49
 QK 104,68,0,32
 v_exp_f32 v53, v117
 QK 96,72,4,96
 RC 64,2,16384
 v_cvt_pk_bf16_f32 v41, v50, v51
 QK 100,72,36,100
 s_add_u32 m0, s25, s27
 v_exp_f32 v54, v118
 QK 108,76,36,108
 RC 68,2,17408
 v_cvt_pk_bf16_f32 v42, v56, v57
 QK 104,76,4,104
 v_cvt_pk_bf16_f32 v43, v58, v59
 v_add_f32 v27, v52, v53
 QK 96,80,8,96
 RC 72,2,18432
 v_add_f32 v27, v27, v54
 QK 100,80,40,100
 s_add_u32 s41, s36, s37
 v_exp_f32 v55, v119
 QK 108,84,40,108
 RC 76,2,19456
 v_add_f32 v27, v27, v55
 QK 104,84,8,104
 v_exp_f32 v60, v124
 QK 96,88,12,96
 RC 80,2,20480
 v_add_f32 v27, v27, v60
 QK 100,88,44,100
 v_exp_f32 v61, v125
 QK 108,92,44,108
 RC 84,2,21504
 v_add_f32 v27, v27, v61
 QK 104,92,12,104
 s_waitcnt lgkmcnt(6)
 v_exp_f32 v62, v126
 QK 96,96,16,96
 RC 88,2,22528
 v_add_f32 v27, v27, v62
 QK 100,96,48,100
 DL 11,8,36,0
 QK 108,100,48,108
 RC 92,2,23552
 v_cvt_pk_bf16_f32 v44, v52, v53
 QK 104,100,16,104
 v_exp_f32 v63, v127
 QK 96,104,20,96
 RC 96,2,24576
 v_add_f32 v27, v27, v63
 QK 100,104,52,100
 DL 12,8,36,1024
 QK 108,108,52,108
 RC 100,2,25600
 v_cvt_pk_bf16_f32 v45, v54, v55
 QK 104,108,20,104
 v_cvt_pk_bf16_f32 v46, v60, v61
 v_cvt_pk_bf16_f32 v47, v62, v63
 QK 96,112,24,96
 RC 104,2,26624
 v_max_f32 v29, v26, v27
 QK 100,112,56,100
 v_cmp_lt_f32 vcc, 0x4f800000, v29
 QK 108,116,56,108
 RC 108,2,27648
 QK 104,116,24,104
 DL 13,8,36,2048
 QK 96,120,28,96
 RC 112,2,28672
 QK 100,120,60,100
 DL 14,8,36,3072
 QK 108,124,60,108
 RC 116,2,29696
 QK 104,124,28,104
 s_waitcnt lgkmcnt(6)
 s_cbranch_vccnz mk_rs_26
mk_rs_26_ret:
 PV 128,64,40
 s_add_u32 m0, m0, 0x1000
 RC 120,2,30720
 v_add_f32 v24, v24, v26
 PV 132,64,44
 v_add_f32 v25, v25, v27
 PV 140,68,44
 RC 124,2,31744
 v_add_u32 v2, s24, v1
 PV 136,68,40
 PV 144,72,40
 RC 64,2,0
 PV 148,72,44
 DL 11,8,41,0
 PV 156,76,44
 RC 68,2,8192
 PV 152,76,40
 v_exp_f32 v48, v96
 PV 160,80,40
 RC 72,2,1024
 PV 164,80,44
 DL 12,8,41,1024
 PV 172,84,44
 RC 76,2,9216
 PV 168,84,40
 v_exp_f32 v49, v97
 PV 176,88,40
 RC 80,2,2048
 v_add_f32 v26, v48, v49
 PV 180,88,44
 v_exp_f32 v50, v98
 PV 188,92,44
 RC 84,2,10240
 v_add_f32 v26, v26, v50
 PV 184,92,40
 s_waitcnt lgkmcnt(6)
 DL 13,8,41,2048
 PV 192,96,40
 RC 88,2,3072
 PV 196,96,44
 v_exp_f32 v51, v99
 PV 204,100,44
 RC 92,2,11264
 v_add_f32 v26, v26, v51
 PV 200,100,40
 v_exp_f32 v56, v104
 PV 208,104,40
 RC 96,2,4096
 v_add_f32 v26, v26, v56
 PV 212,104,44
 v_exp_f32 v57, v105
 PV 220,108,44
 RC 100,2,12288
 v_add_f32 v26, v26, v57
 PV 216,108,40
 v_exp_f32 v58, v106
 PV 224,112,40
 RC 104,2,5120
 v_add_f32 v26, v26, v58
 PV 228,112,44
 v_exp_f32 v59, v107
 DL 14,8,41,3072
 PV 236,116,44
 s_add_u32 s36, s36, s38
 RC 108,2,13312
 v_add_f32 v26, v26, v59
 PV 232,116,40
 PV 240,120,40
 RC 112,2,6144
 PV 244,120,44
 PV 252,124,44
 RC 116,2,14336
 PV 248,124,40
 s_branch mk_t1_end
mk_t1_diag:
 s_waitcnt vmcnt(8)
 s_barrier
 v_add_u32 v2, s24, v1
 s_add_u32 s25, s24, 0x18000
 s_and_b32 s25, s25, 0x1ffff
 s_add_u32 s24, s24, 0x8000
 s_and_b32 s24, s24, 0x1ffff
 RC 64,2,16384
 RC 68,2,17408
 RC 72,2,18432
 RC 76,2,19456
 RC 80,2,20480
 RC 84,2,21504
 RC 88,2,22528
 RC 92,2,23552
 RC 96,2,24576
 RC 100,2,25600
 s_add_u32 m0, s25, s27
 s_add_u32 s41, s36, s37
 s_nop 0
 DL 11,8,36,0
 DL 12,8,36,1024
 DL 13,8,36,2048
 DL 14,8,36,3072
 s_add_u32 m0, m0, 0x1000
 s_nop 0
 DL 11,8,41,0
 DL 12,8,41,1024
 DL 13,8,41,2048
 DL 14,8,41,3072
 s_add_u32 s36, s36, s38
 v_cmp_gt_i32 s[48:49], 0, v23
 v_cmp_gt_i32 s[50:51], 1, v23
 v_cmp_gt_i32 s[52:53], 2, v23
 v_cmp_gt_i32 s[54:55], 3, v23
 v_cndmask_b32 v112, v112, v28, s[48:49]
 v_cndmask_b32 v113, v113, v28, s[50:51]
 v_cndmask_b32 v114, v114, v28, s[52:53]
 v_cndmask_b32 v115, v115, v28, s[54:55]
 v_cmp_gt_i32 s[48:49], 16, v23
 v_cmp_gt_i32 s[50:51], 17, v23
 v_cmp_gt_i32 s[52:53], 18, v23
 v_cmp_gt_i32 s[54:55], 19, v23
 v_cndmask_b32 v120, v120, v28, s[48:49]
 v_cndmask_b32 v121, v121, v28, s[50:51]
 v_cndmask_b32 v122, v122, v28, s[52:53]
 v_cndmask_b32 v123, v123, v28, s[54:55]
 v_cmp_gt_i32 s[48:49], 0, v23
 v_cmp_gt_i32 s[50:51], 1, v23
 v_cmp_gt_i32 s[52:53], 2, v23
 v_cmp_gt_i32 s[54:55], 3, v23
 v_cndmask_b32 v124, v124, v28, s[48:49]
 v_cndmask_b32 v125, v125, v28, s[50:51]
 v_cndmask_b32 v126, v126, v28, s[52:53]
 v_cndmask_b32 v127, v127, v28, s[54:55]
 v_exp_f32 v48, v112
 v_exp_f32 v49, v113
 v_exp_f32 v50, v114
 v_exp_f32 v51, v115
 v_exp_f32 v56, v120
 v_exp_f32 v57, v121
 v_exp_f32 v58, v122
 v_exp_f32 v59, v123
 v_exp_f32 v52, v116
 v_exp_f32 v53, v117
 v_exp_f32 v54, v118
 v_exp_f32 v55, v119
 v_exp_f32 v60, v124
 v_exp_f32 v61, v125
 v_exp_f32 v62, v126
 v_exp_f32 v63, v127
 s_nop 0
 v_add_f32 v26, v48, v49
 v_add_f32 v26, v26, v50
 v_add_f32 v26, v26, v51
 v_add_f32 v26, v26, v56
 v_add_f32 v26, v26, v57
 v_add_f32 v26, v26, v58
 v_add_f32 v26, v26, v59
 v_cvt_pk_bf16_f32 v40, v48, v49
 v_cvt_pk_bf16_f32 v41, v50, v51
 v_cvt_pk_bf16_f32 v42, v56, v57
 v_cvt_pk_bf16_f32 v43, v58, v59
 v_add_f32 v27, v52, v53
 v_add_f32 v27, v27, v54
 v_add_f32 v27, v27, v55
 v_add_f32 v27, v27, v60
 v_add_f32 v27, v27, v61
 v_add_f32 v27, v27, v62
 v_add_f32 v27, v27, v63
 v_cvt_pk_bf16_f32 v44, v52, v53
 v_cvt_pk_bf16_f32 v45, v54, v55
 v_cvt_pk_bf16_f32 v46, v60, v61
 v_cvt_pk_bf16_f32 v47, v62, v63
 v_max_f32 v29, v26, v27
 v_cmp_lt_f32 vcc, 0x4f800000, v29
 s_nop 1
 s_or_b64 vcc, vcc, s[32:33]
 s_cbranch_vccnz mk_rs_27
mk_rs_27_ret:
 s_waitcnt lgkmcnt(6)
 PV 128,64,40
 RC 104,2,26624
 PV 132,64,44
 v_add_f32 v24, v24, v26
 v_add_f32 v25, v25, v27
 PV 140,68,44
 RC 108,2,27648
 PV 136,68,40
 PV 144,72,40
 RC 112,2,28672
 PV 148,72,44
 PV 156,76,44
 RC 116,2,29696
 PV 152,76,40
 s_waitcnt lgkmcnt(6)
 PV 160,80,40
 RC 120,2,30720
 PV 164,80,44
 PV 172,84,44
 RC 124,2,31744
 PV 168,84,40
 PV 176,88,40
 PV 180,88,44
 PV 188,92,44
 PV 184,92,40
 s_waitcnt lgkmcnt(4)
 PV 192,96,40
 PV 196,96,44
 PV 204,100,44
 PV 200,100,40
 PV 208,104,40
 PV 212,104,44
 PV 220,108,44
 PV 216,108,40
 s_waitcnt lgkmcnt(0)
 PV 224,112,40
 PV 228,112,44
 PV 236,116,44
 PV 232,116,40
 PV 240,120,40
 PV 244,120,44
 PV 252,124,44
 PV 248,124,40
 s_branch mk_t1_end
mk_t1_skip:
 s_waitcnt vmcnt(8)
 s_barrier
 s_add_u32 s25, s24, 0x18000
 s_and_b32 s25, s25, 0x1ffff
 s_add_u32 s24, s24, 0x8000
 s_and_b32 s24, s24, 0x1ffff
 s_add_u32 m0, s25, s27
 s_add_u32 s41, s36, s37
 s_nop 0
 DL 11,8,36,0
 DL 12,8,36,1024
 DL 13,8,36,2048
 DL 14,8,36,3072
 s_add_u32 m0, m0, 0x1000
 s_nop 0
 DL 11,8,41,0
 DL 12,8,41,1024
 DL 13,8,41,2048
 DL 14,8,41,3072
 s_add_u32 s36, s36, s38
mk_t1_end:
 s_cmp_eq_u32 s31, 2
 s_cbranch_scc1 mk_t2_diag
 s_cmp_lt_u32 s31, 2
 s_cbranch_scc1 mk_t2_skip
 s_waitcnt vmcnt(12)
 s_barrier
 s_cmp_eq_u32 s35, 1
 s_cbranch_scc0 mk_mp_28
 s_add_u32 s42, s21, 16
 s_lshl_b32 s42, s42, 8
 v_mov_b32 v94, s42
 global_load_dword v95, v94, s[96:97] sc1
mk_mp_28:
 s_waitcnt lgkmcnt(6)
 QK 112,64,0,32
 s_add_u32 s25, s24, 0x18000
 RC 120,2,7168
 s_and_b32 s25, s25, 0x1ffff
 QK 116,64,32,36
 s_add_u32 s24, s24, 0x8000
 v_exp_f32 v52, v100
 QK 124,68,32,36
 s_and_b32 s24, s24, 0x1ffff
 RC 124,2,15360
 v_cvt_pk_bf16_f32 v40, v48, v49
 QK 120,68,0,32
 v_exp_f32 v53, v101
 QK 112,72,4,112
 RC 64,2,16384
 v_cvt_pk_bf16_f32 v41, v50, v51
 QK 116,72,36,116
 s_add_u32 m0, s25, s27
 v_exp_f32 v54, v102
 QK 124,76,36,124
 RC 68,2,17408
 v_cvt_pk_bf16_f32 v42, v56, v57
 QK 120,76,4,120
 v_cvt_pk_bf16_f32 v43, v58, v59
 v_add_f32 v27, v52, v53
 QK 112,80,8,112
 RC 72,2,18432
 v_add_f32 v27, v27, v54
 QK 116,80,40,116
 s_add_u32 s41, s36, s37
 v_exp_f32 v55, v103
 QK 124,84,40,124
 RC 76,2,19456
 v_add_f32 v27, v27, v55
 QK 120,84,8,120
 v_exp_f32 v60, v108
 QK 112,88,12,112
 RC 80,2,20480
 v_add_f32 v27, v27, v60
 QK 116,88,44,116
 v_exp_f32 v61, v109
 QK 124,92,44,124
 RC 84,2,21504
 v_add_f32 v27, v27, v61
 QK 120,92,12,120
 s_waitcnt lgkmcnt(6)
 v_exp_f32 v62, v110
 QK 112,96,16,112
 RC 88,2,22528
 v_add_f32 v27, v27, v62
 QK 116,96,48,116
 DL 11,8,36,0
 QK 124,100,48,124
 RC 92,2,23552
 v_cvt_pk_bf16_f32 v44, v52, v53
 QK 120,100,16,120
 v_exp_f32 v63, v111
 QK 112,104,20,112
 RC 96,2,24576
 v_add_f32 v27, v27, v63
 QK 116,104,52,116
 DL 12,8,36,1024
 QK 124,108,52,124
 RC 100,2,25600
 v_cvt_pk_bf16_f32 v45, v54, v55
 QK 120,108,20,120
 v_cvt_pk_bf16_f32 v46, v60, v61
 v_cvt_pk_bf16_f32 v47, v62, v63
 QK 112,112,24,112
 RC 104,2,26624
 v_max_f32 v29, v26, v27
 QK 116,112,56,116
 v_cmp_lt_f32 vcc, 0x4f800000, v29
 QK 124,116,56,124
 RC 108,2,27648
 QK 120,116,24,120
 DL 13,8,36,2048
 QK 112,120,28,112
 RC 112,2,28672
 QK 116,120,60,116
 DL 14,8,36,3072
 QK 124,124,60,124
 RC 116,2,29696
 QK 120,124,28,120
 s_waitcnt lgkmcnt(6)
 s_cbranch_vccnz mk_rs_29
mk_rs_29_ret:
 PV 128,64,40
 s_add_u32 m0, m0, 0x1000
 RC 120,2,30720
 v_add_f32 v24, v24, v26
 PV 132,64,44
 v_add_f32 v25, v25, v27
 PV 140,68,44
 RC 124,2,31744
 PV 136,68,40
 PV 144,72,40
 PV 148,72,44
 DL 11,8,41,0
 PV 156,76,44
 v_exp_f32 v48, v112
 PV 152,76,40
 PV 160,80,40
 v_exp_f32 v49, v113
 PV 164,80,44
 DL 12,8,41,1024
 PV 172,84,44
 v_exp_f32 v50, v114
 PV 168,84,40
 v_add_f32 v26, v48, v49
 v_add_f32 v26, v26, v50
 PV 176,88,40
 v_exp_f32 v51, v115
 PV 180,88,44
 v_add_f32 v26, v26, v51
 PV 188,92,44
 DL 13,8,41,2048
 PV 184,92,40
 s_waitcnt lgkmcnt(0)
 v_exp_f32 v56, v120
 PV 192,96,40
 v_exp_f32 v57, v121
 PV 196,96,44
 v_add_f32 v26, v26, v56
 v_add_f32 v26, v26, v57
 PV 204,100,44
 v_exp_f32 v58, v122
 PV 200,100,40
 DL 14,8,41,3072
 PV 208,104,40
 v_exp_f32 v59, v123
 PV 212,104,44
 v_add_f32 v26, v26, v58
 v_add_f32 v26, v26, v59
 PV 220,108,44
 PV 216,108,40
 s_add_u32 s36, s36, s38
 PV 224,112,40
 PV 228,112,44
 PV 236,116,44
 PV 232,116,40
 PV 240,120,40
 PV 244,120,44
 PV 252,124,44
 PV 248,124,40
 s_branch mk_t2_end
mk_t2_diag:
 s_waitcnt vmcnt(12)
 s_barrier
 v_add_u32 v2, s24, v1
 s_add_u32 s25, s24, 0x18000
 s_and_b32 s25, s25, 0x1ffff
 s_add_u32 s24, s24, 0x8000
 s_and_b32 s24, s24, 0x1ffff
 RC 64,2,16384
 RC 68,2,17408
 RC 72,2,18432
 RC 76,2,19456
 RC 80,2,20480
 RC 84,2,21504
 RC 88,2,22528
 RC 92,2,23552
 RC 96,2,24576
 RC 100,2,25600
 s_add_u32 m0, s25, s27
 s_add_u32 s41, s36, s37
 s_nop 0
 DL 11,8,36,0
 DL 12,8,36,1024
 DL 13,8,36,2048
 DL 14,8,36,3072
 s_add_u32 m0, m0, 0x1000
 s_nop 0
 DL 11,8,41,0
 DL 12,8,41,1024
 DL 13,8,41,2048
 DL 14,8,41,3072
 s_add_u32 s36, s36, s38
 v_cmp_gt_i32 s[48:49], 0, v23
 v_cmp_gt_i32 s[50:51], 1, v23
 v_cmp_gt_i32 s[52:53], 2, v23
 v_cmp_gt_i32 s[54:55], 3, v23
 v_cndmask_b32 v96, v96, v28, s[48:49]
 v_cndmask_b32 v97, v97, v28, s[50:51]
 v_cndmask_b32 v98, v98, v28, s[52:53]
 v_cndmask_b32 v99, v99, v28, s[54:55]
 v_cmp_gt_i32 s[48:49], 16, v23
 v_cmp_gt_i32 s[50:51], 17, v23
 v_cmp_gt_i32 s[52:53], 18, v23
 v_cmp_gt_i32 s[54:55], 19, v23
 v_cndmask_b32 v104, v104, v28, s[48:49]
 v_cndmask_b32 v105, v105, v28, s[50:51]
 v_cndmask_b32 v106, v106, v28, s[52:53]
 v_cndmask_b32 v107, v107, v28, s[54:55]
 v_cmp_gt_i32 s[48:49], 0, v23
 v_cmp_gt_i32 s[50:51], 1, v23
 v_cmp_gt_i32 s[52:53], 2, v23
 v_cmp_gt_i32 s[54:55], 3, v23
 v_cndmask_b32 v108, v108, v28, s[48:49]
 v_cndmask_b32 v109, v109, v28, s[50:51]
 v_cndmask_b32 v110, v110, v28, s[52:53]
 v_cndmask_b32 v111, v111, v28, s[54:55]
 v_exp_f32 v48, v96
 v_exp_f32 v49, v97
 v_exp_f32 v50, v98
 v_exp_f32 v51, v99
 v_exp_f32 v56, v104
 v_exp_f32 v57, v105
 v_exp_f32 v58, v106
 v_exp_f32 v59, v107
 v_exp_f32 v52, v100
 v_exp_f32 v53, v101
 v_exp_f32 v54, v102
 v_exp_f32 v55, v103
 v_exp_f32 v60, v108
 v_exp_f32 v61, v109
 v_exp_f32 v62, v110
 v_exp_f32 v63, v111
 s_nop 0
 v_add_f32 v26, v48, v49
 v_add_f32 v26, v26, v50
 v_add_f32 v26, v26, v51
 v_add_f32 v26, v26, v56
 v_add_f32 v26, v26, v57
 v_add_f32 v26, v26, v58
 v_add_f32 v26, v26, v59
 v_cvt_pk_bf16_f32 v40, v48, v49
 v_cvt_pk_bf16_f32 v41, v50, v51
 v_cvt_pk_bf16_f32 v42, v56, v57
 v_cvt_pk_bf16_f32 v43, v58, v59
 v_add_f32 v27, v52, v53
 v_add_f32 v27, v27, v54
 v_add_f32 v27, v27, v55
 v_add_f32 v27, v27, v60
 v_add_f32 v27, v27, v61
 v_add_f32 v27, v27, v62
 v_add_f32 v27, v27, v63
 v_cvt_pk_bf16_f32 v44, v52, v53
 v_cvt_pk_bf16_f32 v45, v54, v55
 v_cvt_pk_bf16_f32 v46, v60, v61
 v_cvt_pk_bf16_f32 v47, v62, v63
 v_max_f32 v29, v26, v27
 v_cmp_lt_f32 vcc, 0x4f800000, v29
 s_nop 1
 s_or_b64 vcc, vcc, s[32:33]
 s_cbranch_vccnz mk_rs_30
mk_rs_30_ret:
 s_waitcnt lgkmcnt(6)
 PV 128,64,40
 RC 104,2,26624
 PV 132,64,44
 v_add_f32 v24, v24, v26
 v_add_f32 v25, v25, v27
 PV 140,68,44
 RC 108,2,27648
 PV 136,68,40
 PV 144,72,40
 RC 112,2,28672
 PV 148,72,44
 PV 156,76,44
 RC 116,2,29696
 PV 152,76,40
 s_waitcnt lgkmcnt(6)
 PV 160,80,40
 RC 120,2,30720
 PV 164,80,44
 PV 172,84,44
 RC 124,2,31744
 PV 168,84,40
 PV 176,88,40
 PV 180,88,44
 PV 188,92,44
 PV 184,92,40
 s_waitcnt lgkmcnt(4)
 PV 192,96,40
 PV 196,96,44
 PV 204,100,44
 PV 200,100,40
 PV 208,104,40
 PV 212,104,44
 PV 220,108,44
 PV 216,108,40
 s_waitcnt lgkmcnt(0)
 PV 224,112,40
 PV 228,112,44
 PV 236,116,44
 PV 232,116,40
 PV 240,120,40
 PV 244,120,44
 PV 252,124,44
 PV 248,124,40
 s_branch mk_t2_end
mk_t2_skip:
 s_waitcnt vmcnt(12)
 s_barrier
 s_add_u32 s25, s24, 0x18000
 s_and_b32 s25, s25, 0x1ffff
 s_add_u32 s24, s24, 0x8000
 s_and_b32 s24, s24, 0x1ffff
 s_add_u32 m0, s25, s27
 s_add_u32 s41, s36, s37
 s_nop 0
 DL 11,8,36,0
 DL 12,8,36,1024
 DL 13,8,36,2048
 DL 14,8,36,3072
 s_add_u32 m0, m0, 0x1000
 s_nop 0
 DL 11,8,41,0
 DL 12,8,41,1024
 DL 13,8,41,2048
 DL 14,8,41,3072
 s_add_u32 s36, s36, s38
mk_t2_end:
 s_cmp_eq_u32 s31, 3
 s_cbranch_scc1 mk_t3_diag
 s_cmp_lt_u32 s31, 3
 s_cbranch_scc1 mk_t3_skip
mk_t3_diag:
 s_waitcnt vmcnt(8)
 s_barrier
 v_add_u32 v2, s24, v1
 s_add_u32 s25, s24, 0x18000
 s_and_b32 s25, s25, 0x1ffff
 s_add_u32 s24, s24, 0x8000
 s_and_b32 s24, s24, 0x1ffff
 RC 64,2,16384
 RC 68,2,17408
 RC 72,2,18432
 RC 76,2,19456
 RC 80,2,20480
 RC 84,2,21504
 RC 88,2,22528
 RC 92,2,23552
 RC 96,2,24576
 RC 100,2,25600
 s_cmp_eq_u32 s35, 1
 s_cbranch_scc0 mk_ml_31
 v_readfirstlane_b32 s41, v95
 s_lshl_b32 s43, 1, s23
 s_mov_b32 s44, 0
 s_and_b32 s41, s41, s43
 s_cbranch_scc1 mk_ml_31_ok
mk_ml_31_sp:
 global_load_dword v95, v94, s[96:97] sc1
 s_waitcnt vmcnt(0)
 v_readfirstlane_b32 s41, v95
 s_add_u32 s44, s44, 1
 s_and_b32 s41, s41, s43
 s_cbranch_scc1 mk_ml_31_ok
 s_sleep 2
 s_cmp_lt_u32 s44, 0x40000
 s_cbranch_scc1 mk_ml_31_sp
mk_ml_31_ok:
 v_lshrrev_b32 v94, 1, v1
 buffer_load_dwordx2 v[92:93], v94, s[4:7], s58 offen sc1
 s_add_u32 s41, s57, 0
 buffer_load_dwordx4 a[160:163], v1, s[4:7], s41 offen offset:0 sc1
 s_add_u32 s41, s57, 0
 buffer_load_dwordx4 a[164:167], v1, s[4:7], s41 offen offset:1024 sc1
 s_add_u32 s41, s57, 0
 buffer_load_dwordx4 a[168:171], v1, s[4:7], s41 offen offset:2048 sc1
 s_add_u32 s41, s57, 0
 buffer_load_dwordx4 a[172:175], v1, s[4:7], s41 offen offset:3072 sc1
 s_add_u32 s41, s57, 4096
 buffer_load_dwordx4 a[176:179], v1, s[4:7], s41 offen offset:0 sc1
 s_add_u32 s41, s57, 4096
 buffer_load_dwordx4 a[180:183], v1, s[4:7], s41 offen offset:1024 sc1
 s_add_u32 s41, s57, 4096
 buffer_load_dwordx4 a[184:187], v1, s[4:7], s41 offen offset:2048 sc1
 s_add_u32 s41, s57, 4096
 buffer_load_dwordx4 a[188:191], v1, s[4:7], s41 offen offset:3072 sc1
 s_add_u32 s41, s57, 8192
 buffer_load_dwordx4 a[192:195], v1, s[4:7], s41 offen offset:0 sc1
 s_add_u32 s41, s57, 8192
 buffer_load_dwordx4 a[196:199], v1, s[4:7], s41 offen offset:1024 sc1
 s_add_u32 s41, s57, 8192
 buffer_load_dwordx4 a[200:203], v1, s[4:7], s41 offen offset:2048 sc1
 s_add_u32 s41, s57, 8192
 buffer_load_dwordx4 a[204:207], v1, s[4:7], s41 offen offset:3072 sc1
 s_add_u32 s41, s57, 12288
 buffer_load_dwordx4 a[208:211], v1, s[4:7], s41 offen offset:0 sc1
 s_add_u32 s41, s57, 12288
 buffer_load_dwordx4 a[212:215], v1, s[4:7], s41 offen offset:1024 sc1
 s_add_u32 s41, s57, 12288
 buffer_load_dwordx4 a[216:219], v1, s[4:7], s41 offen offset:2048 sc1
 s_add_u32 s41, s57, 12288
 buffer_load_dwordx4 a[220:223], v1, s[4:7], s41 offen offset:3072 sc1
mk_ml_31:
 s_add_u32 m0, s25, s27
 s_add_u32 s41, s36, s37
 s_nop 0
 DL 11,8,36,0
 DL 12,8,36,1024
 DL 13,8,36,2048
 DL 14,8,36,3072
 s_add_u32 m0, m0, 0x1000
 s_nop 0
 DL 11,8,41,0
 DL 12,8,41,1024
 DL 13,8,41,2048
 DL 14,8,41,3072
 s_add_u32 s36, s36, s38
 v_cmp_gt_i32 s[48:49], 0, v23
 v_cmp_gt_i32 s[50:51], 1, v23
 v_cmp_gt_i32 s[52:53], 2, v23
 v_cmp_gt_i32 s[54:55], 3, v23
 v_cndmask_b32 v112, v112, v28, s[48:49]
 v_cndmask_b32 v113, v113, v28, s[50:51]
 v_cndmask_b32 v114, v114, v28, s[52:53]
 v_cndmask_b32 v115, v115, v28, s[54:55]
 v_cmp_gt_i32 s[48:49], 16, v23
 v_cmp_gt_i32 s[50:51], 17, v23
 v_cmp_gt_i32 s[52:53], 18, v23
 v_cmp_gt_i32 s[54:55], 19, v23
 v_cndmask_b32 v120, v120, v28, s[48:49]
 v_cndmask_b32 v121, v121, v28, s[50:51]
 v_cndmask_b32 v122, v122, v28, s[52:53]
 v_cndmask_b32 v123, v123, v28, s[54:55]
 v_cmp_gt_i32 s[48:49], 0, v23
 v_cmp_gt_i32 s[50:51], 1, v23
 v_cmp_gt_i32 s[52:53], 2, v23
 v_cmp_gt_i32 s[54:55], 3, v23
 v_cndmask_b32 v124, v124, v28, s[48:49]
 v_cndmask_b32 v125, v125, v28, s[50:51]
 v_cndmask_b32 v126, v126, v28, s[52:53]
 v_cndmask_b32 v127, v127, v28, s[54:55]
 v_exp_f32 v48, v112
 v_exp_f32 v49, v113
 v_exp_f32 v50, v114
 v_exp_f32 v51, v115
 v_exp_f32 v56, v120
 v_exp_f32 v57, v121
 v_exp_f32 v58, v122
 v_exp_f32 v59, v123
 v_exp_f32 v52, v116
 v_exp_f32 v53, v117
 v_exp_f32 v54, v118
 v_exp_f32 v55, v119
 v_exp_f32 v60, v124
 v_exp_f32 v61, v125
 v_exp_f32 v62, v126
 v_exp_f32 v63, v127
 s_nop 0
 v_add_f32 v26, v48, v49
 v_add_f32 v26, v26, v50
 v_add_f32 v26, v26, v51
 v_add_f32 v26, v26, v56
 v_add_f32 v26, v26, v57
 v_add_f32 v26, v26, v58
 v_add_f32 v26, v26, v59
 v_cvt_pk_bf16_f32 v40, v48, v49
 v_cvt_pk_bf16_f32 v41, v50, v51
 v_cvt_pk_bf16_f32 v42, v56, v57
 v_cvt_pk_bf16_f32 v43, v58, v59
 v_add_f32 v27, v52, v53
 v_add_f32 v27, v27, v54
 v_add_f32 v27, v27, v55
 v_add_f32 v27, v27, v60
 v_add_f32 v27, v27, v61
 v_add_f32 v27, v27, v62
 v_add_f32 v27, v27, v63
 v_cvt_pk_bf16_f32 v44, v52, v53
 v_cvt_pk_bf16_f32 v45, v54, v55
 v_cvt_pk_bf16_f32 v46, v60, v61
 v_cvt_pk_bf16_f32 v47, v62, v63
 v_max_f32 v29, v26, v27
 v_cmp_lt_f32 vcc, 0x4f800000, v29
 s_nop 1
 s_or_b64 vcc, vcc, s[32:33]
 s_cbranch_vccnz mk_rs_32
mk_rs_32_ret:
 s_waitcnt lgkmcnt(6)
 PV 128,64,40
 RC 104,2,26624
 PV 132,64,44
 v_add_f32 v24, v24, v26
 v_add_f32 v25, v25, v27
 PV 140,68,44
 RC 108,2,27648
 PV 136,68,40
 PV 144,72,40
 RC 112,2,28672
 PV 148,72,44
 PV 156,76,44
 RC 116,2,29696
 PV 152,76,40
 s_waitcnt lgkmcnt(6)
 PV 160,80,40
 RC 120,2,30720
 PV 164,80,44
 PV 172,84,44
 RC 124,2,31744
 PV 168,84,40
 PV 176,88,40
 PV 180,88,44
 PV 188,92,44
 PV 184,92,40
 s_waitcnt lgkmcnt(4)
 PV 192,96,40
 PV 196,96,44
 PV 204,100,44
 PV 200,100,40
 PV 208,104,40
 PV 212,104,44
 PV 220,108,44
 PV 216,108,40
 s_waitcnt lgkmcnt(0)
 PV 224,112,40
 PV 228,112,44
 PV 236,116,44
 PV 232,116,40
 PV 240,120,40
 PV 244,120,44
 PV 252,124,44
 PV 248,124,40
 s_branch mk_t3_end
mk_t3_skip:
 s_waitcnt vmcnt(8)
 s_barrier
 s_add_u32 s25, s24, 0x18000
 s_and_b32 s25, s25, 0x1ffff
 s_add_u32 s24, s24, 0x8000
 s_and_b32 s24, s24, 0x1ffff
 s_add_u32 m0, s25, s27
 s_add_u32 s41, s36, s37
 s_nop 0
 DL 11,8,36,0
 DL 12,8,36,1024
 DL 13,8,36,2048
 DL 14,8,36,3072
 s_add_u32 m0, m0, 0x1000
 s_nop 0
 DL 11,8,41,0
 DL 12,8,41,1024
 DL 13,8,41,2048
 DL 14,8,41,3072
 s_add_u32 s36, s36, s38
mk_t3_end:
 s_nop 7
 v_mov_b32 v29, v24
 s_nop 1
 v_permlane16_swap_b32 v29, v24
 v_add_f32 v24, v24, v29
 v_mov_b32 v29, v24
 s_nop 1
 v_permlane32_swap_b32 v29, v24
 v_add_f32 v24, v24, v29
 v_mov_b32 v29, v25
 s_nop 1
 v_permlane16_swap_b32 v29, v25
 v_add_f32 v25, v25, v29
 v_mov_b32 v29, v25
 s_nop 1
 v_permlane32_swap_b32 v29, v25
 v_add_f32 v25, v25, v29
 s_cmp_eq_u32 s35, 2
 s_cbranch_scc1 mk_partial
 s_cmp_eq_u32 s35, 1
 s_cbranch_scc1 mk_merge
 v_rcp_f32 v26, v24
 v_rcp_f32 v27, v25
 s_nop 0
 v_mov_b32 v80, v26
 v_mov_b32 v81, v26
 v_mov_b32 v82, v27
 v_mov_b32 v83, v27
 v_pk_mul_f32 v[128:129], v[128:129], v[80:81]
 v_pk_mul_f32 v[130:131], v[130:131], v[80:81]
 v_pk_mul_f32 v[136:137], v[136:137], v[80:81]
 v_pk_mul_f32 v[138:139], v[138:139], v[80:81]
 v_cvt_pk_bf16_f32 v128, v128, v129
 v_cvt_pk_bf16_f32 v129, v130, v131
 v_cvt_pk_bf16_f32 v130, v136, v137
 v_cvt_pk_bf16_f32 v131, v138, v139
 v_pk_mul_f32 v[132:133], v[132:133], v[82:83]
 v_pk_mul_f32 v[134:135], v[134:135], v[82:83]
 v_pk_mul_f32 v[140:141], v[140:141], v[82:83]
 v_pk_mul_f32 v[142:143], v[142:143], v[82:83]
 v_cvt_pk_bf16_f32 v132, v132, v133
 v_cvt_pk_bf16_f32 v133, v134, v135
 v_cvt_pk_bf16_f32 v134, v140, v141
 v_cvt_pk_bf16_f32 v135, v142, v143
 v_pk_mul_f32 v[144:145], v[144:145], v[80:81]
 v_pk_mul_f32 v[146:147], v[146:147], v[80:81]
 v_pk_mul_f32 v[152:153], v[152:153], v[80:81]
 v_pk_mul_f32 v[154:155], v[154:155], v[80:81]
 v_cvt_pk_bf16_f32 v144, v144, v145
 v_cvt_pk_bf16_f32 v145, v146, v147
 v_cvt_pk_bf16_f32 v146, v152, v153
 v_cvt_pk_bf16_f32 v147, v154, v155
 v_pk_mul_f32 v[148:149], v[148:149], v[82:83]
 v_pk_mul_f32 v[150:151], v[150:151], v[82:83]
 v_pk_mul_f32 v[156:157], v[156:157], v[82:83]
 v_pk_mul_f32 v[158:159], v[158:159], v[82:83]
 v_cvt_pk_bf16_f32 v148, v148, v149
 v_cvt_pk_bf16_f32 v149, v150, v151
 v_cvt_pk_bf16_f32 v150, v156, v157
 v_cvt_pk_bf16_f32 v151, v158, v159
 v_pk_mul_f32 v[160:161], v[160:161], v[80:81]
 v_pk_mul_f32 v[162:163], v[162:163], v[80:81]
 v_pk_mul_f32 v[168:169], v[168:169], v[80:81]
 v_pk_mul_f32 v[170:171], v[170:171], v[80:81]
 v_cvt_pk_bf16_f32 v160, v160, v161
 v_cvt_pk_bf16_f32 v161, v162, v163
 v_cvt_pk_bf16_f32 v162, v168, v169
 v_cvt_pk_bf16_f32 v163, v170, v171
 v_pk_mul_f32 v[164:165], v[164:165], v[82:83]
 v_pk_mul_f32 v[166:167], v[166:167], v[82:83]
 v_pk_mul_f32 v[172:173], v[172:173], v[82:83]
 v_pk_mul_f32 v[174:175], v[174:175], v[82:83]
 v_cvt_pk_bf16_f32 v164, v164, v165
 v_cvt_pk_bf16_f32 v165, v166, v167
 v_cvt_pk_bf16_f32 v166, v172, v173
 v_cvt_pk_bf16_f32 v167, v174, v175
 v_pk_mul_f32 v[176:177], v[176:177], v[80:81]
 v_pk_mul_f32 v[178:179], v[178:179], v[80:81]
 v_pk_mul_f32 v[184:185], v[184:185], v[80:81]
 v_pk_mul_f32 v[186:187], v[186:187], v[80:81]
 v_cvt_pk_bf16_f32 v176, v176, v177
 v_cvt_pk_bf16_f32 v177, v178, v179
 v_cvt_pk_bf16_f32 v178, v184, v185
 v_cvt_pk_bf16_f32 v179, v186, v187
 v_pk_mul_f32 v[180:181], v[180:181], v[82:83]
 v_pk_mul_f32 v[182:183], v[182:183], v[82:83]
 v_pk_mul_f32 v[188:189], v[188:189], v[82:83]
 v_pk_mul_f32 v[190:191], v[190:191], v[82:83]
 v_cvt_pk_bf16_f32 v180, v180, v181
 v_cvt_pk_bf16_f32 v181, v182, v183
 v_cvt_pk_bf16_f32 v182, v188, v189
 v_cvt_pk_bf16_f32 v183, v190, v191
 v_pk_mul_f32 v[192:193], v[192:193], v[80:81]
 v_pk_mul_f32 v[194:195], v[194:195], v[80:81]
 v_pk_mul_f32 v[200:201], v[200:201], v[80:81]
 v_pk_mul_f32 v[202:203], v[202:203], v[80:81]
 v_cvt_pk_bf16_f32 v192, v192, v193
 v_cvt_pk_bf16_f32 v193, v194, v195
 v_cvt_pk_bf16_f32 v194, v200, v201
 v_cvt_pk_bf16_f32 v195, v202, v203
 v_pk_mul_f32 v[196:197], v[196:197], v[82:83]
 v_pk_mul_f32 v[198:199], v[198:199], v[82:83]
 v_pk_mul_f32 v[204:205], v[204:205], v[82:83]
 v_pk_mul_f32 v[206:207], v[206:207], v[82:83]
 v_cvt_pk_bf16_f32 v196, v196, v197
 v_cvt_pk_bf16_f32 v197, v198, v199
 v_cvt_pk_bf16_f32 v198, v204, v205
 v_cvt_pk_bf16_f32 v199, v206, v207
 v_pk_mul_f32 v[208:209], v[208:209], v[80:81]
 v_pk_mul_f32 v[210:211], v[210:211], v[80:81]
 v_pk_mul_f32 v[216:217], v[216:217], v[80:81]
 v_pk_mul_f32 v[218:219], v[218:219], v[80:81]
 v_cvt_pk_bf16_f32 v208, v208, v209
 v_cvt_pk_bf16_f32 v209, v210, v211
 v_cvt_pk_bf16_f32 v210, v216, v217
 v_cvt_pk_bf16_f32 v211, v218, v219
 v_pk_mul_f32 v[212:213], v[212:213], v[82:83]
 v_pk_mul_f32 v[214:215], v[214:215], v[82:83]
 v_pk_mul_f32 v[220:221], v[220:221], v[82:83]
 v_pk_mul_f32 v[222:223], v[222:223], v[82:83]
 v_cvt_pk_bf16_f32 v212, v212, v213
 v_cvt_pk_bf16_f32 v213, v214, v215
 v_cvt_pk_bf16_f32 v214, v220, v221
 v_cvt_pk_bf16_f32 v215, v222, v223
 v_pk_mul_f32 v[224:225], v[224:225], v[80:81]
 v_pk_mul_f32 v[226:227], v[226:227], v[80:81]
 v_pk_mul_f32 v[232:233], v[232:233], v[80:81]
 v_pk_mul_f32 v[234:235], v[234:235], v[80:81]
 v_cvt_pk_bf16_f32 v224, v224, v225
 v_cvt_pk_bf16_f32 v225, v226, v227
 v_cvt_pk_bf16_f32 v226, v232, v233
 v_cvt_pk_bf16_f32 v227, v234, v235
 v_pk_mul_f32 v[228:229], v[228:229], v[82:83]
 v_pk_mul_f32 v[230:231], v[230:231], v[82:83]
 v_pk_mul_f32 v[236:237], v[236:237], v[82:83]
 v_pk_mul_f32 v[238:239], v[238:239], v[82:83]
 v_cvt_pk_bf16_f32 v228, v228, v229
 v_cvt_pk_bf16_f32 v229, v230, v231
 v_cvt_pk_bf16_f32 v230, v236, v237
 v_cvt_pk_bf16_f32 v231, v238, v239
 v_pk_mul_f32 v[240:241], v[240:241], v[80:81]
 v_pk_mul_f32 v[242:243], v[242:243], v[80:81]
 v_pk_mul_f32 v[248:249], v[248:249], v[80:81]
 v_pk_mul_f32 v[250:251], v[250:251], v[80:81]
 v_cvt_pk_bf16_f32 v240, v240, v241
 v_cvt_pk_bf16_f32 v241, v242, v243
 v_cvt_pk_bf16_f32 v242, v248, v249
 v_cvt_pk_bf16_f32 v243, v250, v251
 v_pk_mul_f32 v[244:245], v[244:245], v[82:83]
 v_pk_mul_f32 v[246:247], v[246:247], v[82:83]
 v_pk_mul_f32 v[252:253], v[252:253], v[82:83]
 v_pk_mul_f32 v[254:255], v[254:255], v[82:83]
 v_cvt_pk_bf16_f32 v244, v244, v245
 v_cvt_pk_bf16_f32 v245, v246, v247
 v_cvt_pk_bf16_f32 v246, v252, v253
 v_cvt_pk_bf16_f32 v247, v254, v255
 s_branch mk_oproj
mk_merge:
 v_log_f32 v66, v24
 v_rcp_f32 v26, v24
 v_log_f32 v67, v25
 v_rcp_f32 v27, v25
 s_nop 0
 v_sub_f32 v66, v66, v32
 v_sub_f32 v67, v67, v36
 s_waitcnt vmcnt(24)
 v_max_f32 v68, v66, v92
 v_sub_f32 v66, v66, v68
 v_sub_f32 v92, v92, v68
 v_exp_f32 v66, v66
 v_exp_f32 v92, v92
 s_nop 0
 v_add_f32 v68, v66, v92
 v_rcp_f32 v68, v68
 s_nop 0
 v_mul_f32 v66, v66, v68
 v_mul_f32 v92, v92, v68
 v_mul_f32 v66, v66, v26
 v_max_f32 v68, v67, v93
 v_sub_f32 v67, v67, v68
 v_sub_f32 v93, v93, v68
 v_exp_f32 v67, v67
 v_exp_f32 v93, v93
 s_nop 0
 v_add_f32 v68, v67, v93
 v_rcp_f32 v68, v68
 s_nop 0
 v_mul_f32 v67, v67, v68
 v_mul_f32 v93, v93, v68
 v_mul_f32 v67, v67, v27
 v_mov_b32 v80, v66
 v_mov_b32 v81, v66
 v_mov_b32 v82, v67
 v_mov_b32 v83, v67
 v_mov_b32 v84, v92
 v_mov_b32 v85, v92
 v_mov_b32 v86, v93
 v_mov_b32 v87, v93
 s_waitcnt vmcnt(23)
 v_accvgpr_read_b32 v72, a160
 v_accvgpr_read_b32 v73, a161
 v_accvgpr_read_b32 v74, a162
 v_accvgpr_read_b32 v75, a163
 v_lshlrev_b32 v76, 16, v72
 v_and_b32 v77, 0xffff0000, v72
 v_pk_mul_f32 v[128:129], v[128:129], v[80:81]
 v_pk_fma_f32 v[128:129], v[76:77], v[84:85], v[128:129]
 v_lshlrev_b32 v78, 16, v73
 v_and_b32 v79, 0xffff0000, v73
 v_pk_mul_f32 v[130:131], v[130:131], v[80:81]
 v_pk_fma_f32 v[130:131], v[78:79], v[84:85], v[130:131]
 v_lshlrev_b32 v76, 16, v74
 v_and_b32 v77, 0xffff0000, v74
 v_pk_mul_f32 v[136:137], v[136:137], v[80:81]
 v_pk_fma_f32 v[136:137], v[76:77], v[84:85], v[136:137]
 v_lshlrev_b32 v78, 16, v75
 v_and_b32 v79, 0xffff0000, v75
 v_pk_mul_f32 v[138:139], v[138:139], v[80:81]
 v_pk_fma_f32 v[138:139], v[78:79], v[84:85], v[138:139]
 v_cvt_pk_bf16_f32 v128, v128, v129
 v_cvt_pk_bf16_f32 v129, v130, v131
 v_cvt_pk_bf16_f32 v130, v136, v137
 v_cvt_pk_bf16_f32 v131, v138, v139
 s_waitcnt vmcnt(22)
 v_accvgpr_read_b32 v72, a164
 v_accvgpr_read_b32 v73, a165
 v_accvgpr_read_b32 v74, a166
 v_accvgpr_read_b32 v75, a167
 v_lshlrev_b32 v76, 16, v72
 v_and_b32 v77, 0xffff0000, v72
 v_pk_mul_f32 v[132:133], v[132:133], v[82:83]
 v_pk_fma_f32 v[132:133], v[76:77], v[86:87], v[132:133]
 v_lshlrev_b32 v78, 16, v73
 v_and_b32 v79, 0xffff0000, v73
 v_pk_mul_f32 v[134:135], v[134:135], v[82:83]
 v_pk_fma_f32 v[134:135], v[78:79], v[86:87], v[134:135]
 v_lshlrev_b32 v76, 16, v74
 v_and_b32 v77, 0xffff0000, v74
 v_pk_mul_f32 v[140:141], v[140:141], v[82:83]
 v_pk_fma_f32 v[140:141], v[76:77], v[86:87], v[140:141]
 v_lshlrev_b32 v78, 16, v75
 v_and_b32 v79, 0xffff0000, v75
 v_pk_mul_f32 v[142:143], v[142:143], v[82:83]
 v_pk_fma_f32 v[142:143], v[78:79], v[86:87], v[142:143]
 v_cvt_pk_bf16_f32 v132, v132, v133
 v_cvt_pk_bf16_f32 v133, v134, v135
 v_cvt_pk_bf16_f32 v134, v140, v141
 v_cvt_pk_bf16_f32 v135, v142, v143
 s_waitcnt vmcnt(21)
 v_accvgpr_read_b32 v72, a168
 v_accvgpr_read_b32 v73, a169
 v_accvgpr_read_b32 v74, a170
 v_accvgpr_read_b32 v75, a171
 v_lshlrev_b32 v76, 16, v72
 v_and_b32 v77, 0xffff0000, v72
 v_pk_mul_f32 v[144:145], v[144:145], v[80:81]
 v_pk_fma_f32 v[144:145], v[76:77], v[84:85], v[144:145]
 v_lshlrev_b32 v78, 16, v73
 v_and_b32 v79, 0xffff0000, v73
 v_pk_mul_f32 v[146:147], v[146:147], v[80:81]
 v_pk_fma_f32 v[146:147], v[78:79], v[84:85], v[146:147]
 v_lshlrev_b32 v76, 16, v74
 v_and_b32 v77, 0xffff0000, v74
 v_pk_mul_f32 v[152:153], v[152:153], v[80:81]
 v_pk_fma_f32 v[152:153], v[76:77], v[84:85], v[152:153]
 v_lshlrev_b32 v78, 16, v75
 v_and_b32 v79, 0xffff0000, v75
 v_pk_mul_f32 v[154:155], v[154:155], v[80:81]
 v_pk_fma_f32 v[154:155], v[78:79], v[84:85], v[154:155]
 v_cvt_pk_bf16_f32 v144, v144, v145
 v_cvt_pk_bf16_f32 v145, v146, v147
 v_cvt_pk_bf16_f32 v146, v152, v153
 v_cvt_pk_bf16_f32 v147, v154, v155
 s_waitcnt vmcnt(20)
 v_accvgpr_read_b32 v72, a172
 v_accvgpr_read_b32 v73, a173
 v_accvgpr_read_b32 v74, a174
 v_accvgpr_read_b32 v75, a175
 v_lshlrev_b32 v76, 16, v72
 v_and_b32 v77, 0xffff0000, v72
 v_pk_mul_f32 v[148:149], v[148:149], v[82:83]
 v_pk_fma_f32 v[148:149], v[76:77], v[86:87], v[148:149]
 v_lshlrev_b32 v78, 16, v73
 v_and_b32 v79, 0xffff0000, v73
 v_pk_mul_f32 v[150:151], v[150:151], v[82:83]
 v_pk_fma_f32 v[150:151], v[78:79], v[86:87], v[150:151]
 v_lshlrev_b32 v76, 16, v74
 v_and_b32 v77, 0xffff0000, v74
 v_pk_mul_f32 v[156:157], v[156:157], v[82:83]
 v_pk_fma_f32 v[156:157], v[76:77], v[86:87], v[156:157]
 v_lshlrev_b32 v78, 16, v75
 v_and_b32 v79, 0xffff0000, v75
 v_pk_mul_f32 v[158:159], v[158:159], v[82:83]
 v_pk_fma_f32 v[158:159], v[78:79], v[86:87], v[158:159]
 v_cvt_pk_bf16_f32 v148, v148, v149
 v_cvt_pk_bf16_f32 v149, v150, v151
 v_cvt_pk_bf16_f32 v150, v156, v157
 v_cvt_pk_bf16_f32 v151, v158, v159
 s_waitcnt vmcnt(19)
 v_accvgpr_read_b32 v72, a176
 v_accvgpr_read_b32 v73, a177
 v_accvgpr_read_b32 v74, a178
 v_accvgpr_read_b32 v75, a179
 v_lshlrev_b32 v76, 16, v72
 v_and_b32 v77, 0xffff0000, v72
 v_pk_mul_f32 v[160:161], v[160:161], v[80:81]
 v_pk_fma_f32 v[160:161], v[76:77], v[84:85], v[160:161]
 v_lshlrev_b32 v78, 16, v73
 v_and_b32 v79, 0xffff0000, v73
 v_pk_mul_f32 v[162:163], v[162:163], v[80:81]
 v_pk_fma_f32 v[162:163], v[78:79], v[84:85], v[162:163]
 v_lshlrev_b32 v76, 16, v74
 v_and_b32 v77, 0xffff0000, v74
 v_pk_mul_f32 v[168:169], v[168:169], v[80:81]
 v_pk_fma_f32 v[168:169], v[76:77], v[84:85], v[168:169]
 v_lshlrev_b32 v78, 16, v75
 v_and_b32 v79, 0xffff0000, v75
 v_pk_mul_f32 v[170:171], v[170:171], v[80:81]
 v_pk_fma_f32 v[170:171], v[78:79], v[84:85], v[170:171]
 v_cvt_pk_bf16_f32 v160, v160, v161
 v_cvt_pk_bf16_f32 v161, v162, v163
 v_cvt_pk_bf16_f32 v162, v168, v169
 v_cvt_pk_bf16_f32 v163, v170, v171
 s_waitcnt vmcnt(18)
 v_accvgpr_read_b32 v72, a180
 v_accvgpr_read_b32 v73, a181
 v_accvgpr_read_b32 v74, a182
 v_accvgpr_read_b32 v75, a183
 v_lshlrev_b32 v76, 16, v72
 v_and_b32 v77, 0xffff0000, v72
 v_pk_mul_f32 v[164:165], v[164:165], v[82:83]
 v_pk_fma_f32 v[164:165], v[76:77], v[86:87], v[164:165]
 v_lshlrev_b32 v78, 16, v73
 v_and_b32 v79, 0xffff0000, v73
 v_pk_mul_f32 v[166:167], v[166:167], v[82:83]
 v_pk_fma_f32 v[166:167], v[78:79], v[86:87], v[166:167]
 v_lshlrev_b32 v76, 16, v74
 v_and_b32 v77, 0xffff0000, v74
 v_pk_mul_f32 v[172:173], v[172:173], v[82:83]
 v_pk_fma_f32 v[172:173], v[76:77], v[86:87], v[172:173]
 v_lshlrev_b32 v78, 16, v75
 v_and_b32 v79, 0xffff0000, v75
 v_pk_mul_f32 v[174:175], v[174:175], v[82:83]
 v_pk_fma_f32 v[174:175], v[78:79], v[86:87], v[174:175]
 v_cvt_pk_bf16_f32 v164, v164, v165
 v_cvt_pk_bf16_f32 v165, v166, v167
 v_cvt_pk_bf16_f32 v166, v172, v173
 v_cvt_pk_bf16_f32 v167, v174, v175
 s_waitcnt vmcnt(17)
 v_accvgpr_read_b32 v72, a184
 v_accvgpr_read_b32 v73, a185
 v_accvgpr_read_b32 v74, a186
 v_accvgpr_read_b32 v75, a187
 v_lshlrev_b32 v76, 16, v72
 v_and_b32 v77, 0xffff0000, v72
 v_pk_mul_f32 v[176:177], v[176:177], v[80:81]
 v_pk_fma_f32 v[176:177], v[76:77], v[84:85], v[176:177]
 v_lshlrev_b32 v78, 16, v73
 v_and_b32 v79, 0xffff0000, v73
 v_pk_mul_f32 v[178:179], v[178:179], v[80:81]
 v_pk_fma_f32 v[178:179], v[78:79], v[84:85], v[178:179]
 v_lshlrev_b32 v76, 16, v74
 v_and_b32 v77, 0xffff0000, v74
 v_pk_mul_f32 v[184:185], v[184:185], v[80:81]
 v_pk_fma_f32 v[184:185], v[76:77], v[84:85], v[184:185]
 v_lshlrev_b32 v78, 16, v75
 v_and_b32 v79, 0xffff0000, v75
 v_pk_mul_f32 v[186:187], v[186:187], v[80:81]
 v_pk_fma_f32 v[186:187], v[78:79], v[84:85], v[186:187]
 v_cvt_pk_bf16_f32 v176, v176, v177
 v_cvt_pk_bf16_f32 v177, v178, v179
 v_cvt_pk_bf16_f32 v178, v184, v185
 v_cvt_pk_bf16_f32 v179, v186, v187
 s_waitcnt vmcnt(16)
 v_accvgpr_read_b32 v72, a188
 v_accvgpr_read_b32 v73, a189
 v_accvgpr_read_b32 v74, a190
 v_accvgpr_read_b32 v75, a191
 v_lshlrev_b32 v76, 16, v72
 v_and_b32 v77, 0xffff0000, v72
 v_pk_mul_f32 v[180:181], v[180:181], v[82:83]
 v_pk_fma_f32 v[180:181], v[76:77], v[86:87], v[180:181]
 v_lshlrev_b32 v78, 16, v73
 v_and_b32 v79, 0xffff0000, v73
 v_pk_mul_f32 v[182:183], v[182:183], v[82:83]
 v_pk_fma_f32 v[182:183], v[78:79], v[86:87], v[182:183]
 v_lshlrev_b32 v76, 16, v74
 v_and_b32 v77, 0xffff0000, v74
 v_pk_mul_f32 v[188:189], v[188:189], v[82:83]
 v_pk_fma_f32 v[188:189], v[76:77], v[86:87], v[188:189]
 v_lshlrev_b32 v78, 16, v75
 v_and_b32 v79, 0xffff0000, v75
 v_pk_mul_f32 v[190:191], v[190:191], v[82:83]
 v_pk_fma_f32 v[190:191], v[78:79], v[86:87], v[190:191]
 v_cvt_pk_bf16_f32 v180, v180, v181
 v_cvt_pk_bf16_f32 v181, v182, v183
 v_cvt_pk_bf16_f32 v182, v188, v189
 v_cvt_pk_bf16_f32 v183, v190, v191
 s_waitcnt vmcnt(15)
 v_accvgpr_read_b32 v72, a192
 v_accvgpr_read_b32 v73, a193
 v_accvgpr_read_b32 v74, a194
 v_accvgpr_read_b32 v75, a195
 v_lshlrev_b32 v76, 16, v72
 v_and_b32 v77, 0xffff0000, v72
 v_pk_mul_f32 v[192:193], v[192:193], v[80:81]
 v_pk_fma_f32 v[192:193], v[76:77], v[84:85], v[192:193]
 v_lshlrev_b32 v78, 16, v73
 v_and_b32 v79, 0xffff0000, v73
 v_pk_mul_f32 v[194:195], v[194:195], v[80:81]
 v_pk_fma_f32 v[194:195], v[78:79], v[84:85], v[194:195]
 v_lshlrev_b32 v76, 16, v74
 v_and_b32 v77, 0xffff0000, v74
 v_pk_mul_f32 v[200:201], v[200:201], v[80:81]
 v_pk_fma_f32 v[200:201], v[76:77], v[84:85], v[200:201]
 v_lshlrev_b32 v78, 16, v75
 v_and_b32 v79, 0xffff0000, v75
 v_pk_mul_f32 v[202:203], v[202:203], v[80:81]
 v_pk_fma_f32 v[202:203], v[78:79], v[84:85], v[202:203]
 v_cvt_pk_bf16_f32 v192, v192, v193
 v_cvt_pk_bf16_f32 v193, v194, v195
 v_cvt_pk_bf16_f32 v194, v200, v201
 v_cvt_pk_bf16_f32 v195, v202, v203
 s_waitcnt vmcnt(14)
 v_accvgpr_read_b32 v72, a196
 v_accvgpr_read_b32 v73, a197
 v_accvgpr_read_b32 v74, a198
 v_accvgpr_read_b32 v75, a199
 v_lshlrev_b32 v76, 16, v72
 v_and_b32 v77, 0xffff0000, v72
 v_pk_mul_f32 v[196:197], v[196:197], v[82:83]
 v_pk_fma_f32 v[196:197], v[76:77], v[86:87], v[196:197]
 v_lshlrev_b32 v78, 16, v73
 v_and_b32 v79, 0xffff0000, v73
 v_pk_mul_f32 v[198:199], v[198:199], v[82:83]
 v_pk_fma_f32 v[198:199], v[78:79], v[86:87], v[198:199]
 v_lshlrev_b32 v76, 16, v74
 v_and_b32 v77, 0xffff0000, v74
 v_pk_mul_f32 v[204:205], v[204:205], v[82:83]
 v_pk_fma_f32 v[204:205], v[76:77], v[86:87], v[204:205]
 v_lshlrev_b32 v78, 16, v75
 v_and_b32 v79, 0xffff0000, v75
 v_pk_mul_f32 v[206:207], v[206:207], v[82:83]
 v_pk_fma_f32 v[206:207], v[78:79], v[86:87], v[206:207]
 v_cvt_pk_bf16_f32 v196, v196, v197
 v_cvt_pk_bf16_f32 v197, v198, v199
 v_cvt_pk_bf16_f32 v198, v204, v205
 v_cvt_pk_bf16_f32 v199, v206, v207
 s_waitcnt vmcnt(13)
 v_accvgpr_read_b32 v72, a200
 v_accvgpr_read_b32 v73, a201
 v_accvgpr_read_b32 v74, a202
 v_accvgpr_read_b32 v75, a203
 v_lshlrev_b32 v76, 16, v72
 v_and_b32 v77, 0xffff0000, v72
 v_pk_mul_f32 v[208:209], v[208:209], v[80:81]
 v_pk_fma_f32 v[208:209], v[76:77], v[84:85], v[208:209]
 v_lshlrev_b32 v78, 16, v73
 v_and_b32 v79, 0xffff0000, v73
 v_pk_mul_f32 v[210:211], v[210:211], v[80:81]
 v_pk_fma_f32 v[210:211], v[78:79], v[84:85], v[210:211]
 v_lshlrev_b32 v76, 16, v74
 v_and_b32 v77, 0xffff0000, v74
 v_pk_mul_f32 v[216:217], v[216:217], v[80:81]
 v_pk_fma_f32 v[216:217], v[76:77], v[84:85], v[216:217]
 v_lshlrev_b32 v78, 16, v75
 v_and_b32 v79, 0xffff0000, v75
 v_pk_mul_f32 v[218:219], v[218:219], v[80:81]
 v_pk_fma_f32 v[218:219], v[78:79], v[84:85], v[218:219]
 v_cvt_pk_bf16_f32 v208, v208, v209
 v_cvt_pk_bf16_f32 v209, v210, v211
 v_cvt_pk_bf16_f32 v210, v216, v217
 v_cvt_pk_bf16_f32 v211, v218, v219
 s_waitcnt vmcnt(12)
 v_accvgpr_read_b32 v72, a204
 v_accvgpr_read_b32 v73, a205
 v_accvgpr_read_b32 v74, a206
 v_accvgpr_read_b32 v75, a207
 v_lshlrev_b32 v76, 16, v72
 v_and_b32 v77, 0xffff0000, v72
 v_pk_mul_f32 v[212:213], v[212:213], v[82:83]
 v_pk_fma_f32 v[212:213], v[76:77], v[86:87], v[212:213]
 v_lshlrev_b32 v78, 16, v73
 v_and_b32 v79, 0xffff0000, v73
 v_pk_mul_f32 v[214:215], v[214:215], v[82:83]
 v_pk_fma_f32 v[214:215], v[78:79], v[86:87], v[214:215]
 v_lshlrev_b32 v76, 16, v74
 v_and_b32 v77, 0xffff0000, v74
 v_pk_mul_f32 v[220:221], v[220:221], v[82:83]
 v_pk_fma_f32 v[220:221], v[76:77], v[86:87], v[220:221]
 v_lshlrev_b32 v78, 16, v75
 v_and_b32 v79, 0xffff0000, v75
 v_pk_mul_f32 v[222:223], v[222:223], v[82:83]
 v_pk_fma_f32 v[222:223], v[78:79], v[86:87], v[222:223]
 v_cvt_pk_bf16_f32 v212, v212, v213
 v_cvt_pk_bf16_f32 v213, v214, v215
 v_cvt_pk_bf16_f32 v214, v220, v221
 v_cvt_pk_bf16_f32 v215, v222, v223
 s_waitcnt vmcnt(11)
 v_accvgpr_read_b32 v72, a208
 v_accvgpr_read_b32 v73, a209
 v_accvgpr_read_b32 v74, a210
 v_accvgpr_read_b32 v75, a211
 v_lshlrev_b32 v76, 16, v72
 v_and_b32 v77, 0xffff0000, v72
 v_pk_mul_f32 v[224:225], v[224:225], v[80:81]
 v_pk_fma_f32 v[224:225], v[76:77], v[84:85], v[224:225]
 v_lshlrev_b32 v78, 16, v73
 v_and_b32 v79, 0xffff0000, v73
 v_pk_mul_f32 v[226:227], v[226:227], v[80:81]
 v_pk_fma_f32 v[226:227], v[78:79], v[84:85], v[226:227]
 v_lshlrev_b32 v76, 16, v74
 v_and_b32 v77, 0xffff0000, v74
 v_pk_mul_f32 v[232:233], v[232:233], v[80:81]
 v_pk_fma_f32 v[232:233], v[76:77], v[84:85], v[232:233]
 v_lshlrev_b32 v78, 16, v75
 v_and_b32 v79, 0xffff0000, v75
 v_pk_mul_f32 v[234:235], v[234:235], v[80:81]
 v_pk_fma_f32 v[234:235], v[78:79], v[84:85], v[234:235]
 v_cvt_pk_bf16_f32 v224, v224, v225
 v_cvt_pk_bf16_f32 v225, v226, v227
 v_cvt_pk_bf16_f32 v226, v232, v233
 v_cvt_pk_bf16_f32 v227, v234, v235
 s_waitcnt vmcnt(10)
 v_accvgpr_read_b32 v72, a212
 v_accvgpr_read_b32 v73, a213
 v_accvgpr_read_b32 v74, a214
 v_accvgpr_read_b32 v75, a215
 v_lshlrev_b32 v76, 16, v72
 v_and_b32 v77, 0xffff0000, v72
 v_pk_mul_f32 v[228:229], v[228:229], v[82:83]
 v_pk_fma_f32 v[228:229], v[76:77], v[86:87], v[228:229]
 v_lshlrev_b32 v78, 16, v73
 v_and_b32 v79, 0xffff0000, v73
 v_pk_mul_f32 v[230:231], v[230:231], v[82:83]
 v_pk_fma_f32 v[230:231], v[78:79], v[86:87], v[230:231]
 v_lshlrev_b32 v76, 16, v74
 v_and_b32 v77, 0xffff0000, v74
 v_pk_mul_f32 v[236:237], v[236:237], v[82:83]
 v_pk_fma_f32 v[236:237], v[76:77], v[86:87], v[236:237]
 v_lshlrev_b32 v78, 16, v75
 v_and_b32 v79, 0xffff0000, v75
 v_pk_mul_f32 v[238:239], v[238:239], v[82:83]
 v_pk_fma_f32 v[238:239], v[78:79], v[86:87], v[238:239]
 v_cvt_pk_bf16_f32 v228, v228, v229
 v_cvt_pk_bf16_f32 v229, v230, v231
 v_cvt_pk_bf16_f32 v230, v236, v237
 v_cvt_pk_bf16_f32 v231, v238, v239
 s_waitcnt vmcnt(9)
 v_accvgpr_read_b32 v72, a216
 v_accvgpr_read_b32 v73, a217
 v_accvgpr_read_b32 v74, a218
 v_accvgpr_read_b32 v75, a219
 v_lshlrev_b32 v76, 16, v72
 v_and_b32 v77, 0xffff0000, v72
 v_pk_mul_f32 v[240:241], v[240:241], v[80:81]
 v_pk_fma_f32 v[240:241], v[76:77], v[84:85], v[240:241]
 v_lshlrev_b32 v78, 16, v73
 v_and_b32 v79, 0xffff0000, v73
 v_pk_mul_f32 v[242:243], v[242:243], v[80:81]
 v_pk_fma_f32 v[242:243], v[78:79], v[84:85], v[242:243]
 v_lshlrev_b32 v76, 16, v74
 v_and_b32 v77, 0xffff0000, v74
 v_pk_mul_f32 v[248:249], v[248:249], v[80:81]
 v_pk_fma_f32 v[248:249], v[76:77], v[84:85], v[248:249]
 v_lshlrev_b32 v78, 16, v75
 v_and_b32 v79, 0xffff0000, v75
 v_pk_mul_f32 v[250:251], v[250:251], v[80:81]
 v_pk_fma_f32 v[250:251], v[78:79], v[84:85], v[250:251]
 v_cvt_pk_bf16_f32 v240, v240, v241
 v_cvt_pk_bf16_f32 v241, v242, v243
 v_cvt_pk_bf16_f32 v242, v248, v249
 v_cvt_pk_bf16_f32 v243, v250, v251
 s_waitcnt vmcnt(8)
 v_accvgpr_read_b32 v72, a220
 v_accvgpr_read_b32 v73, a221
 v_accvgpr_read_b32 v74, a222
 v_accvgpr_read_b32 v75, a223
 v_lshlrev_b32 v76, 16, v72
 v_and_b32 v77, 0xffff0000, v72
 v_pk_mul_f32 v[244:245], v[244:245], v[82:83]
 v_pk_fma_f32 v[244:245], v[76:77], v[86:87], v[244:245]
 v_lshlrev_b32 v78, 16, v73
 v_and_b32 v79, 0xffff0000, v73
 v_pk_mul_f32 v[246:247], v[246:247], v[82:83]
 v_pk_fma_f32 v[246:247], v[78:79], v[86:87], v[246:247]
 v_lshlrev_b32 v76, 16, v74
 v_and_b32 v77, 0xffff0000, v74
 v_pk_mul_f32 v[252:253], v[252:253], v[82:83]
 v_pk_fma_f32 v[252:253], v[76:77], v[86:87], v[252:253]
 v_lshlrev_b32 v78, 16, v75
 v_and_b32 v79, 0xffff0000, v75
 v_pk_mul_f32 v[254:255], v[254:255], v[82:83]
 v_pk_fma_f32 v[254:255], v[78:79], v[86:87], v[254:255]
 v_cvt_pk_bf16_f32 v244, v244, v245
 v_cvt_pk_bf16_f32 v245, v246, v247
 v_cvt_pk_bf16_f32 v246, v252, v253
 v_cvt_pk_bf16_f32 v247, v254, v255
mk_oproj:
 s_getpc_b64 s[98:99]
mk_ct_33:
 s_add_u32 s98, s98, mk_oproj-mk_ct_33
 s_addc_u32 s99, s99, -1
 s_lshr_b32 s41, s2, 3
 s_lshl_b32 s41, s41, 2
 s_add_u32 s41, s41, s20
 s_lshl_b32 s41, s41, 7
 v_lshrrev_b32 v29, 4, v1
 v_min_u32 v29, 3, v29
 v_lshlrev_b32 v29, 14, v29
 v_add_u32 v29, s41, v29
 v_min_u32 v29, (mk_done-mk_oproj)-4, v29
 v_and_b32 v29, 0xfffffffc, v29
 global_load_dword v30, v29, s[98:99]
 s_load_dwordx4 s[80:83], s[0:1], 56
 s_load_dwordx2 s[84:85], s[0:1], 72
 s_mov_b32 s63, s21
 s_mov_b32 s64, s39
 s_lshl_b32 s70, s39, 4
 s_add_u32 s70, s70, s21
 s_and_b32 s68, s20, 1
 s_lshr_b32 s69, s20, 1
 v_and_b32 v44, 63, v0
 s_mul_i32 s41, s68, 448
 v_add_u32 v40, s41, v44
 v_add_u32 v41, 0, v40
 v_mul_u32_u24 v42, 4682, v41
 v_lshrrev_b32 v42, 16, v42
 v_mul_u32_u24 v43, 14, v42
 v_sub_u32 v43, v41, v43
 v_mul_u32_u24 v42, 3584, v42
 v_lshl_add_u32 v32, v43, 4, v42
 v_add_u32 v41, 64, v40
 v_mul_u32_u24 v42, 4682, v41
 v_lshrrev_b32 v42, 16, v42
 v_mul_u32_u24 v43, 14, v42
 v_sub_u32 v43, v41, v43
 v_mul_u32_u24 v42, 3584, v42
 v_lshl_add_u32 v33, v43, 4, v42
 v_subrev_u32 v33, 1024, v33
 v_add_u32 v41, 128, v40
 v_mul_u32_u24 v42, 4682, v41
 v_lshrrev_b32 v42, 16, v42
 v_mul_u32_u24 v43, 14, v42
 v_sub_u32 v43, v41, v43
 v_mul_u32_u24 v42, 3584, v42
 v_lshl_add_u32 v34, v43, 4, v42
 v_subrev_u32 v34, 2048, v34
 v_add_u32 v41, 192, v40
 v_mul_u32_u24 v42, 4682, v41
 v_lshrrev_b32 v42, 16, v42
 v_mul_u32_u24 v43, 14, v42
 v_sub_u32 v43, v41, v43
 v_mul_u32_u24 v42, 3584, v42
 v_lshl_add_u32 v35, v43, 4, v42
 v_subrev_u32 v35, 3072, v35
 v_add_u32 v41, 256, v40
 v_mul_u32_u24 v42, 4682, v41
 v_lshrrev_b32 v42, 16, v42
 v_mul_u32_u24 v43, 14, v42
 v_sub_u32 v43, v41, v43
 v_mul_u32_u24 v42, 3584, v42
 v_lshl_add_u32 v36, v43, 4, v42
 v_add_u32 v41, 320, v40
 v_mul_u32_u24 v42, 4682, v41
 v_lshrrev_b32 v42, 16, v42
 v_mul_u32_u24 v43, 14, v42
 v_sub_u32 v43, v41, v43
 v_mul_u32_u24 v42, 3584, v42
 v_lshl_add_u32 v37, v43, 4, v42
 v_subrev_u32 v37, 1024, v37
 v_add_u32 v41, 384, v40
 v_mul_u32_u24 v42, 4682, v41
 v_lshrrev_b32 v42, 16, v42
 v_mul_u32_u24 v43, 14, v42
 v_sub_u32 v43, v41, v43
 v_mul_u32_u24 v42, 3584, v42
 v_lshl_add_u32 v38, v43, 4, v42
 v_subrev_u32 v38, 2048, v38
 s_mul_i32 s60, s63, 224
 s_mul_i32 s61, s69, 14336
 s_mul_i32 s41, s68, 7168
 s_add_u32 s61, s61, s41
 s_mul_i32 s62, s63, 112
 s_mul_i32 s41, s68, 56
 s_add_u32 s62, s62, s41
 s_mul_i32 s62, s62, 896
 s_lshl_b32 s41, s69, 7
 s_add_u32 s62, s62, s41
 s_waitcnt lgkmcnt(0)
 s_cmp_eq_u32 s69, 0
 s_cselect_b32 s66, s80, s82
 s_cselect_b32 s67, s81, s83
 s_mov_b32 s12, s84
 s_mov_b32 s13, s85
 s_mov_b32 s14, 0x188000
 s_mov_b32 s15, 0x20000
 s_lshl_b32 s41, s39, 2
 s_add_u32 s41, s41, s20
 s_lshl_b32 s41, s41, 5
 s_add_u32 s41, s41, s21
 s_mul_i32 s56, s41, 14336
 s_add_u32 s56, s56, 0x4000000
 s_nop 1
 s_waitcnt vmcnt(8)
 s_barrier
 v_add_u32 v3, s24, v7
 v_add_u32 v4, s24, v8
 v_add_u32 v5, s24, v9
 v_add_u32 v6, s24, v10
 RW 64,3,0
 RW 66,3,2048
 RW 68,4,0
 RW 70,4,2048
 RW 72,5,0
 RW 74,5,2048
 RW 76,6,0
 RW 78,6,2048
 RW 80,3,4096
 RW 82,3,6144
 RW 84,4,4096
 RW 86,4,6144
 RW 88,5,4096
 RW 90,5,6144
 s_waitcnt lgkmcnt(10)
 PVZ 96,64,128
 s_add_u32 s25, s24, 0x18000
 RW 92,6,4096
 s_and_b32 s25, s25, 0x1ffff
 PVZ 100,64,132
 s_add_u32 s24, s24, 0x8000
 RW 94,6,6144
 s_and_b32 s24, s24, 0x1ffff
 PVZ 108,68,132
 RW 96,3,8192
 PVZ 104,68,128
 s_waitcnt lgkmcnt(9)
 RW 98,3,10240
 PVZ 112,72,128
 s_add_u32 m0, s25, s27
 RW 100,4,8192
 PVZ 116,72,132
 RW 102,4,10240
 PVZ 124,76,132
 RW 104,5,8192
 PVZ 120,76,128
 s_waitcnt lgkmcnt(9)
 RW 106,5,10240
 PV 96,80,144
 s_add_u32 s41, s36, s37
 RW 108,6,8192
 PV 100,80,148
 RW 110,6,10240
 PV 108,84,148
 RW 112,3,12288
 PV 104,84,144
 s_waitcnt lgkmcnt(9)
 RW 114,3,14336
 PV 112,88,144
 RW 116,4,12288
 PV 116,88,148
 RW 118,4,14336
 PV 124,92,148
 RW 120,5,12288
 PV 120,92,144
 s_waitcnt lgkmcnt(9)
 RW 122,5,14336
 PV 96,96,160
 RW 124,6,12288
 PV 100,96,164
 RW 126,6,14336
 PV 108,100,164
 RW 64,3,16384
 PV 104,100,160
 s_waitcnt lgkmcnt(9)
 RW 66,3,18432
 DL 11,8,36,0
 PV 112,104,160
 RW 68,4,16384
 PV 116,104,164
 RW 70,4,18432
 PV 124,108,164
 RW 72,5,16384
 PV 120,108,160
 s_waitcnt lgkmcnt(9)
 RW 74,5,18432
 DL 12,8,36,1024
 PV 96,112,176
 RW 76,6,16384
 PV 100,112,180
 RW 78,6,18432
 PV 108,116,180
 RW 80,3,20480
 PV 104,116,176
 s_waitcnt lgkmcnt(9)
 RW 82,3,22528
 PV 112,120,176
 RW 84,4,20480
 DL 13,8,36,2048
 PV 116,120,180
 RW 86,4,22528
 PV 124,124,180
 RW 88,5,20480
 PV 120,124,176
 s_waitcnt lgkmcnt(9)
 RW 90,5,22528
 PV 96,64,192
 RW 92,6,20480
 DL 14,8,36,3072
 PV 100,64,196
 s_add_u32 m0, m0, 0x1000
 RW 94,6,22528
 PV 108,68,196
 RW 96,3,24576
 PV 104,68,192
 s_waitcnt lgkmcnt(9)
 RW 98,3,26624
 PV 112,72,192
 RW 100,4,24576
 PV 116,72,196
 RW 102,4,26624
 PV 124,76,196
 RW 104,5,24576
 PV 120,76,192
 s_waitcnt lgkmcnt(9)
 RW 106,5,26624
 PV 96,80,208
 RW 108,6,24576
 PV 100,80,212
 RW 110,6,26624
 DL 11,8,41,0
 PV 108,84,212
 RW 112,3,28672
 PV 104,84,208
 s_waitcnt lgkmcnt(9)
 RW 114,3,30720
 PV 112,88,208
 RW 116,4,28672
 PV 116,88,212
 RW 118,4,30720
 PV 124,92,212
 RW 120,5,28672
 DL 12,8,41,1024
 PV 120,92,208
 s_waitcnt lgkmcnt(9)
 RW 122,5,30720
 PV 96,96,224
 RW 124,6,28672
 PV 100,96,228
 RW 126,6,30720
 v_add_u32 v3, s24, v7
 PV 108,100,228
 v_add_u32 v4, s24, v8
 v_add_u32 v5, s24, v9
 v_add_u32 v6, s24, v10
 RW 64,3,0
 DL 13,8,41,2048
 PV 104,100,224
 s_waitcnt lgkmcnt(9)
 RW 66,3,2048
 PV 112,104,224
 RW 68,4,0
 PV 116,104,228
 RW 70,4,2048
 PV 124,108,228
 RW 72,5,0
 PV 120,108,224
 s_waitcnt lgkmcnt(9)
 RW 74,5,2048
 DL 14,8,41,3072
 PV 96,112,240
 s_add_u32 s36, s36, s38
 RW 76,6,0
 PV 100,112,244
 RW 78,6,2048
 PV 108,116,244
 RW 80,3,4096
 PV 104,116,240
 s_waitcnt lgkmcnt(9)
 RW 82,3,6144
 PV 112,120,240
 RW 84,4,4096
 PV 116,120,244
 RW 86,4,6144
 PV 124,124,244
 RW 88,5,4096
 PV 120,124,240
 RW 90,5,6144
 s_waitcnt vmcnt(8)
 s_barrier
 s_waitcnt lgkmcnt(10)
 PVZ 64,64,128
 s_add_u32 s25, s24, 0x18000
 RW 92,6,4096
 s_and_b32 s25, s25, 0x1ffff
 PVZ 68,64,132
 s_add_u32 s24, s24, 0x8000
 RW 94,6,6144
 s_and_b32 s24, s24, 0x1ffff
 PVZ 76,68,132
 RW 96,3,8192
 PVZ 72,68,128
 s_waitcnt lgkmcnt(9)
 RW 98,3,10240
 PVZ 80,72,128
 s_add_u32 m0, s25, s27
 RW 100,4,8192
 PVZ 84,72,132
 RW 102,4,10240
 PVZ 92,76,132
 RW 104,5,8192
 PVZ 88,76,128
 s_waitcnt lgkmcnt(9)
 RW 106,5,10240
 PV 64,80,144
 s_add_u32 s41, s36, s37
 RW 108,6,8192
 v_cvt_pk_bf16_f32 v96, v96, v97
 PV 68,80,148
 RW 110,6,10240
 PV 76,84,148
 RW 112,3,12288
 v_cvt_pk_bf16_f32 v97, v98, v99
 PV 72,84,144
 s_waitcnt lgkmcnt(9)
 RW 114,3,14336
 PV 80,88,144
 RW 116,4,12288
 v_cvt_pk_bf16_f32 v98, v104, v105
 PV 84,88,148
 RW 118,4,14336
 PV 92,92,148
 RW 120,5,12288
 v_cvt_pk_bf16_f32 v99, v106, v107
 PV 88,92,144
 s_waitcnt lgkmcnt(9)
 RW 122,5,14336
 PV 64,96,160
 s_add_u32 s42, s56, 0
 RW 124,6,12288
 PV 68,96,164
 RW 126,6,14336
 PV 76,100,164
 RW 64,3,16384
 buffer_store_dwordx4 v[96:99], v1, s[4:7], s42 offen sc1
 PV 72,100,160
 s_waitcnt lgkmcnt(9)
 RW 66,3,18432
 DL 11,8,36,0
 PV 80,104,160
 RW 68,4,16384
 v_cvt_pk_bf16_f32 v100, v100, v101
 PV 84,104,164
 RW 70,4,18432
 PV 92,108,164
 RW 72,5,16384
 v_cvt_pk_bf16_f32 v101, v102, v103
 PV 88,108,160
 s_waitcnt lgkmcnt(9)
 RW 74,5,18432
 DL 12,8,36,1024
 PV 64,112,176
 RW 76,6,16384
 v_cvt_pk_bf16_f32 v102, v108, v109
 PV 68,112,180
 RW 78,6,18432
 PV 76,116,180
 RW 80,3,20480
 v_cvt_pk_bf16_f32 v103, v110, v111
 PV 72,116,176
 s_waitcnt lgkmcnt(9)
 RW 82,3,22528
 PV 80,120,176
 s_add_u32 s42, s56, 229376
 RW 84,4,20480
 DL 13,8,36,2048
 PV 84,120,180
 RW 86,4,22528
 PV 92,124,180
 RW 88,5,20480
 buffer_store_dwordx4 v[100:103], v1, s[4:7], s42 offen sc1
 PV 88,124,176
 s_waitcnt lgkmcnt(9)
 RW 90,5,22528
 PV 64,64,192
 RW 92,6,20480
 DL 14,8,36,3072
 PV 68,64,196
 s_add_u32 m0, m0, 0x1000
 RW 94,6,22528
 v_cvt_pk_bf16_f32 v112, v112, v113
 PV 76,68,196
 RW 96,3,24576
 v_cvt_pk_bf16_f32 v113, v114, v115
 PV 72,68,192
 s_waitcnt lgkmcnt(9)
 RW 98,3,26624
 PV 80,72,192
 RW 100,4,24576
 v_cvt_pk_bf16_f32 v114, v120, v121
 PV 84,72,196
 RW 102,4,26624
 PV 92,76,196
 RW 104,5,24576
 v_cvt_pk_bf16_f32 v115, v122, v123
 PV 88,76,192
 s_waitcnt lgkmcnt(9)
 RW 106,5,26624
 PV 64,80,208
 s_add_u32 s42, s56, 1024
 RW 108,6,24576
 PV 68,80,212
 RW 110,6,26624
 DL 11,8,41,0
 PV 76,84,212
 RW 112,3,28672
 buffer_store_dwordx4 v[112:115], v1, s[4:7], s42 offen sc1
 PV 72,84,208
 s_waitcnt lgkmcnt(9)
 RW 114,3,30720
 PV 80,88,208
 RW 116,4,28672
 v_cvt_pk_bf16_f32 v116, v116, v117
 PV 84,88,212
 RW 118,4,30720
 PV 92,92,212
 RW 120,5,28672
 DL 12,8,41,1024
 PV 88,92,208
 s_waitcnt lgkmcnt(9)
 RW 122,5,30720
 v_cvt_pk_bf16_f32 v117, v118, v119
 PV 64,96,224
 RW 124,6,28672
 v_cvt_pk_bf16_f32 v118, v124, v125
 PV 68,96,228
 RW 126,6,30720
 v_add_u32 v3, s24, v7
 PV 76,100,228
 v_add_u32 v4, s24, v8
 v_add_u32 v5, s24, v9
 v_add_u32 v6, s24, v10
 RW 64,3,0
 DL 13,8,41,2048
 PV 72,100,224
 s_waitcnt lgkmcnt(9)
 RW 66,3,2048
 v_cvt_pk_bf16_f32 v119, v126, v127
 PV 80,104,224
 s_add_u32 s42, s56, 230400
 RW 68,4,0
 PV 84,104,228
 RW 70,4,2048
 PV 92,108,228
 RW 72,5,0
 buffer_store_dwordx4 v[116:119], v1, s[4:7], s42 offen sc1
 PV 88,108,224
 s_waitcnt lgkmcnt(9)
 RW 74,5,2048
 DL 14,8,41,3072
 PV 64,112,240
 s_add_u32 s36, s36, s38
 RW 76,6,0
 PV 68,112,244
 RW 78,6,2048
 PV 76,116,244
 RW 80,3,4096
 PV 72,116,240
 s_waitcnt lgkmcnt(9)
 RW 82,3,6144
 PV 80,120,240
 RW 84,4,4096
 PV 84,120,244
 RW 86,4,6144
 PV 92,124,244
 RW 88,5,4096
 PV 88,124,240
 RW 90,5,6144
 s_waitcnt vmcnt(12)
 s_barrier
 s_waitcnt lgkmcnt(10)
 PVZ 96,64,128
 s_add_u32 s25, s24, 0x18000
 RW 92,6,4096
 s_and_b32 s25, s25, 0x1ffff
 PVZ 100,64,132
 s_add_u32 s24, s24, 0x8000
 RW 94,6,6144
 s_and_b32 s24, s24, 0x1ffff
 PVZ 108,68,132
 RW 96,3,8192
 PVZ 104,68,128
 s_waitcnt lgkmcnt(9)
 RW 98,3,10240
 PVZ 112,72,128
 s_add_u32 m0, s25, s27
 RW 100,4,8192
 PVZ 116,72,132
 RW 102,4,10240
 PVZ 124,76,132
 RW 104,5,8192
 PVZ 120,76,128
 s_waitcnt lgkmcnt(9)
 RW 106,5,10240
 PV 96,80,144
 s_add_u32 s41, s36, s37
 RW 108,6,8192
 v_cvt_pk_bf16_f32 v64, v64, v65
 PV 100,80,148
 RW 110,6,10240
 PV 108,84,148
 RW 112,3,12288
 v_cvt_pk_bf16_f32 v65, v66, v67
 PV 104,84,144
 s_waitcnt lgkmcnt(9)
 RW 114,3,14336
 PV 112,88,144
 RW 116,4,12288
 v_cvt_pk_bf16_f32 v66, v72, v73
 PV 116,88,148
 RW 118,4,14336
 PV 124,92,148
 RW 120,5,12288
 v_cvt_pk_bf16_f32 v67, v74, v75
 PV 120,92,144
 s_waitcnt lgkmcnt(9)
 RW 122,5,14336
 PV 96,96,160
 s_add_u32 s42, s56, 2048
 RW 124,6,12288
 PV 100,96,164
 RW 126,6,14336
 PV 108,100,164
 RW 64,3,16384
 buffer_store_dwordx4 v[64:67], v1, s[4:7], s42 offen sc1
 PV 104,100,160
 s_waitcnt lgkmcnt(9)
 RW 66,3,18432
 DL 11,8,36,0
 PV 112,104,160
 RW 68,4,16384
 v_cvt_pk_bf16_f32 v68, v68, v69
 PV 116,104,164
 RW 70,4,18432
 PV 124,108,164
 RW 72,5,16384
 v_cvt_pk_bf16_f32 v69, v70, v71
 PV 120,108,160
 s_waitcnt lgkmcnt(9)
 RW 74,5,18432
 DL 12,8,36,1024
 PV 96,112,176
 RW 76,6,16384
 v_cvt_pk_bf16_f32 v70, v76, v77
 PV 100,112,180
 RW 78,6,18432
 PV 108,116,180
 RW 80,3,20480
 v_cvt_pk_bf16_f32 v71, v78, v79
 PV 104,116,176
 s_waitcnt lgkmcnt(9)
 RW 82,3,22528
 PV 112,120,176
 s_add_u32 s42, s56, 231424
 RW 84,4,20480
 DL 13,8,36,2048
 PV 116,120,180
 RW 86,4,22528
 PV 124,124,180
 RW 88,5,20480
 buffer_store_dwordx4 v[68:71], v1, s[4:7], s42 offen sc1
 PV 120,124,176
 s_waitcnt lgkmcnt(9)
 RW 90,5,22528
 PV 96,64,192
 RW 92,6,20480
 DL 14,8,36,3072
 PV 100,64,196
 s_add_u32 m0, m0, 0x1000
 RW 94,6,22528
 v_cvt_pk_bf16_f32 v80, v80, v81
 PV 108,68,196
 RW 96,3,24576
 v_cvt_pk_bf16_f32 v81, v82, v83
 PV 104,68,192
 s_waitcnt lgkmcnt(9)
 RW 98,3,26624
 PV 112,72,192
 RW 100,4,24576
 v_cvt_pk_bf16_f32 v82, v88, v89
 PV 116,72,196
 RW 102,4,26624
 PV 124,76,196
 RW 104,5,24576
 v_cvt_pk_bf16_f32 v83, v90, v91
 PV 120,76,192
 s_waitcnt lgkmcnt(9)
 RW 106,5,26624
 PV 96,80,208
 s_add_u32 s42, s56, 3072
 RW 108,6,24576
 PV 100,80,212
 RW 110,6,26624
 DL 11,8,41,0
 PV 108,84,212
 RW 112,3,28672
 buffer_store_dwordx4 v[80:83], v1, s[4:7], s42 offen sc1
 PV 104,84,208
 s_waitcnt lgkmcnt(9)
 RW 114,3,30720
 PV 112,88,208
 RW 116,4,28672
 v_cvt_pk_bf16_f32 v84, v84, v85
 PV 116,88,212
 RW 118,4,30720
 PV 124,92,212
 RW 120,5,28672
 DL 12,8,41,1024
 PV 120,92,208
 s_waitcnt lgkmcnt(9)
 RW 122,5,30720
 v_cvt_pk_bf16_f32 v85, v86, v87
 PV 96,96,224
 RW 124,6,28672
 v_cvt_pk_bf16_f32 v86, v92, v93
 PV 100,96,228
 RW 126,6,30720
 v_add_u32 v3, s24, v7
 PV 108,100,228
 v_add_u32 v4, s24, v8
 v_add_u32 v5, s24, v9
 v_add_u32 v6, s24, v10
 RW 64,3,0
 DL 13,8,41,2048
 PV 104,100,224
 s_waitcnt lgkmcnt(9)
 RW 66,3,2048
 v_cvt_pk_bf16_f32 v87, v94, v95
 PV 112,104,224
 s_add_u32 s42, s56, 232448
 RW 68,4,0
 PV 116,104,228
 RW 70,4,2048
 PV 124,108,228
 RW 72,5,0
 buffer_store_dwordx4 v[84:87], v1, s[4:7], s42 offen sc1
 PV 120,108,224
 s_waitcnt lgkmcnt(9)
 RW 74,5,2048
 DL 14,8,41,3072
 PV 96,112,240
 s_add_u32 s36, s36, s38
 RW 76,6,0
 PV 100,112,244
 RW 78,6,2048
 PV 108,116,244
 RW 80,3,4096
 PV 104,116,240
 s_waitcnt lgkmcnt(9)
 RW 82,3,6144
 PV 112,120,240
 RW 84,4,4096
 PV 116,120,244
 RW 86,4,6144
 PV 124,124,244
 RW 88,5,4096
 PV 120,124,240
 RW 90,5,6144
 s_waitcnt vmcnt(12)
 s_barrier
 s_waitcnt lgkmcnt(10)
 PVZ 64,64,128
 s_add_u32 s25, s24, 0x18000
 RW 92,6,4096
 s_and_b32 s25, s25, 0x1ffff
 PVZ 68,64,132
 s_add_u32 s24, s24, 0x8000
 RW 94,6,6144
 s_and_b32 s24, s24, 0x1ffff
 PVZ 76,68,132
 RW 96,3,8192
 PVZ 72,68,128
 s_waitcnt lgkmcnt(9)
 RW 98,3,10240
 PVZ 80,72,128
 s_add_u32 m0, s25, s27
 RW 100,4,8192
 PVZ 84,72,132
 RW 102,4,10240
 PVZ 92,76,132
 RW 104,5,8192
 PVZ 88,76,128
 s_waitcnt lgkmcnt(9)
 RW 106,5,10240
 PV 64,80,144
 s_add_u32 s41, s36, s37
 RW 108,6,8192
 v_cvt_pk_bf16_f32 v96, v96, v97
 PV 68,80,148
 RW 110,6,10240
 PV 76,84,148
 RW 112,3,12288
 v_cvt_pk_bf16_f32 v97, v98, v99
 PV 72,84,144
 s_waitcnt lgkmcnt(9)
 RW 114,3,14336
 PV 80,88,144
 RW 116,4,12288
 v_cvt_pk_bf16_f32 v98, v104, v105
 PV 84,88,148
 RW 118,4,14336
 PV 92,92,148
 RW 120,5,12288
 v_cvt_pk_bf16_f32 v99, v106, v107
 PV 88,92,144
 s_waitcnt lgkmcnt(9)
 RW 122,5,14336
 PV 64,96,160
 s_add_u32 s42, s56, 4096
 RW 124,6,12288
 PV 68,96,164
 RW 126,6,14336
 PV 76,100,164
 RW 64,3,16384
 buffer_store_dwordx4 v[96:99], v1, s[4:7], s42 offen sc1
 PV 72,100,160
 s_waitcnt lgkmcnt(9)
 RW 66,3,18432
 DL 11,8,36,0
 PV 80,104,160
 RW 68,4,16384
 v_cvt_pk_bf16_f32 v100, v100, v101
 PV 84,104,164
 RW 70,4,18432
 PV 92,108,164
 RW 72,5,16384
 v_cvt_pk_bf16_f32 v101, v102, v103
 PV 88,108,160
 s_waitcnt lgkmcnt(9)
 RW 74,5,18432
 DL 12,8,36,1024
 PV 64,112,176
 RW 76,6,16384
 v_cvt_pk_bf16_f32 v102, v108, v109
 PV 68,112,180
 RW 78,6,18432
 PV 76,116,180
 RW 80,3,20480
 v_cvt_pk_bf16_f32 v103, v110, v111
 PV 72,116,176
 s_waitcnt lgkmcnt(9)
 RW 82,3,22528
 PV 80,120,176
 s_add_u32 s42, s56, 233472
 RW 84,4,20480
 DL 13,8,36,2048
 PV 84,120,180
 RW 86,4,22528
 PV 92,124,180
 RW 88,5,20480
 buffer_store_dwordx4 v[100:103], v1, s[4:7], s42 offen sc1
 PV 88,124,176
 s_waitcnt lgkmcnt(9)
 RW 90,5,22528
 PV 64,64,192
 RW 92,6,20480
 DL 14,8,36,3072
 PV 68,64,196
 s_add_u32 m0, m0, 0x1000
 RW 94,6,22528
 v_cvt_pk_bf16_f32 v112, v112, v113
 PV 76,68,196
 RW 96,3,24576
 v_cvt_pk_bf16_f32 v113, v114, v115
 PV 72,68,192
 s_waitcnt lgkmcnt(9)
 RW 98,3,26624
 PV 80,72,192
 RW 100,4,24576
 v_cvt_pk_bf16_f32 v114, v120, v121
 PV 84,72,196
 RW 102,4,26624
 PV 92,76,196
 RW 104,5,24576
 v_cvt_pk_bf16_f32 v115, v122, v123
 PV 88,76,192
 s_waitcnt lgkmcnt(9)
 RW 106,5,26624
 PV 64,80,208
 s_add_u32 s42, s56, 5120
 RW 108,6,24576
 PV 68,80,212
 RW 110,6,26624
 DL 11,8,41,0
 PV 76,84,212
 RW 112,3,28672
 buffer_store_dwordx4 v[112:115], v1, s[4:7], s42 offen sc1
 PV 72,84,208
 s_waitcnt lgkmcnt(9)
 RW 114,3,30720
 PV 80,88,208
 RW 116,4,28672
 v_cvt_pk_bf16_f32 v116, v116, v117
 PV 84,88,212
 RW 118,4,30720
 PV 92,92,212
 RW 120,5,28672
 DL 12,8,41,1024
 PV 88,92,208
 s_waitcnt lgkmcnt(9)
 RW 122,5,30720
 v_cvt_pk_bf16_f32 v117, v118, v119
 PV 64,96,224
 RW 124,6,28672
 v_cvt_pk_bf16_f32 v118, v124, v125
 PV 68,96,228
 RW 126,6,30720
 v_add_u32 v3, s24, v7
 PV 76,100,228
 v_add_u32 v4, s24, v8
 v_add_u32 v5, s24, v9
 v_add_u32 v6, s24, v10
 RW 64,3,0
 DL 13,8,41,2048
 PV 72,100,224
 s_waitcnt lgkmcnt(9)
 RW 66,3,2048
 v_cvt_pk_bf16_f32 v119, v126, v127
 PV 80,104,224
 s_add_u32 s42, s56, 234496
 RW 68,4,0
 PV 84,104,228
 RW 70,4,2048
 PV 92,108,228
 RW 72,5,0
 buffer_store_dwordx4 v[116:119], v1, s[4:7], s42 offen sc1
 PV 88,108,224
 s_waitcnt lgkmcnt(9)
 RW 74,5,2048
 DL 14,8,41,3072
 PV 64,112,240
 s_add_u32 s36, s36, s38
 RW 76,6,0
 PV 68,112,244
 RW 78,6,2048
 PV 76,116,244
 RW 80,3,4096
 PV 72,116,240
 s_waitcnt lgkmcnt(9)
 RW 82,3,6144
 PV 80,120,240
 RW 84,4,4096
 PV 84,120,244
 RW 86,4,6144
 PV 92,124,244
 RW 88,5,4096
 PV 88,124,240
 RW 90,5,6144
 s_waitcnt vmcnt(12)
 s_barrier
 s_mov_b32 s8, s66
 s_mov_b32 s9, s67
 s_mov_b32 s10, 1605632
 s_waitcnt lgkmcnt(10)
 PVZ 96,64,128
 s_add_u32 s25, s24, 0x18000
 RW 92,6,4096
 s_and_b32 s25, s25, 0x1ffff
 PVZ 100,64,132
 s_add_u32 s24, s24, 0x8000
 RW 94,6,6144
 s_and_b32 s24, s24, 0x1ffff
 PVZ 108,68,132
 RW 96,3,8192
 PVZ 104,68,128
 s_waitcnt lgkmcnt(9)
 RW 98,3,10240
 PVZ 112,72,128
 s_add_u32 m0, s25, s61
 RW 100,4,8192
 PVZ 116,72,132
 RW 102,4,10240
 PVZ 124,76,132
 RW 104,5,8192
 PVZ 120,76,128
 s_waitcnt lgkmcnt(9)
 RW 106,5,10240
 PV 96,80,144
 RW 108,6,8192
 v_cvt_pk_bf16_f32 v64, v64, v65
 PV 100,80,148
 RW 110,6,10240
 PV 108,84,148
 RW 112,3,12288
 v_cvt_pk_bf16_f32 v65, v66, v67
 PV 104,84,144
 s_waitcnt lgkmcnt(9)
 RW 114,3,14336
 PV 112,88,144
 RW 116,4,12288
 v_cvt_pk_bf16_f32 v66, v72, v73
 PV 116,88,148
 RW 118,4,14336
 PV 124,92,148
 RW 120,5,12288
 DL 32,8,60,0
 PV 120,92,144
 s_waitcnt lgkmcnt(9)
 RW 122,5,14336
 v_cvt_pk_bf16_f32 v67, v74, v75
 PV 96,96,160
 s_add_u32 s42, s56, 6144
 RW 124,6,12288
 PV 100,96,164
 RW 126,6,14336
 PV 108,100,164
 RW 64,3,16384
 buffer_store_dwordx4 v[64:67], v1, s[4:7], s42 offen sc1
 PV 104,100,160
 s_waitcnt lgkmcnt(9)
 RW 66,3,18432
 DL 33,8,60,1024
 PV 112,104,160
 RW 68,4,16384
 v_cvt_pk_bf16_f32 v68, v68, v69
 PV 116,104,164
 RW 70,4,18432
 PV 124,108,164
 RW 72,5,16384
 v_cvt_pk_bf16_f32 v69, v70, v71
 PV 120,108,160
 s_waitcnt lgkmcnt(9)
 RW 74,5,18432
 DL 34,8,60,2048
 PV 96,112,176
 RW 76,6,16384
 v_cvt_pk_bf16_f32 v70, v76, v77
 PV 100,112,180
 RW 78,6,18432
 PV 108,116,180
 RW 80,3,20480
 v_cvt_pk_bf16_f32 v71, v78, v79
 PV 104,116,176
 s_waitcnt lgkmcnt(9)
 RW 82,3,22528
 PV 112,120,176
 s_add_u32 s42, s56, 235520
 RW 84,4,20480
 DL 35,8,60,3072
 PV 116,120,180
 s_add_u32 m0, m0, 0x1000
 RW 86,4,22528
 PV 124,124,180
 RW 88,5,20480
 buffer_store_dwordx4 v[68:71], v1, s[4:7], s42 offen sc1
 PV 120,124,176
 s_waitcnt lgkmcnt(9)
 RW 90,5,22528
 PV 96,64,192
 RW 92,6,20480
 v_cvt_pk_bf16_f32 v80, v80, v81
 PV 100,64,196
 RW 94,6,22528
 PV 108,68,196
 RW 96,3,24576
 v_cvt_pk_bf16_f32 v81, v82, v83
 PV 104,68,192
 s_waitcnt lgkmcnt(9)
 RW 98,3,26624
 PV 112,72,192
 RW 100,4,24576
 v_cvt_pk_bf16_f32 v82, v88, v89
 PV 116,72,196
 RW 102,4,26624
 DL 36,8,60,0
 PV 124,76,196
 RW 104,5,24576
 v_cvt_pk_bf16_f32 v83, v90, v91
 PV 120,76,192
 s_waitcnt lgkmcnt(9)
 RW 106,5,26624
 PV 96,80,208
 s_add_u32 s42, s56, 7168
 RW 108,6,24576
 PV 100,80,212
 RW 110,6,26624
 DL 37,8,60,1024
 PV 108,84,212
 RW 112,3,28672
 buffer_store_dwordx4 v[80:83], v1, s[4:7], s42 offen sc1
 PV 104,84,208
 s_waitcnt lgkmcnt(9)
 RW 114,3,30720
 PV 112,88,208
 RW 116,4,28672
 v_cvt_pk_bf16_f32 v84, v84, v85
 PV 116,88,212
 RW 118,4,30720
 PV 124,92,212
 RW 120,5,28672
 DL 38,8,60,2048
 PV 120,92,208
 s_waitcnt lgkmcnt(9)
 RW 122,5,30720
 s_add_u32 s60, s60, 229376
 PV 96,96,224
 RW 124,6,28672
 v_cvt_pk_bf16_f32 v85, v86, v87
 PV 100,96,228
 RW 126,6,30720
 v_add_u32 v3, s24, v7
 PV 108,100,228
 v_add_u32 v4, s24, v8
 v_add_u32 v5, s24, v9
 v_add_u32 v6, s24, v10
 RW 64,3,0
 PV 104,100,224
 s_waitcnt lgkmcnt(9)
 RW 66,3,2048
 v_cvt_pk_bf16_f32 v86, v92, v93
 PV 112,104,224
 RW 68,4,0
 v_cvt_pk_bf16_f32 v87, v94, v95
 PV 116,104,228
 s_add_u32 s42, s56, 236544
 RW 70,4,2048
 PV 124,108,228
 RW 72,5,0
 buffer_store_dwordx4 v[84:87], v1, s[4:7], s42 offen sc1
 PV 120,108,224
 s_waitcnt lgkmcnt(9)
 RW 74,5,2048
 PV 96,112,240
 RW 76,6,0
 PV 100,112,244
 RW 78,6,2048
 PV 108,116,244
 RW 80,3,4096
 PV 104,116,240
 s_waitcnt lgkmcnt(9)
 RW 82,3,6144
 PV 112,120,240
 RW 84,4,4096
 PV 116,120,244
 RW 86,4,6144
 PV 124,124,244
 RW 88,5,4096
 PV 120,124,240
 RW 90,5,6144
 s_waitcnt vmcnt(11)
 s_barrier
 s_waitcnt lgkmcnt(10)
 PVZ 64,64,128
 s_add_u32 s25, s24, 0x18000
 RW 92,6,4096
 s_and_b32 s25, s25, 0x1ffff
 PVZ 68,64,132
 s_add_u32 s24, s24, 0x8000
 RW 94,6,6144
 s_and_b32 s24, s24, 0x1ffff
 PVZ 76,68,132
 RW 96,3,8192
 PVZ 72,68,128
 s_waitcnt lgkmcnt(9)
 RW 98,3,10240
 PVZ 80,72,128
 s_add_u32 m0, s25, s61
 RW 100,4,8192
 PVZ 84,72,132
 RW 102,4,10240
 PVZ 92,76,132
 RW 104,5,8192
 PVZ 88,76,128
 s_waitcnt lgkmcnt(9)
 RW 106,5,10240
 PV 64,80,144
 RW 108,6,8192
 v_cvt_pk_bf16_f32 v96, v96, v97
 PV 68,80,148
 RW 110,6,10240
 PV 76,84,148
 RW 112,3,12288
 v_cvt_pk_bf16_f32 v97, v98, v99
 PV 72,84,144
 s_waitcnt lgkmcnt(9)
 RW 114,3,14336
 PV 80,88,144
 RW 116,4,12288
 v_cvt_pk_bf16_f32 v98, v104, v105
 PV 84,88,148
 RW 118,4,14336
 PV 92,92,148
 RW 120,5,12288
 DL 32,8,60,0
 PV 88,92,144
 s_waitcnt lgkmcnt(9)
 RW 122,5,14336
 v_cvt_pk_bf16_f32 v99, v106, v107
 PV 64,96,160
 s_add_u32 s42, s56, 8192
 RW 124,6,12288
 PV 68,96,164
 RW 126,6,14336
 PV 76,100,164
 RW 64,3,16384
 buffer_store_dwordx4 v[96:99], v1, s[4:7], s42 offen sc1
 PV 72,100,160
 s_waitcnt lgkmcnt(9)
 RW 66,3,18432
 DL 33,8,60,1024
 PV 80,104,160
 RW 68,4,16384
 v_cvt_pk_bf16_f32 v100, v100, v101
 PV 84,104,164
 RW 70,4,18432
 PV 92,108,164
 RW 72,5,16384
 v_cvt_pk_bf16_f32 v101, v102, v103
 PV 88,108,160
 s_waitcnt lgkmcnt(9)
 RW 74,5,18432
 DL 34,8,60,2048
 PV 64,112,176
 RW 76,6,16384
 v_cvt_pk_bf16_f32 v102, v108, v109
 PV 68,112,180
 RW 78,6,18432
 PV 76,116,180
 RW 80,3,20480
 v_cvt_pk_bf16_f32 v103, v110, v111
 PV 72,116,176
 s_waitcnt lgkmcnt(9)
 RW 82,3,22528
 PV 80,120,176
 s_add_u32 s42, s56, 237568
 RW 84,4,20480
 DL 35,8,60,3072
 PV 84,120,180
 s_add_u32 m0, m0, 0x1000
 RW 86,4,22528
 PV 92,124,180
 RW 88,5,20480
 buffer_store_dwordx4 v[100:103], v1, s[4:7], s42 offen sc1
 PV 88,124,176
 s_waitcnt lgkmcnt(9)
 RW 90,5,22528
 PV 64,64,192
 RW 92,6,20480
 v_cvt_pk_bf16_f32 v112, v112, v113
 PV 68,64,196
 RW 94,6,22528
 PV 76,68,196
 RW 96,3,24576
 v_cvt_pk_bf16_f32 v113, v114, v115
 PV 72,68,192
 s_waitcnt lgkmcnt(9)
 RW 98,3,26624
 PV 80,72,192
 RW 100,4,24576
 v_cvt_pk_bf16_f32 v114, v120, v121
 PV 84,72,196
 RW 102,4,26624
 DL 36,8,60,0
 PV 92,76,196
 RW 104,5,24576
 v_cvt_pk_bf16_f32 v115, v122, v123
 PV 88,76,192
 s_waitcnt lgkmcnt(9)
 RW 106,5,26624
 PV 64,80,208
 s_add_u32 s42, s56, 9216
 RW 108,6,24576
 PV 68,80,212
 RW 110,6,26624
 DL 37,8,60,1024
 PV 76,84,212
 RW 112,3,28672
 buffer_store_dwordx4 v[112:115], v1, s[4:7], s42 offen sc1
 PV 72,84,208
 s_waitcnt lgkmcnt(9)
 RW 114,3,30720
 PV 80,88,208
 RW 116,4,28672
 v_cvt_pk_bf16_f32 v116, v116, v117
 PV 84,88,212
 RW 118,4,30720
 PV 92,92,212
 RW 120,5,28672
 DL 38,8,60,2048
 PV 88,92,208
 s_waitcnt lgkmcnt(9)
 RW 122,5,30720
 s_add_u32 s60, s60, 229376
 PV 64,96,224
 RW 124,6,28672
 v_cvt_pk_bf16_f32 v117, v118, v119
 PV 68,96,228
 RW 126,6,30720
 v_add_u32 v3, s24, v7
 PV 76,100,228
 v_add_u32 v4, s24, v8
 v_add_u32 v5, s24, v9
 v_add_u32 v6, s24, v10
 RW 64,3,0
 PV 72,100,224
 s_waitcnt lgkmcnt(9)
 RW 66,3,2048
 v_cvt_pk_bf16_f32 v118, v124, v125
 PV 80,104,224
 RW 68,4,0
 v_cvt_pk_bf16_f32 v119, v126, v127
 PV 84,104,228
 s_add_u32 s42, s56, 238592
 RW 70,4,2048
 PV 92,108,228
 RW 72,5,0
 buffer_store_dwordx4 v[116:119], v1, s[4:7], s42 offen sc1
 PV 88,108,224
 s_waitcnt lgkmcnt(9)
 RW 74,5,2048
 PV 64,112,240
 RW 76,6,0
 PV 68,112,244
 RW 78,6,2048
 PV 76,116,244
 RW 80,3,4096
 PV 72,116,240
 s_waitcnt lgkmcnt(9)
 RW 82,3,6144
 PV 80,120,240
 RW 84,4,4096
 PV 84,120,244
 RW 86,4,6144
 PV 92,124,244
 RW 88,5,4096
 PV 88,124,240
 RW 90,5,6144
 s_waitcnt vmcnt(63)
 s_barrier
 s_waitcnt lgkmcnt(10)
 PVZ 96,64,128
 s_add_u32 s25, s24, 0x18000
 RW 92,6,4096
 s_and_b32 s25, s25, 0x1ffff
 PVZ 100,64,132
 s_add_u32 s24, s24, 0x8000
 RW 94,6,6144
 s_and_b32 s24, s24, 0x1ffff
 PVZ 108,68,132
 RW 96,3,8192
 PVZ 104,68,128
 s_waitcnt lgkmcnt(9)
 RW 98,3,10240
 PVZ 112,72,128
 RW 100,4,8192
 PVZ 116,72,132
 RW 102,4,10240
 PVZ 124,76,132
 RW 104,5,8192
 PVZ 120,76,128
 s_waitcnt lgkmcnt(9)
 RW 106,5,10240
 PV 96,80,144
 RW 108,6,8192
 v_cvt_pk_bf16_f32 v64, v64, v65
 PV 100,80,148
 RW 110,6,10240
 PV 108,84,148
 RW 112,3,12288
 v_cvt_pk_bf16_f32 v65, v66, v67
 PV 104,84,144
 s_waitcnt lgkmcnt(9)
 RW 114,3,14336
 PV 112,88,144
 RW 116,4,12288
 v_cvt_pk_bf16_f32 v66, v72, v73
 PV 116,88,148
 RW 118,4,14336
 PV 124,92,148
 RW 120,5,12288
 v_cvt_pk_bf16_f32 v67, v74, v75
 PV 120,92,144
 s_waitcnt lgkmcnt(9)
 RW 122,5,14336
 PV 96,96,160
 s_add_u32 s42, s56, 10240
 RW 124,6,12288
 PV 100,96,164
 RW 126,6,14336
 PV 108,100,164
 RW 64,3,16384
 buffer_store_dwordx4 v[64:67], v1, s[4:7], s42 offen sc1
 PV 104,100,160
 s_waitcnt lgkmcnt(9)
 RW 66,3,18432
 PV 112,104,160
 RW 68,4,16384
 v_cvt_pk_bf16_f32 v68, v68, v69
 PV 116,104,164
 RW 70,4,18432
 PV 124,108,164
 RW 72,5,16384
 v_cvt_pk_bf16_f32 v69, v70, v71
 PV 120,108,160
 s_waitcnt lgkmcnt(9)
 RW 74,5,18432
 PV 96,112,176
 RW 76,6,16384
 v_cvt_pk_bf16_f32 v70, v76, v77
 PV 100,112,180
 RW 78,6,18432
 PV 108,116,180
 RW 80,3,20480
 v_cvt_pk_bf16_f32 v71, v78, v79
 PV 104,116,176
 s_waitcnt lgkmcnt(9)
 RW 82,3,22528
 PV 112,120,176
 s_add_u32 s42, s56, 239616
 RW 84,4,20480
 PV 116,120,180
 RW 86,4,22528
 PV 124,124,180
 RW 88,5,20480
 buffer_store_dwordx4 v[68:71], v1, s[4:7], s42 offen sc1
 PV 120,124,176
 s_waitcnt lgkmcnt(9)
 RW 90,5,22528
 PV 96,64,192
 RW 92,6,20480
 v_cvt_pk_bf16_f32 v80, v80, v81
 PV 100,64,196
 RW 94,6,22528
 PV 108,68,196
 RW 96,3,24576
 v_cvt_pk_bf16_f32 v81, v82, v83
 PV 104,68,192
 s_waitcnt lgkmcnt(9)
 RW 98,3,26624
 PV 112,72,192
 RW 100,4,24576
 v_cvt_pk_bf16_f32 v82, v88, v89
 PV 116,72,196
 RW 102,4,26624
 PV 124,76,196
 RW 104,5,24576
 v_cvt_pk_bf16_f32 v83, v90, v91
 PV 120,76,192
 s_waitcnt lgkmcnt(9)
 RW 106,5,26624
 PV 96,80,208
 s_add_u32 s42, s56, 11264
 RW 108,6,24576
 PV 100,80,212
 RW 110,6,26624
 PV 108,84,212
 RW 112,3,28672
 buffer_store_dwordx4 v[80:83], v1, s[4:7], s42 offen sc1
 PV 104,84,208
 s_waitcnt lgkmcnt(9)
 RW 114,3,30720
 PV 112,88,208
 RW 116,4,28672
 v_cvt_pk_bf16_f32 v84, v84, v85
 PV 116,88,212
 RW 118,4,30720
 PV 124,92,212
 RW 120,5,28672
 v_cvt_pk_bf16_f32 v85, v86, v87
 PV 120,92,208
 s_waitcnt lgkmcnt(9)
 RW 122,5,30720
 PV 96,96,224
 RW 124,6,28672
 v_cvt_pk_bf16_f32 v86, v92, v93
 PV 100,96,228
 RW 126,6,30720
 PV 108,100,228
 v_cvt_pk_bf16_f32 v87, v94, v95
 PV 104,100,224
 s_waitcnt lgkmcnt(8)
 PV 112,104,224
 s_add_u32 s42, s56, 240640
 PV 116,104,228
 PV 124,108,228
 buffer_store_dwordx4 v[84:87], v1, s[4:7], s42 offen sc1
 PV 120,108,224
 s_waitcnt lgkmcnt(4)
 PV 96,112,240
 PV 100,112,244
 PV 108,116,244
 PV 104,116,240
 s_waitcnt lgkmcnt(0)
 PV 112,120,240
 PV 116,120,244
 PV 124,124,244
 PV 120,124,240
 s_nop 7
 v_cvt_pk_bf16_f32 v96, v96, v97
 v_cvt_pk_bf16_f32 v97, v98, v99
 v_cvt_pk_bf16_f32 v98, v104, v105
 v_cvt_pk_bf16_f32 v99, v106, v107
 s_add_u32 s42, s56, 12288
 buffer_store_dwordx4 v[96:99], v1, s[4:7], s42 offen sc1
 v_cvt_pk_bf16_f32 v100, v100, v101
 v_cvt_pk_bf16_f32 v101, v102, v103
 v_cvt_pk_bf16_f32 v102, v108, v109
 v_cvt_pk_bf16_f32 v103, v110, v111
 s_add_u32 s42, s56, 241664
 buffer_store_dwordx4 v[100:103], v1, s[4:7], s42 offen sc1
 v_cvt_pk_bf16_f32 v112, v112, v113
 v_cvt_pk_bf16_f32 v113, v114, v115
 v_cvt_pk_bf16_f32 v114, v120, v121
 v_cvt_pk_bf16_f32 v115, v122, v123
 s_add_u32 s42, s56, 13312
 buffer_store_dwordx4 v[112:115], v1, s[4:7], s42 offen sc1
 v_cvt_pk_bf16_f32 v116, v116, v117
 v_cvt_pk_bf16_f32 v117, v118, v119
 v_cvt_pk_bf16_f32 v118, v124, v125
 v_cvt_pk_bf16_f32 v119, v126, v127
 s_add_u32 s42, s56, 242688
 buffer_store_dwordx4 v[116:119], v1, s[4:7], s42 offen sc1
 s_add_u32 m0, s25, s61
 s_nop 0
 DL 32,8,60,0
 DL 33,8,60,1024
 DL 34,8,60,2048
 DL 35,8,60,3072
 s_add_u32 m0, m0, 0x1000
 s_nop 0
 DL 36,8,60,0
 DL 37,8,60,1024
 DL 38,8,60,2048
 s_add_u32 s60, s60, 229376
 s_waitcnt vmcnt(7)
 s_barrier
 s_add_u32 s41, s39, 32
 s_cmp_eq_u32 s20, 0
 s_cbranch_scc0 mk_sg_34
 s_lshl_b32 s44, s41, 8
 v_mov_b32 v29, s44
 v_mov_b32 v30, 1
 s_mov_b64 exec, 1
 global_atomic_add v29, v30, s[96:97] sc1
 s_mov_b64 exec, -1
mk_sg_34:
 v_and_b32 v44, 7, v0
 v_lshrrev_b32 v45, 5, v0
 v_bfe_u32 v46, v0, 3, 2
 s_and_b32 s41, s70, 1
 s_lshl_b32 s41, s41, 3
 v_add_u32 v47, s41, v44
 v_lshl_add_u32 v40, v46, 4, v47
 v_lshlrev_b32 v40, 4, v40
 v_lshl_add_u32 v40, v45, 10, v40
 v_mul_u32_u24 v41, 896, v44
 v_lshl_add_u32 v41, v45, 6, v41
 v_lshl_add_u32 v41, v46, 3, v41
 v_lshrrev_b32 v42, 6, v0
 v_lshl_add_u32 v42, v44, 2, v42
 v_lshlrev_b32 v42, 2, v42
 v_lshlrev_b32 v43, 4, v44
 s_mul_i32 s42, s70, 7168
 buffer_load_dwordx2 v[224:225], v41, s[92:95], s42 offen
 buffer_load_dwordx2 v[226:227], v41, s[92:95], s42 offen offset:32
 s_cmp_eq_u32 s20, 3
 s_cbranch_scc1 mk_w3_35
 buffer_load_dwordx2 v[228:229], v41, s[92:95], s42 offen offset:512
 buffer_load_dwordx2 v[230:231], v41, s[92:95], s42 offen offset:544
mk_w3_35:
 s_add_u32 s41, s39, 32
 s_cmp_eq_u32 s20, 0
 s_cbranch_scc0 mk_wf_36
 s_lshl_b32 s44, s41, 8
 v_mov_b32 v29, s44
 s_mov_b32 s44, 0
mk_sp_37:
 global_load_dword v30, v29, s[96:97] sc1
 s_waitcnt vmcnt(0)
 v_readfirstlane_b32 s43, v30
 s_add_u32 s44, s44, 1
 s_bfe_u32 s43, s43, 0x100000
 s_cmp_ge_u32 s43, 16
 s_cbranch_scc1 mk_sp_37_ok
 s_sleep 2
 s_cmp_lt_u32 s44, 0x40000
 s_cbranch_scc1 mk_sp_37
mk_sp_37_ok:
mk_wf_36:
 s_barrier
 s_waitcnt vmcnt(0)
 s_lshr_b32 s42, s70, 1
 s_mul_i32 s42, s42, 229376
 s_add_u32 s42, s42, 0x4000000
 s_add_u32 s43, s42, 8192
 buffer_load_dwordx4 v[64:67], v40, s[4:7], s42 offen
 s_add_u32 s42, s42, 14336
 buffer_load_dwordx4 v[68:71], v40, s[4:7], s42 offen
 s_add_u32 s42, s42, 14336
 buffer_load_dwordx4 v[72:75], v40, s[4:7], s42 offen
 s_add_u32 s42, s42, 14336
 buffer_load_dwordx4 v[76:79], v40, s[4:7], s42 offen
 s_add_u32 s42, s42, 14336
 buffer_load_dwordx4 v[80:83], v40, s[4:7], s42 offen
 s_add_u32 s42, s42, 14336
 buffer_load_dwordx4 v[84:87], v40, s[4:7], s42 offen
 s_add_u32 s42, s42, 14336
 buffer_load_dwordx4 v[88:91], v40, s[4:7], s42 offen
 s_add_u32 s42, s42, 14336
 buffer_load_dwordx4 v[92:95], v40, s[4:7], s42 offen
 s_add_u32 s42, s42, 14336
 buffer_load_dwordx4 v[96:99], v40, s[4:7], s42 offen
 s_add_u32 s42, s42, 14336
 buffer_load_dwordx4 v[100:103], v40, s[4:7], s42 offen
 s_add_u32 s42, s42, 14336
 buffer_load_dwordx4 v[104:107], v40, s[4:7], s42 offen
 s_add_u32 s42, s42, 14336
 buffer_load_dwordx4 v[108:111], v40, s[4:7], s42 offen
 s_add_u32 s42, s42, 14336
 buffer_load_dwordx4 v[112:115], v40, s[4:7], s42 offen
 s_add_u32 s42, s42, 14336
 buffer_load_dwordx4 v[116:119], v40, s[4:7], s42 offen
 s_add_u32 s42, s42, 14336
 buffer_load_dwordx4 v[120:123], v40, s[4:7], s42 offen
 s_add_u32 s42, s42, 14336
 buffer_load_dwordx4 v[124:127], v40, s[4:7], s42 offen
 s_cmp_eq_u32 s20, 3
 s_cbranch_scc1 mk_w3_38
 buffer_load_dwordx4 v[128:131], v40, s[4:7], s43 offen
 s_add_u32 s43, s43, 14336
 buffer_load_dwordx4 v[132:135], v40, s[4:7], s43 offen
 s_add_u32 s43, s43, 14336
 buffer_load_dwordx4 v[136:139], v40, s[4:7], s43 offen
 s_add_u32 s43, s43, 14336
 buffer_load_dwordx4 v[140:143], v40, s[4:7], s43 offen
 s_add_u32 s43, s43, 14336
 buffer_load_dwordx4 v[144:147], v40, s[4:7], s43 offen
 s_add_u32 s43, s43, 14336
 buffer_load_dwordx4 v[148:151], v40, s[4:7], s43 offen
 s_add_u32 s43, s43, 14336
 buffer_load_dwordx4 v[152:155], v40, s[4:7], s43 offen
 s_add_u32 s43, s43, 14336
 buffer_load_dwordx4 v[156:159], v40, s[4:7], s43 offen
 s_add_u32 s43, s43, 14336
 buffer_load_dwordx4 v[160:163], v40, s[4:7], s43 offen
 s_add_u32 s43, s43, 14336
 buffer_load_dwordx4 v[164:167], v40, s[4:7], s43 offen
 s_add_u32 s43, s43, 14336
 buffer_load_dwordx4 v[168:171], v40, s[4:7], s43 offen
 s_add_u32 s43, s43, 14336
 buffer_load_dwordx4 v[172:175], v40, s[4:7], s43 offen
 s_add_u32 s43, s43, 14336
 buffer_load_dwordx4 v[176:179], v40, s[4:7], s43 offen
 s_add_u32 s43, s43, 14336
 buffer_load_dwordx4 v[180:183], v40, s[4:7], s43 offen
 s_add_u32 s43, s43, 14336
 buffer_load_dwordx4 v[184:187], v40, s[4:7], s43 offen
 s_add_u32 s43, s43, 14336
 buffer_load_dwordx4 v[188:191], v40, s[4:7], s43 offen
mk_w3_38:
 v_lshlrev_b32 v48, 16, v224
 v_and_b32 v49, 0xffff0000, v224
 v_lshlrev_b32 v50, 16, v225
 v_and_b32 v51, 0xffff0000, v225
 v_lshlrev_b32 v52, 16, v226
 v_and_b32 v53, 0xffff0000, v226
 v_lshlrev_b32 v54, 16, v227
 v_and_b32 v55, 0xffff0000, v227
 s_cmp_eq_u32 s20, 3
 s_cbranch_scc1 mk_w3_39
 v_lshlrev_b32 v56, 16, v228
 v_and_b32 v57, 0xffff0000, v228
 v_lshlrev_b32 v58, 16, v229
 v_and_b32 v59, 0xffff0000, v229
 v_lshlrev_b32 v60, 16, v230
 v_and_b32 v61, 0xffff0000, v230
 v_lshlrev_b32 v62, 16, v231
 v_and_b32 v63, 0xffff0000, v231
mk_w3_39:
 s_mov_b32 s98, 0x3f80
 s_mov_b32 s99, 0x3f800000
 s_cmp_eq_u32 s20, 3
 s_cbranch_scc1 mk_w3_40
 s_waitcnt vmcnt(31)
 v_dot2_f32_bf16 v48, v64, s98, v48
 v_dot2_f32_bf16 v49, v64, s99, v49
 v_dot2_f32_bf16 v50, v65, s98, v50
 v_dot2_f32_bf16 v51, v65, s99, v51
 v_dot2_f32_bf16 v52, v66, s98, v52
 v_dot2_f32_bf16 v53, v66, s99, v53
 v_dot2_f32_bf16 v54, v67, s98, v54
 v_dot2_f32_bf16 v55, v67, s99, v55
 s_waitcnt vmcnt(30)
 v_dot2_f32_bf16 v48, v68, s98, v48
 v_dot2_f32_bf16 v49, v68, s99, v49
 v_dot2_f32_bf16 v50, v69, s98, v50
 v_dot2_f32_bf16 v51, v69, s99, v51
 v_dot2_f32_bf16 v52, v70, s98, v52
 v_dot2_f32_bf16 v53, v70, s99, v53
 v_dot2_f32_bf16 v54, v71, s98, v54
 v_dot2_f32_bf16 v55, v71, s99, v55
 s_waitcnt vmcnt(29)
 v_dot2_f32_bf16 v48, v72, s98, v48
 v_dot2_f32_bf16 v49, v72, s99, v49
 v_dot2_f32_bf16 v50, v73, s98, v50
 v_dot2_f32_bf16 v51, v73, s99, v51
 v_dot2_f32_bf16 v52, v74, s98, v52
 v_dot2_f32_bf16 v53, v74, s99, v53
 v_dot2_f32_bf16 v54, v75, s98, v54
 v_dot2_f32_bf16 v55, v75, s99, v55
 s_waitcnt vmcnt(28)
 v_dot2_f32_bf16 v48, v76, s98, v48
 v_dot2_f32_bf16 v49, v76, s99, v49
 v_dot2_f32_bf16 v50, v77, s98, v50
 v_dot2_f32_bf16 v51, v77, s99, v51
 v_dot2_f32_bf16 v52, v78, s98, v52
 v_dot2_f32_bf16 v53, v78, s99, v53
 v_dot2_f32_bf16 v54, v79, s98, v54
 v_dot2_f32_bf16 v55, v79, s99, v55
 s_waitcnt vmcnt(27)
 v_dot2_f32_bf16 v48, v80, s98, v48
 v_dot2_f32_bf16 v49, v80, s99, v49
 v_dot2_f32_bf16 v50, v81, s98, v50
 v_dot2_f32_bf16 v51, v81, s99, v51
 v_dot2_f32_bf16 v52, v82, s98, v52
 v_dot2_f32_bf16 v53, v82, s99, v53
 v_dot2_f32_bf16 v54, v83, s98, v54
 v_dot2_f32_bf16 v55, v83, s99, v55
 s_waitcnt vmcnt(26)
 v_dot2_f32_bf16 v48, v84, s98, v48
 v_dot2_f32_bf16 v49, v84, s99, v49
 v_dot2_f32_bf16 v50, v85, s98, v50
 v_dot2_f32_bf16 v51, v85, s99, v51
 v_dot2_f32_bf16 v52, v86, s98, v52
 v_dot2_f32_bf16 v53, v86, s99, v53
 v_dot2_f32_bf16 v54, v87, s98, v54
 v_dot2_f32_bf16 v55, v87, s99, v55
 s_waitcnt vmcnt(25)
 v_dot2_f32_bf16 v48, v88, s98, v48
 v_dot2_f32_bf16 v49, v88, s99, v49
 v_dot2_f32_bf16 v50, v89, s98, v50
 v_dot2_f32_bf16 v51, v89, s99, v51
 v_dot2_f32_bf16 v52, v90, s98, v52
 v_dot2_f32_bf16 v53, v90, s99, v53
 v_dot2_f32_bf16 v54, v91, s98, v54
 v_dot2_f32_bf16 v55, v91, s99, v55
 s_waitcnt vmcnt(24)
 v_dot2_f32_bf16 v48, v92, s98, v48
 v_dot2_f32_bf16 v49, v92, s99, v49
 v_dot2_f32_bf16 v50, v93, s98, v50
 v_dot2_f32_bf16 v51, v93, s99, v51
 v_dot2_f32_bf16 v52, v94, s98, v52
 v_dot2_f32_bf16 v53, v94, s99, v53
 v_dot2_f32_bf16 v54, v95, s98, v54
 v_dot2_f32_bf16 v55, v95, s99, v55
 s_waitcnt vmcnt(23)
 v_dot2_f32_bf16 v48, v96, s98, v48
 v_dot2_f32_bf16 v49, v96, s99, v49
 v_dot2_f32_bf16 v50, v97, s98, v50
 v_dot2_f32_bf16 v51, v97, s99, v51
 v_dot2_f32_bf16 v52, v98, s98, v52
 v_dot2_f32_bf16 v53, v98, s99, v53
 v_dot2_f32_bf16 v54, v99, s98, v54
 v_dot2_f32_bf16 v55, v99, s99, v55
 s_waitcnt vmcnt(22)
 v_dot2_f32_bf16 v48, v100, s98, v48
 v_dot2_f32_bf16 v49, v100, s99, v49
 v_dot2_f32_bf16 v50, v101, s98, v50
 v_dot2_f32_bf16 v51, v101, s99, v51
 v_dot2_f32_bf16 v52, v102, s98, v52
 v_dot2_f32_bf16 v53, v102, s99, v53
 v_dot2_f32_bf16 v54, v103, s98, v54
 v_dot2_f32_bf16 v55, v103, s99, v55
 s_waitcnt vmcnt(21)
 v_dot2_f32_bf16 v48, v104, s98, v48
 v_dot2_f32_bf16 v49, v104, s99, v49
 v_dot2_f32_bf16 v50, v105, s98, v50
 v_dot2_f32_bf16 v51, v105, s99, v51
 v_dot2_f32_bf16 v52, v106, s98, v52
 v_dot2_f32_bf16 v53, v106, s99, v53
 v_dot2_f32_bf16 v54, v107, s98, v54
 v_dot2_f32_bf16 v55, v107, s99, v55
 s_waitcnt vmcnt(20)
 v_dot2_f32_bf16 v48, v108, s98, v48
 v_dot2_f32_bf16 v49, v108, s99, v49
 v_dot2_f32_bf16 v50, v109, s98, v50
 v_dot2_f32_bf16 v51, v109, s99, v51
 v_dot2_f32_bf16 v52, v110, s98, v52
 v_dot2_f32_bf16 v53, v110, s99, v53
 v_dot2_f32_bf16 v54, v111, s98, v54
 v_dot2_f32_bf16 v55, v111, s99, v55
 s_waitcnt vmcnt(19)
 v_dot2_f32_bf16 v48, v112, s98, v48
 v_dot2_f32_bf16 v49, v112, s99, v49
 v_dot2_f32_bf16 v50, v113, s98, v50
 v_dot2_f32_bf16 v51, v113, s99, v51
 v_dot2_f32_bf16 v52, v114, s98, v52
 v_dot2_f32_bf16 v53, v114, s99, v53
 v_dot2_f32_bf16 v54, v115, s98, v54
 v_dot2_f32_bf16 v55, v115, s99, v55
 s_waitcnt vmcnt(18)
 v_dot2_f32_bf16 v48, v116, s98, v48
 v_dot2_f32_bf16 v49, v116, s99, v49
 v_dot2_f32_bf16 v50, v117, s98, v50
 v_dot2_f32_bf16 v51, v117, s99, v51
 v_dot2_f32_bf16 v52, v118, s98, v52
 v_dot2_f32_bf16 v53, v118, s99, v53
 v_dot2_f32_bf16 v54, v119, s98, v54
 v_dot2_f32_bf16 v55, v119, s99, v55
 s_waitcnt vmcnt(17)
 v_dot2_f32_bf16 v48, v120, s98, v48
 v_dot2_f32_bf16 v49, v120, s99, v49
 v_dot2_f32_bf16 v50, v121, s98, v50
 v_dot2_f32_bf16 v51, v121, s99, v51
 v_dot2_f32_bf16 v52, v122, s98, v52
 v_dot2_f32_bf16 v53, v122, s99, v53
 v_dot2_f32_bf16 v54, v123, s98, v54
 v_dot2_f32_bf16 v55, v123, s99, v55
 s_waitcnt vmcnt(16)
 v_dot2_f32_bf16 v48, v124, s98, v48
 v_dot2_f32_bf16 v49, v124, s99, v49
 v_dot2_f32_bf16 v50, v125, s98, v50
 v_dot2_f32_bf16 v51, v125, s99, v51
 v_dot2_f32_bf16 v52, v126, s98, v52
 v_dot2_f32_bf16 v53, v126, s99, v53
 v_dot2_f32_bf16 v54, v127, s98, v54
 v_dot2_f32_bf16 v55, v127, s99, v55
 s_waitcnt vmcnt(15)
 v_dot2_f32_bf16 v56, v128, s98, v56
 v_dot2_f32_bf16 v57, v128, s99, v57
 v_dot2_f32_bf16 v58, v129, s98, v58
 v_dot2_f32_bf16 v59, v129, s99, v59
 v_dot2_f32_bf16 v60, v130, s98, v60
 v_dot2_f32_bf16 v61, v130, s99, v61
 v_dot2_f32_bf16 v62, v131, s98, v62
 v_dot2_f32_bf16 v63, v131, s99, v63
 s_waitcnt vmcnt(14)
 v_dot2_f32_bf16 v56, v132, s98, v56
 v_dot2_f32_bf16 v57, v132, s99, v57
 v_dot2_f32_bf16 v58, v133, s98, v58
 v_dot2_f32_bf16 v59, v133, s99, v59
 v_dot2_f32_bf16 v60, v134, s98, v60
 v_dot2_f32_bf16 v61, v134, s99, v61
 v_dot2_f32_bf16 v62, v135, s98, v62
 v_dot2_f32_bf16 v63, v135, s99, v63
 s_waitcnt vmcnt(13)
 v_dot2_f32_bf16 v56, v136, s98, v56
 v_dot2_f32_bf16 v57, v136, s99, v57
 v_dot2_f32_bf16 v58, v137, s98, v58
 v_dot2_f32_bf16 v59, v137, s99, v59
 v_dot2_f32_bf16 v60, v138, s98, v60
 v_dot2_f32_bf16 v61, v138, s99, v61
 v_dot2_f32_bf16 v62, v139, s98, v62
 v_dot2_f32_bf16 v63, v139, s99, v63
 s_waitcnt vmcnt(12)
 v_dot2_f32_bf16 v56, v140, s98, v56
 v_dot2_f32_bf16 v57, v140, s99, v57
 v_dot2_f32_bf16 v58, v141, s98, v58
 v_dot2_f32_bf16 v59, v141, s99, v59
 v_dot2_f32_bf16 v60, v142, s98, v60
 v_dot2_f32_bf16 v61, v142, s99, v61
 v_dot2_f32_bf16 v62, v143, s98, v62
 v_dot2_f32_bf16 v63, v143, s99, v63
 s_waitcnt vmcnt(11)
 v_dot2_f32_bf16 v56, v144, s98, v56
 v_dot2_f32_bf16 v57, v144, s99, v57
 v_dot2_f32_bf16 v58, v145, s98, v58
 v_dot2_f32_bf16 v59, v145, s99, v59
 v_dot2_f32_bf16 v60, v146, s98, v60
 v_dot2_f32_bf16 v61, v146, s99, v61
 v_dot2_f32_bf16 v62, v147, s98, v62
 v_dot2_f32_bf16 v63, v147, s99, v63
 s_waitcnt vmcnt(10)
 v_dot2_f32_bf16 v56, v148, s98, v56
 v_dot2_f32_bf16 v57, v148, s99, v57
 v_dot2_f32_bf16 v58, v149, s98, v58
 v_dot2_f32_bf16 v59, v149, s99, v59
 v_dot2_f32_bf16 v60, v150, s98, v60
 v_dot2_f32_bf16 v61, v150, s99, v61
 v_dot2_f32_bf16 v62, v151, s98, v62
 v_dot2_f32_bf16 v63, v151, s99, v63
 s_waitcnt vmcnt(9)
 v_dot2_f32_bf16 v56, v152, s98, v56
 v_dot2_f32_bf16 v57, v152, s99, v57
 v_dot2_f32_bf16 v58, v153, s98, v58
 v_dot2_f32_bf16 v59, v153, s99, v59
 v_dot2_f32_bf16 v60, v154, s98, v60
 v_dot2_f32_bf16 v61, v154, s99, v61
 v_dot2_f32_bf16 v62, v155, s98, v62
 v_dot2_f32_bf16 v63, v155, s99, v63
 s_waitcnt vmcnt(8)
 v_dot2_f32_bf16 v56, v156, s98, v56
 v_dot2_f32_bf16 v57, v156, s99, v57
 v_dot2_f32_bf16 v58, v157, s98, v58
 v_dot2_f32_bf16 v59, v157, s99, v59
 v_dot2_f32_bf16 v60, v158, s98, v60
 v_dot2_f32_bf16 v61, v158, s99, v61
 v_dot2_f32_bf16 v62, v159, s98, v62
 v_dot2_f32_bf16 v63, v159, s99, v63
 s_waitcnt vmcnt(7)
 v_dot2_f32_bf16 v56, v160, s98, v56
 v_dot2_f32_bf16 v57, v160, s99, v57
 v_dot2_f32_bf16 v58, v161, s98, v58
 v_dot2_f32_bf16 v59, v161, s99, v59
 v_dot2_f32_bf16 v60, v162, s98, v60
 v_dot2_f32_bf16 v61, v162, s99, v61
 v_dot2_f32_bf16 v62, v163, s98, v62
 v_dot2_f32_bf16 v63, v163, s99, v63
 s_waitcnt vmcnt(6)
 v_dot2_f32_bf16 v56, v164, s98, v56
 v_dot2_f32_bf16 v57, v164, s99, v57
 v_dot2_f32_bf16 v58, v165, s98, v58
 v_dot2_f32_bf16 v59, v165, s99, v59
 v_dot2_f32_bf16 v60, v166, s98, v60
 v_dot2_f32_bf16 v61, v166, s99, v61
 v_dot2_f32_bf16 v62, v167, s98, v62
 v_dot2_f32_bf16 v63, v167, s99, v63
 s_waitcnt vmcnt(5)
 v_dot2_f32_bf16 v56, v168, s98, v56
 v_dot2_f32_bf16 v57, v168, s99, v57
 v_dot2_f32_bf16 v58, v169, s98, v58
 v_dot2_f32_bf16 v59, v169, s99, v59
 v_dot2_f32_bf16 v60, v170, s98, v60
 v_dot2_f32_bf16 v61, v170, s99, v61
 v_dot2_f32_bf16 v62, v171, s98, v62
 v_dot2_f32_bf16 v63, v171, s99, v63
 s_waitcnt vmcnt(4)
 v_dot2_f32_bf16 v56, v172, s98, v56
 v_dot2_f32_bf16 v57, v172, s99, v57
 v_dot2_f32_bf16 v58, v173, s98, v58
 v_dot2_f32_bf16 v59, v173, s99, v59
 v_dot2_f32_bf16 v60, v174, s98, v60
 v_dot2_f32_bf16 v61, v174, s99, v61
 v_dot2_f32_bf16 v62, v175, s98, v62
 v_dot2_f32_bf16 v63, v175, s99, v63
 s_waitcnt vmcnt(3)
 v_dot2_f32_bf16 v56, v176, s98, v56
 v_dot2_f32_bf16 v57, v176, s99, v57
 v_dot2_f32_bf16 v58, v177, s98, v58
 v_dot2_f32_bf16 v59, v177, s99, v59
 v_dot2_f32_bf16 v60, v178, s98, v60
 v_dot2_f32_bf16 v61, v178, s99, v61
 v_dot2_f32_bf16 v62, v179, s98, v62
 v_dot2_f32_bf16 v63, v179, s99, v63
 s_waitcnt vmcnt(2)
 v_dot2_f32_bf16 v56, v180, s98, v56
 v_dot2_f32_bf16 v57, v180, s99, v57
 v_dot2_f32_bf16 v58, v181, s98, v58
 v_dot2_f32_bf16 v59, v181, s99, v59
 v_dot2_f32_bf16 v60, v182, s98, v60
 v_dot2_f32_bf16 v61, v182, s99, v61
 v_dot2_f32_bf16 v62, v183, s98, v62
 v_dot2_f32_bf16 v63, v183, s99, v63
 s_waitcnt vmcnt(1)
 v_dot2_f32_bf16 v56, v184, s98, v56
 v_dot2_f32_bf16 v57, v184, s99, v57
 v_dot2_f32_bf16 v58, v185, s98, v58
 v_dot2_f32_bf16 v59, v185, s99, v59
 v_dot2_f32_bf16 v60, v186, s98, v60
 v_dot2_f32_bf16 v61, v186, s99, v61
 v_dot2_f32_bf16 v62, v187, s98, v62
 v_dot2_f32_bf16 v63, v187, s99, v63
 s_waitcnt vmcnt(0)
 v_dot2_f32_bf16 v56, v188, s98, v56
 v_dot2_f32_bf16 v57, v188, s99, v57
 v_dot2_f32_bf16 v58, v189, s98, v58
 v_dot2_f32_bf16 v59, v189, s99, v59
 v_dot2_f32_bf16 v60, v190, s98, v60
 v_dot2_f32_bf16 v61, v190, s99, v61
 v_dot2_f32_bf16 v62, v191, s98, v62
 v_dot2_f32_bf16 v63, v191, s99, v63
 s_branch mk_ae_41
mk_w3_40:
 s_waitcnt vmcnt(15)
 v_dot2_f32_bf16 v48, v64, s98, v48
 v_dot2_f32_bf16 v49, v64, s99, v49
 v_dot2_f32_bf16 v50, v65, s98, v50
 v_dot2_f32_bf16 v51, v65, s99, v51
 v_dot2_f32_bf16 v52, v66, s98, v52
 v_dot2_f32_bf16 v53, v66, s99, v53
 v_dot2_f32_bf16 v54, v67, s98, v54
 v_dot2_f32_bf16 v55, v67, s99, v55
 s_waitcnt vmcnt(14)
 v_dot2_f32_bf16 v48, v68, s98, v48
 v_dot2_f32_bf16 v49, v68, s99, v49
 v_dot2_f32_bf16 v50, v69, s98, v50
 v_dot2_f32_bf16 v51, v69, s99, v51
 v_dot2_f32_bf16 v52, v70, s98, v52
 v_dot2_f32_bf16 v53, v70, s99, v53
 v_dot2_f32_bf16 v54, v71, s98, v54
 v_dot2_f32_bf16 v55, v71, s99, v55
 s_waitcnt vmcnt(13)
 v_dot2_f32_bf16 v48, v72, s98, v48
 v_dot2_f32_bf16 v49, v72, s99, v49
 v_dot2_f32_bf16 v50, v73, s98, v50
 v_dot2_f32_bf16 v51, v73, s99, v51
 v_dot2_f32_bf16 v52, v74, s98, v52
 v_dot2_f32_bf16 v53, v74, s99, v53
 v_dot2_f32_bf16 v54, v75, s98, v54
 v_dot2_f32_bf16 v55, v75, s99, v55
 s_waitcnt vmcnt(12)
 v_dot2_f32_bf16 v48, v76, s98, v48
 v_dot2_f32_bf16 v49, v76, s99, v49
 v_dot2_f32_bf16 v50, v77, s98, v50
 v_dot2_f32_bf16 v51, v77, s99, v51
 v_dot2_f32_bf16 v52, v78, s98, v52
 v_dot2_f32_bf16 v53, v78, s99, v53
 v_dot2_f32_bf16 v54, v79, s98, v54
 v_dot2_f32_bf16 v55, v79, s99, v55
 s_waitcnt vmcnt(11)
 v_dot2_f32_bf16 v48, v80, s98, v48
 v_dot2_f32_bf16 v49, v80, s99, v49
 v_dot2_f32_bf16 v50, v81, s98, v50
 v_dot2_f32_bf16 v51, v81, s99, v51
 v_dot2_f32_bf16 v52, v82, s98, v52
 v_dot2_f32_bf16 v53, v82, s99, v53
 v_dot2_f32_bf16 v54, v83, s98, v54
 v_dot2_f32_bf16 v55, v83, s99, v55
 s_waitcnt vmcnt(10)
 v_dot2_f32_bf16 v48, v84, s98, v48
 v_dot2_f32_bf16 v49, v84, s99, v49
 v_dot2_f32_bf16 v50, v85, s98, v50
 v_dot2_f32_bf16 v51, v85, s99, v51
 v_dot2_f32_bf16 v52, v86, s98, v52
 v_dot2_f32_bf16 v53, v86, s99, v53
 v_dot2_f32_bf16 v54, v87, s98, v54
 v_dot2_f32_bf16 v55, v87, s99, v55
 s_waitcnt vmcnt(9)
 v_dot2_f32_bf16 v48, v88, s98, v48
 v_dot2_f32_bf16 v49, v88, s99, v49
 v_dot2_f32_bf16 v50, v89, s98, v50
 v_dot2_f32_bf16 v51, v89, s99, v51
 v_dot2_f32_bf16 v52, v90, s98, v52
 v_dot2_f32_bf16 v53, v90, s99, v53
 v_dot2_f32_bf16 v54, v91, s98, v54
 v_dot2_f32_bf16 v55, v91, s99, v55
 s_waitcnt vmcnt(8)
 v_dot2_f32_bf16 v48, v92, s98, v48
 v_dot2_f32_bf16 v49, v92, s99, v49
 v_dot2_f32_bf16 v50, v93, s98, v50
 v_dot2_f32_bf16 v51, v93, s99, v51
 v_dot2_f32_bf16 v52, v94, s98, v52
 v_dot2_f32_bf16 v53, v94, s99, v53
 v_dot2_f32_bf16 v54, v95, s98, v54
 v_dot2_f32_bf16 v55, v95, s99, v55
 s_waitcnt vmcnt(7)
 v_dot2_f32_bf16 v48, v96, s98, v48
 v_dot2_f32_bf16 v49, v96, s99, v49
 v_dot2_f32_bf16 v50, v97, s98, v50
 v_dot2_f32_bf16 v51, v97, s99, v51
 v_dot2_f32_bf16 v52, v98, s98, v52
 v_dot2_f32_bf16 v53, v98, s99, v53
 v_dot2_f32_bf16 v54, v99, s98, v54
 v_dot2_f32_bf16 v55, v99, s99, v55
 s_waitcnt vmcnt(6)
 v_dot2_f32_bf16 v48, v100, s98, v48
 v_dot2_f32_bf16 v49, v100, s99, v49
 v_dot2_f32_bf16 v50, v101, s98, v50
 v_dot2_f32_bf16 v51, v101, s99, v51
 v_dot2_f32_bf16 v52, v102, s98, v52
 v_dot2_f32_bf16 v53, v102, s99, v53
 v_dot2_f32_bf16 v54, v103, s98, v54
 v_dot2_f32_bf16 v55, v103, s99, v55
 s_waitcnt vmcnt(5)
 v_dot2_f32_bf16 v48, v104, s98, v48
 v_dot2_f32_bf16 v49, v104, s99, v49
 v_dot2_f32_bf16 v50, v105, s98, v50
 v_dot2_f32_bf16 v51, v105, s99, v51
 v_dot2_f32_bf16 v52, v106, s98, v52
 v_dot2_f32_bf16 v53, v106, s99, v53
 v_dot2_f32_bf16 v54, v107, s98, v54
 v_dot2_f32_bf16 v55, v107, s99, v55
 s_waitcnt vmcnt(4)
 v_dot2_f32_bf16 v48, v108, s98, v48
 v_dot2_f32_bf16 v49, v108, s99, v49
 v_dot2_f32_bf16 v50, v109, s98, v50
 v_dot2_f32_bf16 v51, v109, s99, v51
 v_dot2_f32_bf16 v52, v110, s98, v52
 v_dot2_f32_bf16 v53, v110, s99, v53
 v_dot2_f32_bf16 v54, v111, s98, v54
 v_dot2_f32_bf16 v55, v111, s99, v55
 s_waitcnt vmcnt(3)
 v_dot2_f32_bf16 v48, v112, s98, v48
 v_dot2_f32_bf16 v49, v112, s99, v49
 v_dot2_f32_bf16 v50, v113, s98, v50
 v_dot2_f32_bf16 v51, v113, s99, v51
 v_dot2_f32_bf16 v52, v114, s98, v52
 v_dot2_f32_bf16 v53, v114, s99, v53
 v_dot2_f32_bf16 v54, v115, s98, v54
 v_dot2_f32_bf16 v55, v115, s99, v55
 s_waitcnt vmcnt(2)
 v_dot2_f32_bf16 v48, v116, s98, v48
 v_dot2_f32_bf16 v49, v116, s99, v49
 v_dot2_f32_bf16 v50, v117, s98, v50
 v_dot2_f32_bf16 v51, v117, s99, v51
 v_dot2_f32_bf16 v52, v118, s98, v52
 v_dot2_f32_bf16 v53, v118, s99, v53
 v_dot2_f32_bf16 v54, v119, s98, v54
 v_dot2_f32_bf16 v55, v119, s99, v55
 s_waitcnt vmcnt(1)
 v_dot2_f32_bf16 v48, v120, s98, v48
 v_dot2_f32_bf16 v49, v120, s99, v49
 v_dot2_f32_bf16 v50, v121, s98, v50
 v_dot2_f32_bf16 v51, v121, s99, v51
 v_dot2_f32_bf16 v52, v122, s98, v52
 v_dot2_f32_bf16 v53, v122, s99, v53
 v_dot2_f32_bf16 v54, v123, s98, v54
 v_dot2_f32_bf16 v55, v123, s99, v55
 s_waitcnt vmcnt(0)
 v_dot2_f32_bf16 v48, v124, s98, v48
 v_dot2_f32_bf16 v49, v124, s99, v49
 v_dot2_f32_bf16 v50, v125, s98, v50
 v_dot2_f32_bf16 v51, v125, s99, v51
 v_dot2_f32_bf16 v52, v126, s98, v52
 v_dot2_f32_bf16 v53, v126, s99, v53
 v_dot2_f32_bf16 v54, v127, s98, v54
 v_dot2_f32_bf16 v55, v127, s99, v55
mk_ae_41:
 v_accvgpr_write_b32 a0, v48
 v_accvgpr_write_b32 a1, v49
 v_accvgpr_write_b32 a2, v50
 v_accvgpr_write_b32 a3, v51
 v_accvgpr_write_b32 a4, v52
 v_accvgpr_write_b32 a5, v53
 v_accvgpr_write_b32 a6, v54
 v_accvgpr_write_b32 a7, v55
 v_accvgpr_write_b32 a8, v56
 v_accvgpr_write_b32 a9, v57
 v_accvgpr_write_b32 a10, v58
 v_accvgpr_write_b32 a11, v59
 v_accvgpr_write_b32 a12, v60
 v_accvgpr_write_b32 a13, v61
 v_accvgpr_write_b32 a14, v62
 v_accvgpr_write_b32 a15, v63
 v_lshlrev_b32 v42, 1, v42
 v_add_u32 v42, 131072, v42
 v_lshlrev_b32 v43, 1, v43
 v_add_u32 v43, 131072, v43
 v_add_f32 v200, v48, v49
 v_mul_f32 v201, v48, v48
 v_fmac_f32 v201, v49, v49
 v_add_f32 v200, v200, v50
 v_fmac_f32 v201, v50, v50
 v_add_f32 v200, v200, v51
 v_fmac_f32 v201, v51, v51
 v_add_f32 v200, v200, v52
 v_fmac_f32 v201, v52, v52
 v_add_f32 v200, v200, v53
 v_fmac_f32 v201, v53, v53
 v_add_f32 v200, v200, v54
 v_fmac_f32 v201, v54, v54
 v_add_f32 v200, v200, v55
 v_fmac_f32 v201, v55, v55
 s_cmp_eq_u32 s20, 3
 s_cbranch_scc1 mk_w3_42
 v_add_f32 v200, v200, v56
 v_fmac_f32 v201, v56, v56
 v_add_f32 v200, v200, v57
 v_fmac_f32 v201, v57, v57
 v_add_f32 v200, v200, v58
 v_fmac_f32 v201, v58, v58
 v_add_f32 v200, v200, v59
 v_fmac_f32 v201, v59, v59
 v_add_f32 v200, v200, v60
 v_fmac_f32 v201, v60, v60
 v_add_f32 v200, v200, v61
 v_fmac_f32 v201, v61, v61
 v_add_f32 v200, v200, v62
 v_fmac_f32 v201, v62, v62
 v_add_f32 v200, v200, v63
 v_fmac_f32 v201, v63, v63
mk_w3_42:
 s_nop 1
 v_add_f32_dpp v200, v200, v200 row_ror:8 row_mask:0xf bank_mask:0xf
 v_add_f32_dpp v201, v201, v201 row_ror:8 row_mask:0xf bank_mask:0xf
 v_mov_b32 v202, v200
 v_mov_b32 v203, v201
 s_nop 1
 v_permlane16_swap_b32 v202, v200
 v_permlane16_swap_b32 v203, v201
 v_add_f32 v200, v200, v202
 v_add_f32 v201, v201, v203
 v_mov_b32 v202, v200
 v_mov_b32 v203, v201
 s_nop 1
 v_permlane32_swap_b32 v202, v200
 v_permlane32_swap_b32 v203, v201
 v_add_f32 v200, v200, v202
 v_add_f32 v201, v201, v203
 ds_write_b64 v42, v[200:201]
 s_waitcnt lgkmcnt(0)
 s_barrier
 ds_read_b128 v[200:203], v43
 ds_read_b128 v[204:207], v43 offset:16
 s_waitcnt lgkmcnt(0)
 v_add_f32 v200, v200, v202
 v_add_f32 v201, v201, v203
 v_add_f32 v200, v200, v204
 v_add_f32 v201, v201, v205
 v_add_f32 v200, v200, v206
 v_add_f32 v201, v201, v207
 v_mul_f32 v200, 0x3b124925, v200
 v_mul_f32 v201, 0x3b124925, v201
 v_fma_f32 v201, -v200, v200, v201
 v_max_f32 v201, 0, v201
 v_add_f32 v201, 0x3727c5ac, v201
 v_rsq_f32 v201, v201
 s_nop 0
 s_lshr_b32 s42, s70, 1
 s_mul_i32 s42, s42, 14336
 s_add_u32 s42, s42, 0x2200000
 v_sub_f32 v48, v48, v200
 v_sub_f32 v49, v49, v200
 v_sub_f32 v50, v50, v200
 v_sub_f32 v51, v51, v200
 v_sub_f32 v52, v52, v200
 v_sub_f32 v53, v53, v200
 v_sub_f32 v54, v54, v200
 v_sub_f32 v55, v55, v200
 v_mul_f32 v48, v48, v201
 v_mul_f32 v49, v49, v201
 v_mul_f32 v50, v50, v201
 v_mul_f32 v51, v51, v201
 v_mul_f32 v52, v52, v201
 v_mul_f32 v53, v53, v201
 v_mul_f32 v54, v54, v201
 v_mul_f32 v55, v55, v201
 v_cvt_pk_bf16_f32 v204, v48, v49
 v_cvt_pk_bf16_f32 v205, v50, v51
 v_cvt_pk_bf16_f32 v206, v52, v53
 v_cvt_pk_bf16_f32 v207, v54, v55
 buffer_store_dwordx4 v[204:207], v40, s[4:7], s42 offen sc1
 s_nop 1
 s_cmp_eq_u32 s20, 3
 s_cbranch_scc1 mk_w3_43
 v_sub_f32 v56, v56, v200
 v_sub_f32 v57, v57, v200
 v_sub_f32 v58, v58, v200
 v_sub_f32 v59, v59, v200
 v_sub_f32 v60, v60, v200
 v_sub_f32 v61, v61, v200
 v_sub_f32 v62, v62, v200
 v_sub_f32 v63, v63, v200
 v_mul_f32 v56, v56, v201
 v_mul_f32 v57, v57, v201
 v_mul_f32 v58, v58, v201
 v_mul_f32 v59, v59, v201
 v_mul_f32 v60, v60, v201
 v_mul_f32 v61, v61, v201
 v_mul_f32 v62, v62, v201
 v_mul_f32 v63, v63, v201
 v_cvt_pk_bf16_f32 v204, v56, v57
 v_cvt_pk_bf16_f32 v205, v58, v59
 v_cvt_pk_bf16_f32 v206, v60, v61
 v_cvt_pk_bf16_f32 v207, v62, v63
 s_add_u32 s42, s42, 8192
 buffer_store_dwordx4 v[204:207], v40, s[4:7], s42 offen sc1
 s_nop 1
mk_w3_43:
 s_waitcnt vmcnt(0)
 s_barrier
 s_add_u32 s41, s39, 48
 s_cmp_eq_u32 s20, 0
 s_cbranch_scc0 mk_sg_44
 s_lshl_b32 s44, s41, 8
 v_mov_b32 v29, s44
 v_mov_b32 v30, 1
 s_mov_b64 exec, 1
 global_atomic_add v29, v30, s[96:97] sc1
 s_mov_b64 exec, -1
mk_sg_44:
 v_and_b32 v44, 63, v0
 v_and_b32 v45, 15, v44
 v_lshrrev_b32 v46, 4, v44
 v_lshrrev_b32 v48, 2, v45
 v_lshl_add_u32 v47, v46, 2, v48
 v_mul_u32_u24 v47, 224, v47
 v_and_b32 v49, 3, v45
 v_lshl_add_u32 v18, v49, 3, v47
 s_add_u32 s41, s64, 48
 s_cmp_eq_u32 s20, 0
 s_cbranch_scc0 mk_wf_45
 s_lshl_b32 s44, s41, 8
 v_mov_b32 v29, s44
 s_mov_b32 s44, 0
mk_sp_46:
 global_load_dword v30, v29, s[96:97] sc1
 s_waitcnt vmcnt(0)
 v_readfirstlane_b32 s43, v30
 s_add_u32 s44, s44, 1
 s_bfe_u32 s43, s43, 0x100000
 s_cmp_ge_u32 s43, 16
 s_cbranch_scc1 mk_sp_46_ok
 s_sleep 2
 s_cmp_lt_u32 s44, 0x40000
 s_cbranch_scc1 mk_sp_46
mk_sp_46_ok:
mk_wf_45:
 s_barrier
 s_lshl_b32 s41, s64, 2
 s_add_u32 s41, s41, s20
 s_mul_i32 s42, s41, 28672
 s_add_u32 s42, s42, 0x2200000
 s_add_u32 s43, s42, 14336
 buffer_load_dwordx4 a[128:131], v1, s[4:7], s42 offen offset:0
 buffer_load_dwordx4 a[184:187], v1, s[4:7], s43 offen offset:0
 buffer_load_dwordx4 a[132:135], v1, s[4:7], s42 offen offset:1024
 buffer_load_dwordx4 a[188:191], v1, s[4:7], s43 offen offset:1024
 buffer_load_dwordx4 a[136:139], v1, s[4:7], s42 offen offset:2048
 buffer_load_dwordx4 a[192:195], v1, s[4:7], s43 offen offset:2048
 buffer_load_dwordx4 a[140:143], v1, s[4:7], s42 offen offset:3072
 buffer_load_dwordx4 a[196:199], v1, s[4:7], s43 offen offset:3072
 s_add_u32 s42, s42, 4096
 s_add_u32 s43, s43, 4096
 buffer_load_dwordx4 a[144:147], v1, s[4:7], s42 offen offset:0
 buffer_load_dwordx4 a[200:203], v1, s[4:7], s43 offen offset:0
 buffer_load_dwordx4 a[148:151], v1, s[4:7], s42 offen offset:1024
 buffer_load_dwordx4 a[204:207], v1, s[4:7], s43 offen offset:1024
 buffer_load_dwordx4 a[152:155], v1, s[4:7], s42 offen offset:2048
 buffer_load_dwordx4 a[208:211], v1, s[4:7], s43 offen offset:2048
 buffer_load_dwordx4 a[156:159], v1, s[4:7], s42 offen offset:3072
 buffer_load_dwordx4 a[212:215], v1, s[4:7], s43 offen offset:3072
 s_add_u32 s42, s42, 4096
 s_add_u32 s43, s43, 4096
 buffer_load_dwordx4 a[160:163], v1, s[4:7], s42 offen offset:0
 buffer_load_dwordx4 a[216:219], v1, s[4:7], s43 offen offset:0
 buffer_load_dwordx4 a[164:167], v1, s[4:7], s42 offen offset:1024
 buffer_load_dwordx4 a[220:223], v1, s[4:7], s43 offen offset:1024
 buffer_load_dwordx4 a[168:171], v1, s[4:7], s42 offen offset:2048
 buffer_load_dwordx4 a[224:227], v1, s[4:7], s43 offen offset:2048
 buffer_load_dwordx4 a[172:175], v1, s[4:7], s42 offen offset:3072
 buffer_load_dwordx4 a[228:231], v1, s[4:7], s43 offen offset:3072
 s_add_u32 s42, s42, 4096
 s_add_u32 s43, s43, 4096
 buffer_load_dwordx4 a[176:179], v1, s[4:7], s42 offen offset:0
 buffer_load_dwordx4 a[232:235], v1, s[4:7], s43 offen offset:0
 buffer_load_dwordx4 a[180:183], v1, s[4:7], s42 offen offset:1024
 buffer_load_dwordx4 a[236:239], v1, s[4:7], s43 offen offset:1024
 s_lshl_b32 s41, s41, 5
 s_add_u32 s41, s41, s63
 s_mul_i32 s65, s41, 14336
 s_add_u32 s65, s65, 0x6000000
 s_waitcnt vmcnt(24)
 s_waitcnt vmcnt(63)
 s_barrier
 v_add_u32 v2, s24, v18
 RW 64,2,0
 RW 66,2,3584
 RW 68,2,14336
 RW 70,2,17920
 RW 72,2,32
 RW 74,2,3616
 RW 76,2,14368
 RW 78,2,17952
 RW 80,2,64
 RW 82,2,3648
 RW 84,2,14400
 RW 86,2,17984
 RW 88,2,96
 RW 90,2,3680
 s_waitcnt lgkmcnt(10)
 GAZ 128,64,128
 s_add_u32 s25, s24, 0x18000
 RW 92,2,14432
 s_and_b32 s25, s25, 0x1ffff
 GAZ 132,64,184
 s_add_u32 s24, s24, 0x8000
 RW 94,2,18016
 s_and_b32 s24, s24, 0x1ffff
 GAZ 188,68,184
 RW 96,2,128
 GAZ 184,68,128
 s_waitcnt lgkmcnt(9)
 RW 98,2,3712
 GAZ 136,72,128
 s_add_u32 m0, s25, s61
 RW 100,2,14464
 GAZ 140,72,184
 RW 102,2,18048
 GAZ 196,76,184
 RW 104,2,160
 GAZ 192,76,128
 s_waitcnt lgkmcnt(9)
 RW 106,2,3744
 GAZ 144,80,128
 RW 108,2,14496
 GAZ 148,80,184
 RW 110,2,18080
 GAZ 204,84,184
 RW 112,2,192
 GAZ 200,84,128
 s_waitcnt lgkmcnt(9)
 RW 114,2,3776
 GAZ 152,88,128
 RW 116,2,14528
 GAZ 156,88,184
 RW 118,2,18112
 GAZ 212,92,184
 RW 120,2,7168
 DL 32,8,60,0
 GAZ 208,92,128
 s_waitcnt lgkmcnt(9)
 RW 122,2,10752
 GAZ 160,96,128
 RW 124,2,21504
 GAZ 164,96,184
 RW 126,2,25088
 GAZ 220,100,184
 RW 64,2,7200
 DL 33,8,60,1024
 GAZ 216,100,128
 s_waitcnt lgkmcnt(9)
 RW 66,2,10784
 GAZ 168,104,128
 RW 68,2,21536
 GAZ 172,104,184
 RW 70,2,25120
 GAZ 228,108,184
 RW 72,2,7232
 DL 34,8,60,2048
 GAZ 224,108,128
 s_waitcnt lgkmcnt(9)
 RW 74,2,10816
 GAZ 176,112,128
 RW 76,2,21568
 GAZ 180,112,184
 RW 78,2,25152
 GAZ 236,116,184
 RW 80,2,7264
 DL 35,8,60,3072
 GAZ 232,116,128
 s_waitcnt lgkmcnt(9)
 RW 82,2,10848
 s_add_u32 m0, m0, 0x1000
 GA 128,120,132
 RW 84,2,21600
 GA 132,120,188
 RW 86,2,25184
 GA 188,124,188
 RW 88,2,7296
 GA 184,124,132
 s_waitcnt lgkmcnt(9)
 RW 90,2,10880
 GA 136,64,132
 RW 92,2,21632
 GA 140,64,188
 RW 94,2,25216
 GA 196,68,188
 RW 96,2,7328
 GA 192,68,132
 s_waitcnt lgkmcnt(9)
 RW 98,2,10912
 DL 36,8,60,0
 GA 144,72,132
 RW 100,2,21664
 GA 148,72,188
 RW 102,2,25248
 GA 204,76,188
 RW 104,2,7360
 GA 200,76,132
 s_waitcnt lgkmcnt(9)
 RW 106,2,10944
 DL 37,8,60,1024
 GA 152,80,132
 RW 108,2,21696
 GA 156,80,188
 RW 110,2,25280
 v_add_u32 v2, s24, v18
 GA 212,84,188
 RW 112,2,0
 GA 208,84,132
 s_waitcnt lgkmcnt(9)
 RW 114,2,3584
 DL 38,8,60,2048
 GA 160,88,132
 s_add_u32 s60, s60, 229376
 RW 116,2,14336
 GA 164,88,188
 RW 118,2,17920
 GA 220,92,188
 RW 120,2,32
 GA 216,92,132
 s_waitcnt lgkmcnt(9)
 RW 122,2,3616
 GA 168,96,132
 RW 124,2,14368
 GA 172,96,188
 RW 126,2,17952
 GA 228,100,188
 RW 64,2,64
 GA 224,100,132
 s_waitcnt lgkmcnt(9)
 RW 66,2,3648
 GA 176,104,132
 RW 68,2,14400
 GA 180,104,188
 RW 70,2,17984
 GA 236,108,188
 RW 72,2,96
 GA 232,108,132
 RW 74,2,3680
 s_waitcnt vmcnt(27)
 s_barrier
 s_waitcnt lgkmcnt(10)
 GA 128,112,136
 s_add_u32 s25, s24, 0x18000
 RW 76,2,14432
 s_and_b32 s25, s25, 0x1ffff
 GA 132,112,192
 s_add_u32 s24, s24, 0x8000
 RW 78,2,18016
 s_and_b32 s24, s24, 0x1ffff
 GA 188,116,192
 RW 80,2,128
 GA 184,116,136
 s_waitcnt lgkmcnt(9)
 RW 82,2,3712
 GA 136,120,136
 s_add_u32 m0, s25, s61
 RW 84,2,14464
 GA 140,120,192
 RW 86,2,18048
 GA 196,124,192
 RW 88,2,160
 GA 192,124,136
 s_waitcnt lgkmcnt(9)
 RW 90,2,3744
 GA 144,64,136
 RW 92,2,14496
 GA 148,64,192
 RW 94,2,18080
 GA 204,68,192
 RW 96,2,192
 GA 200,68,136
 s_waitcnt lgkmcnt(9)
 RW 98,2,3776
 GA 152,72,136
 RW 100,2,14528
 GA 156,72,192
 RW 102,2,18112
 GA 212,76,192
 RW 104,2,7168
 DL 32,8,60,0
 GA 208,76,136
 s_waitcnt lgkmcnt(9)
 RW 106,2,10752
 GA 160,80,136
 RW 108,2,21504
 GA 164,80,192
 RW 110,2,25088
 GA 220,84,192
 RW 112,2,7200
 DL 33,8,60,1024
 GA 216,84,136
 s_waitcnt lgkmcnt(9)
 RW 114,2,10784
 GA 168,88,136
 RW 116,2,21536
 GA 172,88,192
 RW 118,2,25120
 GA 228,92,192
 RW 120,2,7232
 DL 34,8,60,2048
 GA 224,92,136
 s_waitcnt lgkmcnt(9)
 RW 122,2,10816
 GA 176,96,136
 RW 124,2,21568
 GA 180,96,192
 RW 126,2,25152
 GA 236,100,192
 RW 64,2,7264
 DL 35,8,60,3072
 GA 232,100,136
 s_waitcnt lgkmcnt(9)
 RW 66,2,10848
 s_add_u32 m0, m0, 0x1000
 GA 128,104,140
 RW 68,2,21600
 GA 132,104,196
 RW 70,2,25184
 GA 188,108,196
 RW 72,2,7296
 GA 184,108,140
 s_waitcnt lgkmcnt(9)
 RW 74,2,10880
 GA 136,112,140
 RW 76,2,21632
 GA 140,112,196
 RW 78,2,25216
 GA 196,116,196
 RW 80,2,7328
 GA 192,116,140
 s_waitcnt lgkmcnt(9)
 RW 82,2,10912
 DL 36,8,60,0
 GA 144,120,140
 RW 84,2,21664
 GA 148,120,196
 RW 86,2,25248
 GA 204,124,196
 RW 88,2,7360
 GA 200,124,140
 s_waitcnt lgkmcnt(9)
 RW 90,2,10944
 DL 37,8,60,1024
 GA 152,64,140
 RW 92,2,21696
 GA 156,64,196
 RW 94,2,25280
 v_add_u32 v2, s24, v18
 GA 212,68,196
 RW 96,2,0
 GA 208,68,140
 s_waitcnt lgkmcnt(9)
 RW 98,2,3584
 DL 38,8,60,2048
 GA 160,72,140
 s_add_u32 s60, s60, 229376
 RW 100,2,14336
 GA 164,72,196
 RW 102,2,17920
 GA 220,76,196
 RW 104,2,32
 GA 216,76,140
 s_waitcnt lgkmcnt(9)
 RW 106,2,3616
 GA 168,80,140
 RW 108,2,14368
 GA 172,80,196
 RW 110,2,17952
 GA 228,84,196
 RW 112,2,64
 GA 224,84,140
 s_waitcnt lgkmcnt(9)
 RW 114,2,3648
 GA 176,88,140
 RW 116,2,14400
 GA 180,88,196
 RW 118,2,17984
 GA 236,92,196
 RW 120,2,96
 GA 232,92,140
 RW 122,2,3680
 s_waitcnt vmcnt(7)
 s_barrier
 s_waitcnt lgkmcnt(10)
 GA 128,96,144
 s_add_u32 s25, s24, 0x18000
 RW 124,2,14432
 s_and_b32 s25, s25, 0x1ffff
 GA 132,96,200
 s_add_u32 s24, s24, 0x8000
 RW 126,2,18016
 s_and_b32 s24, s24, 0x1ffff
 GA 188,100,200
 RW 64,2,128
 GA 184,100,144
 s_waitcnt lgkmcnt(9)
 RW 66,2,3712
 GA 136,104,144
 s_add_u32 m0, s25, s61
 RW 68,2,14464
 GA 140,104,200
 RW 70,2,18048
 GA 196,108,200
 RW 72,2,160
 GA 192,108,144
 s_waitcnt lgkmcnt(9)
 RW 74,2,3744
 GA 144,112,144
 RW 76,2,14496
 GA 148,112,200
 RW 78,2,18080
 GA 204,116,200
 RW 80,2,192
 GA 200,116,144
 s_waitcnt lgkmcnt(9)
 RW 82,2,3776
 GA 152,120,144
 RW 84,2,14528
 GA 156,120,200
 RW 86,2,18112
 GA 212,124,200
 RW 88,2,7168
 DL 32,8,60,0
 GA 208,124,144
 s_waitcnt lgkmcnt(9)
 RW 90,2,10752
 GA 160,64,144
 RW 92,2,21504
 GA 164,64,200
 RW 94,2,25088
 GA 220,68,200
 RW 96,2,7200
 DL 33,8,60,1024
 GA 216,68,144
 s_waitcnt lgkmcnt(9)
 RW 98,2,10784
 GA 168,72,144
 RW 100,2,21536
 GA 172,72,200
 RW 102,2,25120
 GA 228,76,200
 RW 104,2,7232
 DL 34,8,60,2048
 GA 224,76,144
 s_waitcnt lgkmcnt(9)
 RW 106,2,10816
 GA 176,80,144
 RW 108,2,21568
 GA 180,80,200
 RW 110,2,25152
 GA 236,84,200
 RW 112,2,7264
 DL 35,8,60,3072
 GA 232,84,144
 s_waitcnt lgkmcnt(9)
 RW 114,2,10848
 s_add_u32 m0, m0, 0x1000
 GA 128,88,148
 RW 116,2,21600
 GA 132,88,204
 RW 118,2,25184
 GA 188,92,204
 RW 120,2,7296
 GA 184,92,148
 s_waitcnt lgkmcnt(9)
 RW 122,2,10880
 GA 136,96,148
 RW 124,2,21632
 GA 140,96,204
 RW 126,2,25216
 GA 196,100,204
 RW 64,2,7328
 GA 192,100,148
 s_waitcnt lgkmcnt(9)
 RW 66,2,10912
 DL 36,8,60,0
 GA 144,104,148
 RW 68,2,21664
 GA 148,104,204
 RW 70,2,25248
 GA 204,108,204
 RW 72,2,7360
 GA 200,108,148
 s_waitcnt lgkmcnt(9)
 RW 74,2,10944
 DL 37,8,60,1024
 GA 152,112,148
 RW 76,2,21696
 GA 156,112,204
 RW 78,2,25280
 v_add_u32 v2, s24, v18
 GA 212,116,204
 RW 80,2,0
 GA 208,116,148
 s_waitcnt lgkmcnt(9)
 RW 82,2,3584
 DL 38,8,60,2048
 GA 160,120,148
 s_add_u32 s60, s60, 229376
 RW 84,2,14336
 GA 164,120,204
 RW 86,2,17920
 GA 220,124,204
 RW 88,2,32
 GA 216,124,148
 s_waitcnt lgkmcnt(9)
 RW 90,2,3616
 GA 168,64,148
 RW 92,2,14368
 GA 172,64,204
 RW 94,2,17952
 GA 228,68,204
 RW 96,2,64
 GA 224,68,148
 s_waitcnt lgkmcnt(9)
 RW 98,2,3648
 GA 176,72,148
 RW 100,2,14400
 GA 180,72,204
 RW 102,2,17984
 GA 236,76,204
 RW 104,2,96
 GA 232,76,148
 RW 106,2,3680
 s_waitcnt vmcnt(7)
 s_barrier
 s_waitcnt lgkmcnt(10)
 GA 128,80,152
 s_add_u32 s25, s24, 0x18000
 RW 108,2,14432
 s_and_b32 s25, s25, 0x1ffff
 GA 132,80,208
 s_add_u32 s24, s24, 0x8000
 RW 110,2,18016
 s_and_b32 s24, s24, 0x1ffff
 GA 188,84,208
 RW 112,2,128
 GA 184,84,152
 s_waitcnt lgkmcnt(9)
 RW 114,2,3712
 GA 136,88,152
 s_add_u32 m0, s25, s61
 RW 116,2,14464
 GA 140,88,208
 RW 118,2,18048
 GA 196,92,208
 RW 120,2,160
 GA 192,92,152
 s_waitcnt lgkmcnt(9)
 RW 122,2,3744
 GA 144,96,152
 RW 124,2,14496
 GA 148,96,208
 RW 126,2,18080
 GA 204,100,208
 RW 64,2,192
 GA 200,100,152
 s_waitcnt lgkmcnt(9)
 RW 66,2,3776
 GA 152,104,152
 RW 68,2,14528
 GA 156,104,208
 RW 70,2,18112
 GA 212,108,208
 RW 72,2,7168
 DL 32,8,60,0
 GA 208,108,152
 s_waitcnt lgkmcnt(9)
 RW 74,2,10752
 GA 160,112,152
 RW 76,2,21504
 GA 164,112,208
 RW 78,2,25088
 GA 220,116,208
 RW 80,2,7200
 DL 33,8,60,1024
 GA 216,116,152
 s_waitcnt lgkmcnt(9)
 RW 82,2,10784
 GA 168,120,152
 RW 84,2,21536
 GA 172,120,208
 RW 86,2,25120
 GA 228,124,208
 RW 88,2,7232
 DL 34,8,60,2048
 GA 224,124,152
 s_waitcnt lgkmcnt(9)
 RW 90,2,10816
 GA 176,64,152
 RW 92,2,21568
 GA 180,64,208
 RW 94,2,25152
 GA 236,68,208
 RW 96,2,7264
 DL 35,8,60,3072
 GA 232,68,152
 s_waitcnt lgkmcnt(9)
 RW 98,2,10848
 s_add_u32 m0, m0, 0x1000
 GA 128,72,156
 RW 100,2,21600
 GA 132,72,212
 RW 102,2,25184
 GA 188,76,212
 RW 104,2,7296
 GA 184,76,156
 s_waitcnt lgkmcnt(9)
 RW 106,2,10880
 GA 136,80,156
 RW 108,2,21632
 GA 140,80,212
 RW 110,2,25216
 GA 196,84,212
 RW 112,2,7328
 GA 192,84,156
 s_waitcnt lgkmcnt(9)
 RW 114,2,10912
 DL 36,8,60,0
 GA 144,88,156
 RW 116,2,21664
 GA 148,88,212
 RW 118,2,25248
 GA 204,92,212
 RW 120,2,7360
 GA 200,92,156
 s_waitcnt lgkmcnt(9)
 RW 122,2,10944
 DL 37,8,60,1024
 GA 152,96,156
 RW 124,2,21696
 GA 156,96,212
 RW 126,2,25280
 v_add_u32 v2, s24, v18
 GA 212,100,212
 RW 64,2,0
 GA 208,100,156
 s_waitcnt lgkmcnt(9)
 RW 66,2,3584
 DL 38,8,60,2048
 GA 160,104,156
 s_add_u32 s60, s60, 229376
 RW 68,2,14336
 GA 164,104,212
 RW 70,2,17920
 GA 220,108,212
 RW 72,2,32
 GA 216,108,156
 s_waitcnt lgkmcnt(9)
 RW 74,2,3616
 GA 168,112,156
 RW 76,2,14368
 GA 172,112,212
 RW 78,2,17952
 GA 228,116,212
 RW 80,2,64
 GA 224,116,156
 s_waitcnt lgkmcnt(9)
 RW 82,2,3648
 GA 176,120,156
 RW 84,2,14400
 GA 180,120,212
 RW 86,2,17984
 GA 236,124,212
 RW 88,2,96
 GA 232,124,156
 RW 90,2,3680
 s_waitcnt vmcnt(7)
 s_barrier
 s_waitcnt lgkmcnt(10)
 GA 128,64,160
 s_add_u32 s25, s24, 0x18000
 RW 92,2,14432
 s_and_b32 s25, s25, 0x1ffff
 GA 132,64,216
 s_add_u32 s24, s24, 0x8000
 RW 94,2,18016
 s_and_b32 s24, s24, 0x1ffff
 GA 188,68,216
 RW 96,2,128
 GA 184,68,160
 s_waitcnt lgkmcnt(9)
 RW 98,2,3712
 GA 136,72,160
 s_add_u32 m0, s25, s61
 RW 100,2,14464
 GA 140,72,216
 RW 102,2,18048
 GA 196,76,216
 RW 104,2,160
 GA 192,76,160
 s_waitcnt lgkmcnt(9)
 RW 106,2,3744
 GA 144,80,160
 s_add_u32 s41, s62, 28672
 RW 108,2,14496
 GA 148,80,216
 RW 110,2,18080
 GA 204,84,216
 RW 112,2,192
 GA 200,84,160
 s_waitcnt lgkmcnt(9)
 RW 114,2,3776
 GA 152,88,160
 RW 116,2,14528
 GA 156,88,216
 RW 118,2,18112
 GA 212,92,216
 RW 120,2,7168
 GA 208,92,160
 s_waitcnt lgkmcnt(9)
 RW 122,2,10752
 GA 160,96,160
 RW 124,2,21504
 GA 164,96,216
 RW 126,2,25088
 GA 220,100,216
 RW 64,2,7200
 DL 19,12,62,0
 GA 216,100,160
 s_waitcnt lgkmcnt(9)
 RW 66,2,10784
 GA 168,104,160
 RW 68,2,21536
 GA 172,104,216
 RW 70,2,25120
 GA 228,108,216
 RW 72,2,7232
 DL 20,12,62,1024
 GA 224,108,160
 s_waitcnt lgkmcnt(9)
 RW 74,2,10816
 GA 176,112,160
 RW 76,2,21568
 GA 180,112,216
 RW 78,2,25152
 GA 236,116,216
 RW 80,2,7264
 DL 21,12,62,2048
 GA 232,116,160
 s_waitcnt lgkmcnt(9)
 RW 82,2,10848
 GA 128,120,164
 RW 84,2,21600
 GA 132,120,220
 RW 86,2,25184
 GA 188,124,220
 RW 88,2,7296
 GA 184,124,164
 s_waitcnt lgkmcnt(9)
 RW 90,2,10880
 DL 22,12,62,3072
 GA 136,64,164
 s_add_u32 m0, m0, 0x1000
 RW 92,2,21632
 GA 140,64,220
 RW 94,2,25216
 GA 196,68,220
 RW 96,2,7328
 GA 192,68,164
 s_waitcnt lgkmcnt(9)
 RW 98,2,10912
 GA 144,72,164
 RW 100,2,21664
 GA 148,72,220
 RW 102,2,25248
 GA 204,76,220
 RW 104,2,7360
 GA 200,76,164
 s_waitcnt lgkmcnt(9)
 RW 106,2,10944
 DL 19,12,41,0
 GA 152,80,164
 RW 108,2,21696
 GA 156,80,220
 RW 110,2,25280
 v_add_u32 v2, s24, v18
 GA 212,84,220
 RW 112,2,0
 GA 208,84,164
 s_waitcnt lgkmcnt(9)
 RW 114,2,3584
 DL 20,12,41,1024
 GA 160,88,164
 RW 116,2,14336
 GA 164,88,220
 RW 118,2,17920
 GA 220,92,220
 RW 120,2,32
 GA 216,92,164
 s_waitcnt lgkmcnt(9)
 RW 122,2,3616
 DL 21,12,41,2048
 GA 168,96,164
 s_add_u32 s62, s62, 256
 RW 124,2,14368
 GA 172,96,220
 RW 126,2,17952
 GA 228,100,220
 RW 64,2,64
 GA 224,100,164
 s_waitcnt lgkmcnt(9)
 RW 66,2,3648
 GA 176,104,164
 RW 68,2,14400
 GA 180,104,220
 RW 70,2,17984
 GA 236,108,220
 RW 72,2,96
 GA 232,108,164
 RW 74,2,3680
 s_waitcnt vmcnt(7)
 s_barrier
 s_waitcnt lgkmcnt(10)
 GA 128,112,168
 s_add_u32 s25, s24, 0x18000
 RW 76,2,14432
 s_and_b32 s25, s25, 0x1ffff
 GA 132,112,224
 s_add_u32 s24, s24, 0x8000
 RW 78,2,18016
 s_and_b32 s24, s24, 0x1ffff
 GA 188,116,224
 RW 80,2,128
 GA 184,116,168
 s_waitcnt lgkmcnt(9)
 RW 82,2,3712
 GA 136,120,168
 s_add_u32 m0, s25, s61
 RW 84,2,14464
 GA 140,120,224
 RW 86,2,18048
 GA 196,124,224
 RW 88,2,160
 GA 192,124,168
 s_waitcnt lgkmcnt(9)
 RW 90,2,3744
 GA 144,64,168
 s_add_u32 s41, s62, 28672
 RW 92,2,14496
 GA 148,64,224
 RW 94,2,18080
 GA 204,68,224
 RW 96,2,192
 GA 200,68,168
 s_waitcnt lgkmcnt(9)
 RW 98,2,3776
 GA 152,72,168
 RW 100,2,14528
 GA 156,72,224
 RW 102,2,18112
 GA 212,76,224
 RW 104,2,7168
 GA 208,76,168
 s_waitcnt lgkmcnt(9)
 RW 106,2,10752
 GA 160,80,168
 RW 108,2,21504
 GA 164,80,224
 RW 110,2,25088
 GA 220,84,224
 RW 112,2,7200
 DL 19,12,62,0
 GA 216,84,168
 s_waitcnt lgkmcnt(9)
 RW 114,2,10784
 GA 168,88,168
 RW 116,2,21536
 GA 172,88,224
 RW 118,2,25120
 GA 228,92,224
 RW 120,2,7232
 DL 20,12,62,1024
 GA 224,92,168
 s_waitcnt lgkmcnt(9)
 RW 122,2,10816
 GA 176,96,168
 RW 124,2,21568
 GA 180,96,224
 RW 126,2,25152
 GA 236,100,224
 RW 64,2,7264
 DL 21,12,62,2048
 GA 232,100,168
 s_waitcnt lgkmcnt(9)
 RW 66,2,10848
 GA 128,104,172
 RW 68,2,21600
 GA 132,104,228
 RW 70,2,25184
 GA 188,108,228
 RW 72,2,7296
 GA 184,108,172
 s_waitcnt lgkmcnt(9)
 RW 74,2,10880
 DL 22,12,62,3072
 GA 136,112,172
 s_add_u32 m0, m0, 0x1000
 RW 76,2,21632
 GA 140,112,228
 RW 78,2,25216
 GA 196,116,228
 RW 80,2,7328
 GA 192,116,172
 s_waitcnt lgkmcnt(9)
 RW 82,2,10912
 GA 144,120,172
 RW 84,2,21664
 GA 148,120,228
 RW 86,2,25248
 GA 204,124,228
 RW 88,2,7360
 GA 200,124,172
 s_waitcnt lgkmcnt(9)
 RW 90,2,10944
 DL 19,12,41,0
 GA 152,64,172
 RW 92,2,21696
 GA 156,64,228
 RW 94,2,25280
 v_add_u32 v2, s24, v18
 GA 212,68,228
 RW 96,2,0
 GA 208,68,172
 s_waitcnt lgkmcnt(9)
 RW 98,2,3584
 DL 20,12,41,1024
 GA 160,72,172
 RW 100,2,14336
 GA 164,72,228
 RW 102,2,17920
 GA 220,76,228
 RW 104,2,32
 GA 216,76,172
 s_waitcnt lgkmcnt(9)
 RW 106,2,3616
 DL 21,12,41,2048
 GA 168,80,172
 s_add_u32 s62, s62, 256
 RW 108,2,14368
 GA 172,80,228
 RW 110,2,17952
 GA 228,84,228
 RW 112,2,64
 GA 224,84,172
 s_waitcnt lgkmcnt(9)
 RW 114,2,3648
 GA 176,88,172
 RW 116,2,14400
 GA 180,88,228
 RW 118,2,17984
 GA 236,92,228
 RW 120,2,96
 GA 232,92,172
 RW 122,2,3680
 s_waitcnt vmcnt(7)
 s_barrier
 s_waitcnt lgkmcnt(10)
 GA 128,96,176
 s_add_u32 s25, s24, 0x18000
 RW 124,2,14432
 s_and_b32 s25, s25, 0x1ffff
 GA 132,96,232
 s_add_u32 s24, s24, 0x8000
 RW 126,2,18016
 s_and_b32 s24, s24, 0x1ffff
 GA 188,100,232
 RW 64,2,128
 GA 184,100,176
 s_waitcnt lgkmcnt(9)
 RW 66,2,3712
 GA 136,104,176
 s_add_u32 m0, s25, s61
 RW 68,2,14464
 GA 140,104,232
 RW 70,2,18048
 GA 196,108,232
 RW 72,2,160
 GA 192,108,176
 s_waitcnt lgkmcnt(9)
 RW 74,2,3744
 GA 144,112,176
 s_add_u32 s41, s62, 28672
 RW 76,2,14496
 GA 148,112,232
 RW 78,2,18080
 GA 204,116,232
 RW 80,2,192
 GA 200,116,176
 s_waitcnt lgkmcnt(9)
 RW 82,2,3776
 GA 152,120,176
 RW 84,2,14528
 GA 156,120,232
 RW 86,2,18112
 GA 212,124,232
 RW 88,2,7168
 GA 208,124,176
 s_waitcnt lgkmcnt(9)
 RW 90,2,10752
 GA 160,64,176
 RW 92,2,21504
 GA 164,64,232
 RW 94,2,25088
 GA 220,68,232
 RW 96,2,7200
 DL 19,12,62,0
 GA 216,68,176
 s_waitcnt lgkmcnt(9)
 RW 98,2,10784
 GA 168,72,176
 RW 100,2,21536
 GA 172,72,232
 RW 102,2,25120
 GA 228,76,232
 RW 104,2,7232
 DL 20,12,62,1024
 GA 224,76,176
 s_waitcnt lgkmcnt(9)
 RW 106,2,10816
 GA 176,80,176
 RW 108,2,21568
 GA 180,80,232
 RW 110,2,25152
 GA 236,84,232
 RW 112,2,7264
 DL 21,12,62,2048
 GA 232,84,176
 s_waitcnt lgkmcnt(9)
 RW 114,2,10848
 GA 128,88,180
 RW 116,2,21600
 GA 132,88,236
 RW 118,2,25184
 GA 188,92,236
 RW 120,2,7296
 GA 184,92,180
 s_waitcnt lgkmcnt(9)
 RW 122,2,10880
 DL 22,12,62,3072
 GA 136,96,180
 s_add_u32 m0, m0, 0x1000
 RW 124,2,21632
 GA 140,96,236
 RW 126,2,25216
 GA 196,100,236
 RW 64,2,7328
 GA 192,100,180
 s_waitcnt lgkmcnt(9)
 RW 66,2,10912
 GA 144,104,180
 RW 68,2,21664
 GA 148,104,236
 RW 70,2,25248
 GA 204,108,236
 RW 72,2,7360
 GA 200,108,180
 s_waitcnt lgkmcnt(9)
 RW 74,2,10944
 DL 19,12,41,0
 GA 152,112,180
 RW 76,2,21696
 GA 156,112,236
 RW 78,2,25280
 v_add_u32 v3, s24, v7
 GA 212,116,236
 v_add_u32 v4, s24, v8
 v_add_u32 v5, s24, v9
 v_add_u32 v6, s24, v10
 RW 80,3,0
 GA 208,116,180
 s_waitcnt lgkmcnt(9)
 RW 82,3,2048
 DL 20,12,41,1024
 GA 160,120,180
 RW 84,4,0
 GA 164,120,236
 RW 86,4,2048
 GA 220,124,236
 RW 88,5,0
 GA 216,124,180
 s_waitcnt lgkmcnt(9)
 RW 90,5,2048
 DL 21,12,41,2048
 GA 168,64,180
 s_add_u32 s62, s62, 256
 RW 92,6,0
 GA 172,64,236
 RW 94,6,2048
 GA 228,68,236
 RW 96,3,4096
 GA 224,68,180
 s_waitcnt lgkmcnt(9)
 RW 98,3,6144
 GA 176,72,180
 RW 100,4,4096
 GA 180,72,236
 RW 102,4,6144
 GA 236,76,236
 RW 104,5,4096
 GA 232,76,180
 RW 106,5,6144
 v_mov_b32 v60, 0xc0135761
 v_mov_b32 v61, 0xbdd2d3e8
 v_mov_b32 v72, 0xc0135761
 v_mov_b32 v73, 0xc0135761
 v_mov_b32 v74, 0xbdd2d3e8
 v_mov_b32 v75, 0xbdd2d3e8
 v_mov_b32 v76, 0x3f800000
 v_mov_b32 v77, 0x3f800000
 s_nop 5
 v_pk_mul_f32 v[64:65], v[128:129], v[128:129]
 v_pk_mul_f32 v[66:67], v[130:131], v[130:131]
 v_pk_fma_f32 v[64:65], v[64:65], v[74:75], v[72:73]
 v_pk_fma_f32 v[66:67], v[66:67], v[74:75], v[72:73]
 v_pk_mul_f32 v[64:65], v[64:65], v[128:129]
 v_pk_mul_f32 v[66:67], v[66:67], v[130:131]
 v_exp_f32 v64, v64
 v_exp_f32 v65, v65
 v_exp_f32 v66, v66
 v_exp_f32 v67, v67
 v_pk_mul_f32 v[128:129], v[128:129], v[184:185]
 v_pk_mul_f32 v[130:131], v[130:131], v[186:187]
 s_nop 0
 v_pk_add_f32 v[64:65], v[64:65], v[76:77]
 v_pk_add_f32 v[66:67], v[66:67], v[76:77]
 v_rcp_f32 v64, v64
 v_rcp_f32 v65, v65
 v_rcp_f32 v66, v66
 v_rcp_f32 v67, v67
 s_nop 0
 v_pk_mul_f32 v[128:129], v[128:129], v[64:65]
 v_pk_mul_f32 v[130:131], v[130:131], v[66:67]
 v_cvt_pk_bf16_f32 v32, v128, v129
 v_cvt_pk_bf16_f32 v33, v130, v131
 v_pk_mul_f32 v[68:69], v[132:133], v[132:133]
 v_pk_mul_f32 v[70:71], v[134:135], v[134:135]
 v_pk_fma_f32 v[68:69], v[68:69], v[74:75], v[72:73]
 v_pk_fma_f32 v[70:71], v[70:71], v[74:75], v[72:73]
 v_pk_mul_f32 v[68:69], v[68:69], v[132:133]
 v_pk_mul_f32 v[70:71], v[70:71], v[134:135]
 v_exp_f32 v68, v68
 v_exp_f32 v69, v69
 v_exp_f32 v70, v70
 v_exp_f32 v71, v71
 v_pk_mul_f32 v[132:133], v[132:133], v[188:189]
 v_pk_mul_f32 v[134:135], v[134:135], v[190:191]
 s_nop 0
 v_pk_add_f32 v[68:69], v[68:69], v[76:77]
 v_pk_add_f32 v[70:71], v[70:71], v[76:77]
 v_rcp_f32 v68, v68
 v_rcp_f32 v69, v69
 v_rcp_f32 v70, v70
 v_rcp_f32 v71, v71
 s_nop 0
 v_pk_mul_f32 v[132:133], v[132:133], v[68:69]
 v_pk_mul_f32 v[134:135], v[134:135], v[70:71]
 v_cvt_pk_bf16_f32 v46, v132, v133
 v_cvt_pk_bf16_f32 v47, v134, v135
 v_pk_mul_f32 v[64:65], v[136:137], v[136:137]
 v_pk_mul_f32 v[66:67], v[138:139], v[138:139]
 v_pk_fma_f32 v[64:65], v[64:65], v[74:75], v[72:73]
 v_pk_fma_f32 v[66:67], v[66:67], v[74:75], v[72:73]
 v_pk_mul_f32 v[64:65], v[64:65], v[136:137]
 v_pk_mul_f32 v[66:67], v[66:67], v[138:139]
 v_exp_f32 v64, v64
 v_exp_f32 v65, v65
 v_exp_f32 v66, v66
 v_exp_f32 v67, v67
 v_pk_mul_f32 v[136:137], v[136:137], v[192:193]
 v_pk_mul_f32 v[138:139], v[138:139], v[194:195]
 s_nop 0
 v_pk_add_f32 v[64:65], v[64:65], v[76:77]
 v_pk_add_f32 v[66:67], v[66:67], v[76:77]
 v_rcp_f32 v64, v64
 v_rcp_f32 v65, v65
 v_rcp_f32 v66, v66
 v_rcp_f32 v67, v67
 s_nop 0
 v_pk_mul_f32 v[136:137], v[136:137], v[64:65]
 v_pk_mul_f32 v[138:139], v[138:139], v[66:67]
 v_cvt_pk_bf16_f32 v34, v136, v137
 v_cvt_pk_bf16_f32 v35, v138, v139
 v_pk_mul_f32 v[68:69], v[140:141], v[140:141]
 v_pk_mul_f32 v[70:71], v[142:143], v[142:143]
 v_pk_fma_f32 v[68:69], v[68:69], v[74:75], v[72:73]
 v_pk_fma_f32 v[70:71], v[70:71], v[74:75], v[72:73]
 v_pk_mul_f32 v[68:69], v[68:69], v[140:141]
 v_pk_mul_f32 v[70:71], v[70:71], v[142:143]
 v_exp_f32 v68, v68
 v_exp_f32 v69, v69
 v_exp_f32 v70, v70
 v_exp_f32 v71, v71
 v_pk_mul_f32 v[140:141], v[140:141], v[196:197]
 v_pk_mul_f32 v[142:143], v[142:143], v[198:199]
 s_nop 0
 v_pk_add_f32 v[68:69], v[68:69], v[76:77]
 v_pk_add_f32 v[70:71], v[70:71], v[76:77]
 v_rcp_f32 v68, v68
 v_rcp_f32 v69, v69
 v_rcp_f32 v70, v70
 v_rcp_f32 v71, v71
 s_nop 0
 v_pk_mul_f32 v[140:141], v[140:141], v[68:69]
 v_pk_mul_f32 v[142:143], v[142:143], v[70:71]
 v_cvt_pk_bf16_f32 v48, v140, v141
 v_cvt_pk_bf16_f32 v49, v142, v143
 v_pk_mul_f32 v[64:65], v[144:145], v[144:145]
 v_pk_mul_f32 v[66:67], v[146:147], v[146:147]
 v_pk_fma_f32 v[64:65], v[64:65], v[74:75], v[72:73]
 v_pk_fma_f32 v[66:67], v[66:67], v[74:75], v[72:73]
 v_pk_mul_f32 v[64:65], v[64:65], v[144:145]
 v_pk_mul_f32 v[66:67], v[66:67], v[146:147]
 v_exp_f32 v64, v64
 v_exp_f32 v65, v65
 v_exp_f32 v66, v66
 v_exp_f32 v67, v67
 v_pk_mul_f32 v[144:145], v[144:145], v[200:201]
 v_pk_mul_f32 v[146:147], v[146:147], v[202:203]
 s_nop 0
 v_pk_add_f32 v[64:65], v[64:65], v[76:77]
 v_pk_add_f32 v[66:67], v[66:67], v[76:77]
 v_rcp_f32 v64, v64
 v_rcp_f32 v65, v65
 v_rcp_f32 v66, v66
 v_rcp_f32 v67, v67
 s_nop 0
 v_pk_mul_f32 v[144:145], v[144:145], v[64:65]
 v_pk_mul_f32 v[146:147], v[146:147], v[66:67]
 v_cvt_pk_bf16_f32 v36, v144, v145
 v_cvt_pk_bf16_f32 v37, v146, v147
 v_pk_mul_f32 v[68:69], v[148:149], v[148:149]
 v_pk_mul_f32 v[70:71], v[150:151], v[150:151]
 v_pk_fma_f32 v[68:69], v[68:69], v[74:75], v[72:73]
 v_pk_fma_f32 v[70:71], v[70:71], v[74:75], v[72:73]
 v_pk_mul_f32 v[68:69], v[68:69], v[148:149]
 v_pk_mul_f32 v[70:71], v[70:71], v[150:151]
 v_exp_f32 v68, v68
 v_exp_f32 v69, v69
 v_exp_f32 v70, v70
 v_exp_f32 v71, v71
 v_pk_mul_f32 v[148:149], v[148:149], v[204:205]
 v_pk_mul_f32 v[150:151], v[150:151], v[206:207]
 s_nop 0
 v_pk_add_f32 v[68:69], v[68:69], v[76:77]
 v_pk_add_f32 v[70:71], v[70:71], v[76:77]
 v_rcp_f32 v68, v68
 v_rcp_f32 v69, v69
 v_rcp_f32 v70, v70
 v_rcp_f32 v71, v71
 s_nop 0
 v_pk_mul_f32 v[148:149], v[148:149], v[68:69]
 v_pk_mul_f32 v[150:151], v[150:151], v[70:71]
 v_cvt_pk_bf16_f32 v50, v148, v149
 v_cvt_pk_bf16_f32 v51, v150, v151
 v_pk_mul_f32 v[64:65], v[152:153], v[152:153]
 v_pk_mul_f32 v[66:67], v[154:155], v[154:155]
 v_pk_fma_f32 v[64:65], v[64:65], v[74:75], v[72:73]
 v_pk_fma_f32 v[66:67], v[66:67], v[74:75], v[72:73]
 v_pk_mul_f32 v[64:65], v[64:65], v[152:153]
 v_pk_mul_f32 v[66:67], v[66:67], v[154:155]
 v_exp_f32 v64, v64
 v_exp_f32 v65, v65
 v_exp_f32 v66, v66
 v_exp_f32 v67, v67
 v_pk_mul_f32 v[152:153], v[152:153], v[208:209]
 v_pk_mul_f32 v[154:155], v[154:155], v[210:211]
 s_nop 0
 v_pk_add_f32 v[64:65], v[64:65], v[76:77]
 v_pk_add_f32 v[66:67], v[66:67], v[76:77]
 v_rcp_f32 v64, v64
 v_rcp_f32 v65, v65
 v_rcp_f32 v66, v66
 v_rcp_f32 v67, v67
 s_nop 0
 v_pk_mul_f32 v[152:153], v[152:153], v[64:65]
 v_pk_mul_f32 v[154:155], v[154:155], v[66:67]
 v_cvt_pk_bf16_f32 v38, v152, v153
 v_cvt_pk_bf16_f32 v39, v154, v155
 v_pk_mul_f32 v[68:69], v[156:157], v[156:157]
 v_pk_mul_f32 v[70:71], v[158:159], v[158:159]
 v_pk_fma_f32 v[68:69], v[68:69], v[74:75], v[72:73]
 v_pk_fma_f32 v[70:71], v[70:71], v[74:75], v[72:73]
 v_pk_mul_f32 v[68:69], v[68:69], v[156:157]
 v_pk_mul_f32 v[70:71], v[70:71], v[158:159]
 v_exp_f32 v68, v68
 v_exp_f32 v69, v69
 v_exp_f32 v70, v70
 v_exp_f32 v71, v71
 v_pk_mul_f32 v[156:157], v[156:157], v[212:213]
 v_pk_mul_f32 v[158:159], v[158:159], v[214:215]
 s_nop 0
 v_pk_add_f32 v[68:69], v[68:69], v[76:77]
 v_pk_add_f32 v[70:71], v[70:71], v[76:77]
 v_rcp_f32 v68, v68
 v_rcp_f32 v69, v69
 v_rcp_f32 v70, v70
 v_rcp_f32 v71, v71
 s_nop 0
 v_pk_mul_f32 v[156:157], v[156:157], v[68:69]
 v_pk_mul_f32 v[158:159], v[158:159], v[70:71]
 v_cvt_pk_bf16_f32 v52, v156, v157
 v_cvt_pk_bf16_f32 v53, v158, v159
 v_pk_mul_f32 v[64:65], v[160:161], v[160:161]
 v_pk_mul_f32 v[66:67], v[162:163], v[162:163]
 v_pk_fma_f32 v[64:65], v[64:65], v[74:75], v[72:73]
 v_pk_fma_f32 v[66:67], v[66:67], v[74:75], v[72:73]
 v_pk_mul_f32 v[64:65], v[64:65], v[160:161]
 v_pk_mul_f32 v[66:67], v[66:67], v[162:163]
 v_exp_f32 v64, v64
 v_exp_f32 v65, v65
 v_exp_f32 v66, v66
 v_exp_f32 v67, v67
 v_pk_mul_f32 v[160:161], v[160:161], v[216:217]
 v_pk_mul_f32 v[162:163], v[162:163], v[218:219]
 s_nop 0
 v_pk_add_f32 v[64:65], v[64:65], v[76:77]
 v_pk_add_f32 v[66:67], v[66:67], v[76:77]
 v_rcp_f32 v64, v64
 v_rcp_f32 v65, v65
 v_rcp_f32 v66, v66
 v_rcp_f32 v67, v67
 s_nop 0
 v_pk_mul_f32 v[160:161], v[160:161], v[64:65]
 v_pk_mul_f32 v[162:163], v[162:163], v[66:67]
 v_cvt_pk_bf16_f32 v40, v160, v161
 v_cvt_pk_bf16_f32 v41, v162, v163
 v_pk_mul_f32 v[68:69], v[164:165], v[164:165]
 v_pk_mul_f32 v[70:71], v[166:167], v[166:167]
 v_pk_fma_f32 v[68:69], v[68:69], v[74:75], v[72:73]
 v_pk_fma_f32 v[70:71], v[70:71], v[74:75], v[72:73]
 v_pk_mul_f32 v[68:69], v[68:69], v[164:165]
 v_pk_mul_f32 v[70:71], v[70:71], v[166:167]
 v_exp_f32 v68, v68
 v_exp_f32 v69, v69
 v_exp_f32 v70, v70
 v_exp_f32 v71, v71
 v_pk_mul_f32 v[164:165], v[164:165], v[220:221]
 v_pk_mul_f32 v[166:167], v[166:167], v[222:223]
 s_nop 0
 v_pk_add_f32 v[68:69], v[68:69], v[76:77]
 v_pk_add_f32 v[70:71], v[70:71], v[76:77]
 v_rcp_f32 v68, v68
 v_rcp_f32 v69, v69
 v_rcp_f32 v70, v70
 v_rcp_f32 v71, v71
 s_nop 0
 v_pk_mul_f32 v[164:165], v[164:165], v[68:69]
 v_pk_mul_f32 v[166:167], v[166:167], v[70:71]
 v_cvt_pk_bf16_f32 v54, v164, v165
 v_cvt_pk_bf16_f32 v55, v166, v167
 v_pk_mul_f32 v[64:65], v[168:169], v[168:169]
 v_pk_mul_f32 v[66:67], v[170:171], v[170:171]
 v_pk_fma_f32 v[64:65], v[64:65], v[74:75], v[72:73]
 v_pk_fma_f32 v[66:67], v[66:67], v[74:75], v[72:73]
 v_pk_mul_f32 v[64:65], v[64:65], v[168:169]
 v_pk_mul_f32 v[66:67], v[66:67], v[170:171]
 v_exp_f32 v64, v64
 v_exp_f32 v65, v65
 v_exp_f32 v66, v66
 v_exp_f32 v67, v67
 v_pk_mul_f32 v[168:169], v[168:169], v[224:225]
 v_pk_mul_f32 v[170:171], v[170:171], v[226:227]
 s_nop 0
 v_pk_add_f32 v[64:65], v[64:65], v[76:77]
 v_pk_add_f32 v[66:67], v[66:67], v[76:77]
 v_rcp_f32 v64, v64
 v_rcp_f32 v65, v65
 v_rcp_f32 v66, v66
 v_rcp_f32 v67, v67
 s_nop 0
 v_pk_mul_f32 v[168:169], v[168:169], v[64:65]
 v_pk_mul_f32 v[170:171], v[170:171], v[66:67]
 v_cvt_pk_bf16_f32 v42, v168, v169
 v_cvt_pk_bf16_f32 v43, v170, v171
 v_pk_mul_f32 v[68:69], v[172:173], v[172:173]
 v_pk_mul_f32 v[70:71], v[174:175], v[174:175]
 v_pk_fma_f32 v[68:69], v[68:69], v[74:75], v[72:73]
 v_pk_fma_f32 v[70:71], v[70:71], v[74:75], v[72:73]
 v_pk_mul_f32 v[68:69], v[68:69], v[172:173]
 v_pk_mul_f32 v[70:71], v[70:71], v[174:175]
 v_exp_f32 v68, v68
 v_exp_f32 v69, v69
 v_exp_f32 v70, v70
 v_exp_f32 v71, v71
 v_pk_mul_f32 v[172:173], v[172:173], v[228:229]
 v_pk_mul_f32 v[174:175], v[174:175], v[230:231]
 s_nop 0
 v_pk_add_f32 v[68:69], v[68:69], v[76:77]
 v_pk_add_f32 v[70:71], v[70:71], v[76:77]
 v_rcp_f32 v68, v68
 v_rcp_f32 v69, v69
 v_rcp_f32 v70, v70
 v_rcp_f32 v71, v71
 s_nop 0
 v_pk_mul_f32 v[172:173], v[172:173], v[68:69]
 v_pk_mul_f32 v[174:175], v[174:175], v[70:71]
 v_cvt_pk_bf16_f32 v56, v172, v173
 v_cvt_pk_bf16_f32 v57, v174, v175
 v_pk_mul_f32 v[64:65], v[176:177], v[176:177]
 v_pk_mul_f32 v[66:67], v[178:179], v[178:179]
 v_pk_fma_f32 v[64:65], v[64:65], v[74:75], v[72:73]
 v_pk_fma_f32 v[66:67], v[66:67], v[74:75], v[72:73]
 v_pk_mul_f32 v[64:65], v[64:65], v[176:177]
 v_pk_mul_f32 v[66:67], v[66:67], v[178:179]
 v_exp_f32 v64, v64
 v_exp_f32 v65, v65
 v_exp_f32 v66, v66
 v_exp_f32 v67, v67
 v_pk_mul_f32 v[176:177], v[176:177], v[232:233]
 v_pk_mul_f32 v[178:179], v[178:179], v[234:235]
 s_nop 0
 v_pk_add_f32 v[64:65], v[64:65], v[76:77]
 v_pk_add_f32 v[66:67], v[66:67], v[76:77]
 v_rcp_f32 v64, v64
 v_rcp_f32 v65, v65
 v_rcp_f32 v66, v66
 v_rcp_f32 v67, v67
 s_nop 0
 v_pk_mul_f32 v[176:177], v[176:177], v[64:65]
 v_pk_mul_f32 v[178:179], v[178:179], v[66:67]
 v_cvt_pk_bf16_f32 v44, v176, v177
 v_cvt_pk_bf16_f32 v45, v178, v179
 v_pk_mul_f32 v[68:69], v[180:181], v[180:181]
 v_pk_mul_f32 v[70:71], v[182:183], v[182:183]
 v_pk_fma_f32 v[68:69], v[68:69], v[74:75], v[72:73]
 v_pk_fma_f32 v[70:71], v[70:71], v[74:75], v[72:73]
 v_pk_mul_f32 v[68:69], v[68:69], v[180:181]
 v_pk_mul_f32 v[70:71], v[70:71], v[182:183]
 v_exp_f32 v68, v68
 v_exp_f32 v69, v69
 v_exp_f32 v70, v70
 v_exp_f32 v71, v71
 v_pk_mul_f32 v[180:181], v[180:181], v[236:237]
 v_pk_mul_f32 v[182:183], v[182:183], v[238:239]
 s_nop 0
 v_pk_add_f32 v[68:69], v[68:69], v[76:77]
 v_pk_add_f32 v[70:71], v[70:71], v[76:77]
 v_rcp_f32 v68, v68
 v_rcp_f32 v69, v69
 v_rcp_f32 v70, v70
 v_rcp_f32 v71, v71
 s_nop 0
 v_pk_mul_f32 v[180:181], v[180:181], v[68:69]
 v_pk_mul_f32 v[182:183], v[182:183], v[70:71]
 v_cvt_pk_bf16_f32 v58, v180, v181
 v_cvt_pk_bf16_f32 v59, v182, v183
 s_nop 1
 s_waitcnt vmcnt(7)
 s_barrier
 s_waitcnt lgkmcnt(10)
 PVZ 64,80,32
 s_add_u32 s25, s24, 0x18000
 RW 108,6,4096
 s_and_b32 s25, s25, 0x1ffff
 PVZ 68,80,46
 s_add_u32 s24, s24, 0x8000
 RW 110,6,6144
 s_and_b32 s24, s24, 0x1ffff
 PVZ 76,84,46
 RW 112,3,8192
 PVZ 72,84,32
 s_waitcnt lgkmcnt(9)
 RW 114,3,10240
 PVZ 80,88,32
 s_add_u32 m0, s25, s61
 RW 116,4,8192
 PVZ 84,88,46
 RW 118,4,10240
 PVZ 92,92,46
 RW 120,5,8192
 PVZ 88,92,32
 s_waitcnt lgkmcnt(9)
 RW 122,5,10240
 PV 64,96,36
 s_add_u32 s41, s62, 28672
 RW 124,6,8192
 PV 68,96,50
 RW 126,6,10240
 PV 76,100,50
 RW 64,3,12288
 PV 72,100,36
 s_waitcnt lgkmcnt(9)
 PV 80,104,36
 RW 68,4,12288
 PV 84,104,50
 DL 19,12,62,0
 PV 92,108,50
 RW 72,5,12288
 PV 88,108,36
 s_waitcnt lgkmcnt(7)
 PV 64,112,40
 RW 76,6,12288
 PV 68,112,54
 DL 20,12,62,1024
 PV 76,116,54
 RW 80,3,14336
 PV 72,116,40
 s_waitcnt lgkmcnt(5)
 RW 82,3,16384
 PV 80,120,40
 RW 84,4,14336
 PV 84,120,54
 RW 86,4,16384
 PV 92,124,54
 RW 88,5,14336
 PV 88,124,40
 s_waitcnt lgkmcnt(7)
 RW 90,5,16384
 GH 64,64,44
 RW 92,6,14336
 GH 68,64,58
 RW 94,6,16384
 GH 76,68,58
 RW 96,3,18432
 GH 72,68,44
 s_waitcnt lgkmcnt(9)
 RW 98,3,20480
 GH 80,72,44
 RW 100,4,18432
 DL 21,12,62,2048
 GH 84,72,58
 RW 102,4,20480
 GH 92,76,58
 RW 104,5,18432
 GH 88,76,44
 s_waitcnt lgkmcnt(9)
 RW 106,5,20480
 PVZ 96,80,32
 RW 108,6,18432
 DL 22,12,62,3072
 PVZ 100,80,46
 s_add_u32 m0, m0, 0x1000
 RW 110,6,20480
 PVZ 108,84,46
 RW 112,3,22528
 PVZ 104,84,32
 s_waitcnt lgkmcnt(9)
 RW 114,3,24576
 PVZ 112,88,32
 RW 116,4,22528
 PVZ 116,88,46
 RW 118,4,24576
 PVZ 124,92,46
 RW 120,5,22528
 PVZ 120,92,32
 s_waitcnt lgkmcnt(9)
 RW 122,5,24576
 PV 96,96,36
 RW 124,6,22528
 PV 100,96,50
 RW 126,6,24576
 DL 19,12,41,0
 PV 108,100,50
 RW 64,3,26624
 PV 104,100,36
 s_waitcnt lgkmcnt(9)
 DL 20,12,41,1024
 PV 112,104,36
 RW 68,4,26624
 PV 116,104,50
 DL 21,12,41,2048
 PV 124,108,50
 RW 72,5,26624
 PV 120,108,36
 s_waitcnt lgkmcnt(7)
 PV 96,112,40
 RW 76,6,26624
 v_add_u32 v3, s24, v7
 PV 100,112,54
 s_add_u32 s62, s62, 256
 v_add_u32 v4, s24, v8
 v_add_u32 v5, s24, v9
 PV 108,116,54
 v_add_u32 v6, s24, v10
 RW 80,3,0
 PV 104,116,40
 s_waitcnt lgkmcnt(5)
 RW 82,3,2048
 PV 112,120,40
 RW 84,4,0
 PV 116,120,54
 RW 86,4,2048
 PV 124,124,54
 RW 88,5,0
 PV 120,124,40
 s_waitcnt lgkmcnt(7)
 RW 90,5,2048
 GH 96,64,44
 RW 92,6,0
 GH 100,64,58
 RW 94,6,2048
 GH 108,68,58
 RW 96,3,4096
 GH 104,68,44
 s_waitcnt lgkmcnt(9)
 RW 98,3,6144
 GH 112,72,44
 RW 100,4,4096
 GH 116,72,58
 RW 102,4,6144
 GH 124,76,58
 RW 104,5,4096
 GH 120,76,44
 RW 106,5,6144
 s_waitcnt vmcnt(7)
 s_barrier
 s_waitcnt lgkmcnt(10)
 PVZ 128,80,32
 s_add_u32 s25, s24, 0x18000
 RW 108,6,4096
 s_and_b32 s25, s25, 0x1ffff
 PVZ 132,80,46
 s_add_u32 s24, s24, 0x8000
 RW 110,6,6144
 s_and_b32 s24, s24, 0x1ffff
 PVZ 140,84,46
 RW 112,3,8192
 PVZ 136,84,32
 s_waitcnt lgkmcnt(9)
 RW 114,3,10240
 PVZ 144,88,32
 RW 116,4,8192
 PVZ 148,88,46
 RW 118,4,10240
 PVZ 156,92,46
 RW 120,5,8192
 PVZ 152,92,32
 s_waitcnt lgkmcnt(9)
 RW 122,5,10240
 PV 128,96,36
 RW 124,6,8192
 v_cvt_pk_bf16_f32 v64, v64, v65
 PV 132,96,50
 RW 126,6,10240
 v_cvt_pk_bf16_f32 v65, v66, v67
 PV 140,100,50
 RW 64,3,12288
 v_cvt_pk_bf16_f32 v66, v72, v73
 PV 136,100,36
 s_waitcnt lgkmcnt(9)
 v_cvt_pk_bf16_f32 v67, v74, v75
 PV 144,104,36
 s_add_u32 s42, s65, 0
 RW 68,4,12288
 PV 148,104,50
 buffer_store_dwordx4 v[64:67], v1, s[4:7], s42 offen sc1
 PV 156,108,50
 RW 72,5,12288
 v_cvt_pk_bf16_f32 v68, v68, v69
 PV 152,108,36
 s_waitcnt lgkmcnt(7)
 v_cvt_pk_bf16_f32 v69, v70, v71
 PV 128,112,40
 RW 76,6,12288
 v_cvt_pk_bf16_f32 v70, v76, v77
 PV 132,112,54
 v_cvt_pk_bf16_f32 v71, v78, v79
 PV 140,116,54
 RW 80,3,14336
 PV 136,116,40
 s_waitcnt lgkmcnt(5)
 RW 82,3,16384
 s_add_u32 s42, s65, 229376
 PV 144,120,40
 RW 84,4,14336
 buffer_store_dwordx4 v[68:71], v1, s[4:7], s42 offen sc1
 PV 148,120,54
 RW 86,4,16384
 v_cvt_pk_bf16_f32 v80, v80, v81
 PV 156,124,54
 RW 88,5,14336
 v_cvt_pk_bf16_f32 v81, v82, v83
 PV 152,124,40
 s_waitcnt lgkmcnt(7)
 RW 90,5,16384
 v_cvt_pk_bf16_f32 v82, v88, v89
 GH 128,64,44
 RW 92,6,14336
 v_cvt_pk_bf16_f32 v83, v90, v91
 GH 132,64,58
 s_add_u32 s42, s65, 1024
 RW 94,6,16384
 GH 140,68,58
 RW 96,3,18432
 buffer_store_dwordx4 v[80:83], v1, s[4:7], s42 offen sc1
 GH 136,68,44
 s_waitcnt lgkmcnt(9)
 RW 98,3,20480
 v_cvt_pk_bf16_f32 v84, v84, v85
 GH 144,72,44
 RW 100,4,18432
 v_cvt_pk_bf16_f32 v85, v86, v87
 GH 148,72,58
 RW 102,4,20480
 GH 156,76,58
 RW 104,5,18432
 v_cvt_pk_bf16_f32 v86, v92, v93
 GH 152,76,44
 s_waitcnt lgkmcnt(9)
 RW 106,5,20480
 v_cvt_pk_bf16_f32 v87, v94, v95
 PVZ 160,80,32
 s_add_u32 s42, s65, 230400
 RW 108,6,18432
 PVZ 164,80,46
 RW 110,6,20480
 buffer_store_dwordx4 v[84:87], v1, s[4:7], s42 offen sc1
 PVZ 172,84,46
 RW 112,3,22528
 v_cvt_pk_bf16_f32 v96, v96, v97
 PVZ 168,84,32
 s_waitcnt lgkmcnt(9)
 RW 114,3,24576
 v_cvt_pk_bf16_f32 v97, v98, v99
 PVZ 176,88,32
 RW 116,4,22528
 v_cvt_pk_bf16_f32 v98, v104, v105
 PVZ 180,88,46
 RW 118,4,24576
 v_cvt_pk_bf16_f32 v99, v106, v107
 PVZ 188,92,46
 s_add_u32 s42, s65, 2048
 RW 120,5,22528
 PVZ 184,92,32
 s_waitcnt lgkmcnt(9)
 RW 122,5,24576
 buffer_store_dwordx4 v[96:99], v1, s[4:7], s42 offen sc1
 PV 160,96,36
 RW 124,6,22528
 PV 164,96,50
 RW 126,6,24576
 v_cvt_pk_bf16_f32 v100, v100, v101
 PV 172,100,50
 RW 64,3,26624
 v_cvt_pk_bf16_f32 v101, v102, v103
 PV 168,100,36
 s_waitcnt lgkmcnt(9)
 v_cvt_pk_bf16_f32 v102, v108, v109
 PV 176,104,36
 RW 68,4,26624
 v_cvt_pk_bf16_f32 v103, v110, v111
 PV 180,104,50
 s_add_u32 s42, s65, 231424
 PV 188,108,50
 RW 72,5,26624
 buffer_store_dwordx4 v[100:103], v1, s[4:7], s42 offen sc1
 PV 184,108,36
 s_waitcnt lgkmcnt(7)
 v_cvt_pk_bf16_f32 v112, v112, v113
 PV 160,112,40
 RW 76,6,26624
 v_add_u32 v3, s24, v7
 PV 164,112,54
 v_add_u32 v4, s24, v8
 v_add_u32 v5, s24, v9
 PV 172,116,54
 v_add_u32 v6, s24, v10
 RW 80,3,0
 PV 168,116,40
 s_waitcnt lgkmcnt(5)
 RW 82,3,2048
 v_cvt_pk_bf16_f32 v113, v114, v115
 PV 176,120,40
 RW 84,4,0
 v_cvt_pk_bf16_f32 v114, v120, v121
 PV 180,120,54
 RW 86,4,2048
 v_cvt_pk_bf16_f32 v115, v122, v123
 PV 188,124,54
 s_add_u32 s42, s65, 3072
 RW 88,5,0
 buffer_store_dwordx4 v[112:115], v1, s[4:7], s42 offen sc1
 PV 184,124,40
 s_waitcnt lgkmcnt(7)
 RW 90,5,2048
 v_cvt_pk_bf16_f32 v116, v116, v117
 GH 160,64,44
 RW 92,6,0
 v_cvt_pk_bf16_f32 v117, v118, v119
 GH 164,64,58
 RW 94,6,2048
 v_cvt_pk_bf16_f32 v118, v124, v125
 GH 172,68,58
 RW 96,3,4096
 v_cvt_pk_bf16_f32 v119, v126, v127
 GH 168,68,44
 s_waitcnt lgkmcnt(9)
 RW 98,3,6144
 s_add_u32 s42, s65, 232448
 GH 176,72,44
 RW 100,4,4096
 buffer_store_dwordx4 v[116:119], v1, s[4:7], s42 offen sc1
 GH 180,72,58
 RW 102,4,6144
 GH 188,76,58
 RW 104,5,4096
 GH 184,76,44
 RW 106,5,6144
 s_waitcnt vmcnt(8)
 s_barrier
 s_waitcnt lgkmcnt(10)
 PVZ 64,80,32
 s_add_u32 s25, s24, 0x18000
 RW 108,6,4096
 s_and_b32 s25, s25, 0x1ffff
 PVZ 68,80,46
 s_add_u32 s24, s24, 0x8000
 RW 110,6,6144
 s_and_b32 s24, s24, 0x1ffff
 PVZ 76,84,46
 RW 112,3,8192
 PVZ 72,84,32
 s_waitcnt lgkmcnt(9)
 RW 114,3,10240
 PVZ 80,88,32
 RW 116,4,8192
 PVZ 84,88,46
 RW 118,4,10240
 PVZ 92,92,46
 RW 120,5,8192
 PVZ 88,92,32
 s_waitcnt lgkmcnt(9)
 RW 122,5,10240
 PV 64,96,36
 RW 124,6,8192
 v_cvt_pk_bf16_f32 v128, v128, v129
 PV 68,96,50
 RW 126,6,10240
 v_cvt_pk_bf16_f32 v129, v130, v131
 PV 76,100,50
 RW 64,3,12288
 v_cvt_pk_bf16_f32 v130, v136, v137
 PV 72,100,36
 s_waitcnt lgkmcnt(9)
 v_cvt_pk_bf16_f32 v131, v138, v139
 PV 80,104,36
 s_add_u32 s42, s65, 4096
 RW 68,4,12288
 PV 84,104,50
 buffer_store_dwordx4 v[128:131], v1, s[4:7], s42 offen sc1
 PV 92,108,50
 RW 72,5,12288
 v_cvt_pk_bf16_f32 v132, v132, v133
 PV 88,108,36
 s_waitcnt lgkmcnt(7)
 v_cvt_pk_bf16_f32 v133, v134, v135
 PV 64,112,40
 RW 76,6,12288
 v_cvt_pk_bf16_f32 v134, v140, v141
 PV 68,112,54
 v_cvt_pk_bf16_f32 v135, v142, v143
 PV 76,116,54
 RW 80,3,14336
 PV 72,116,40
 s_waitcnt lgkmcnt(5)
 RW 82,3,16384
 s_add_u32 s42, s65, 233472
 PV 80,120,40
 RW 84,4,14336
 buffer_store_dwordx4 v[132:135], v1, s[4:7], s42 offen sc1
 PV 84,120,54
 RW 86,4,16384
 v_cvt_pk_bf16_f32 v144, v144, v145
 PV 92,124,54
 RW 88,5,14336
 v_cvt_pk_bf16_f32 v145, v146, v147
 PV 88,124,40
 s_waitcnt lgkmcnt(7)
 RW 90,5,16384
 v_cvt_pk_bf16_f32 v146, v152, v153
 GH 64,64,44
 RW 92,6,14336
 v_cvt_pk_bf16_f32 v147, v154, v155
 GH 68,64,58
 s_add_u32 s42, s65, 5120
 RW 94,6,16384
 GH 76,68,58
 RW 96,3,18432
 buffer_store_dwordx4 v[144:147], v1, s[4:7], s42 offen sc1
 GH 72,68,44
 s_waitcnt lgkmcnt(9)
 RW 98,3,20480
 v_cvt_pk_bf16_f32 v148, v148, v149
 GH 80,72,44
 RW 100,4,18432
 v_cvt_pk_bf16_f32 v149, v150, v151
 GH 84,72,58
 RW 102,4,20480
 GH 92,76,58
 RW 104,5,18432
 v_cvt_pk_bf16_f32 v150, v156, v157
 GH 88,76,44
 s_waitcnt lgkmcnt(9)
 RW 106,5,20480
 v_cvt_pk_bf16_f32 v151, v158, v159
 PVZ 96,80,32
 s_add_u32 s42, s65, 234496
 RW 108,6,18432
 PVZ 100,80,46
 RW 110,6,20480
 buffer_store_dwordx4 v[148:151], v1, s[4:7], s42 offen sc1
 PVZ 108,84,46
 RW 112,3,22528
 v_cvt_pk_bf16_f32 v160, v160, v161
 PVZ 104,84,32
 s_waitcnt lgkmcnt(9)
 RW 114,3,24576
 v_cvt_pk_bf16_f32 v161, v162, v163
 PVZ 112,88,32
 RW 116,4,22528
 v_cvt_pk_bf16_f32 v162, v168, v169
 PVZ 116,88,46
 RW 118,4,24576
 v_cvt_pk_bf16_f32 v163, v170, v171
 PVZ 124,92,46
 s_add_u32 s42, s65, 6144
 RW 120,5,22528
 PVZ 120,92,32
 s_waitcnt lgkmcnt(9)
 RW 122,5,24576
 buffer_store_dwordx4 v[160:163], v1, s[4:7], s42 offen sc1
 PV 96,96,36
 RW 124,6,22528
 PV 100,96,50
 RW 126,6,24576
 v_cvt_pk_bf16_f32 v164, v164, v165
 PV 108,100,50
 RW 64,3,26624
 v_cvt_pk_bf16_f32 v165, v166, v167
 PV 104,100,36
 s_waitcnt lgkmcnt(9)
 v_cvt_pk_bf16_f32 v166, v172, v173
 PV 112,104,36
 RW 68,4,26624
 v_cvt_pk_bf16_f32 v167, v174, v175
 PV 116,104,50
 s_add_u32 s42, s65, 235520
 PV 124,108,50
 RW 72,5,26624
 buffer_store_dwordx4 v[164:167], v1, s[4:7], s42 offen sc1
 PV 120,108,36
 s_waitcnt lgkmcnt(7)
 v_cvt_pk_bf16_f32 v176, v176, v177
 PV 96,112,40
 RW 76,6,26624
 v_add_u32 v3, s24, v7
 PV 100,112,54
 v_add_u32 v4, s24, v8
 v_add_u32 v5, s24, v9
 PV 108,116,54
 v_add_u32 v6, s24, v10
 RW 80,3,0
 PV 104,116,40
 s_waitcnt lgkmcnt(5)
 RW 82,3,2048
 v_cvt_pk_bf16_f32 v177, v178, v179
 PV 112,120,40
 RW 84,4,0
 v_cvt_pk_bf16_f32 v178, v184, v185
 PV 116,120,54
 RW 86,4,2048
 v_cvt_pk_bf16_f32 v179, v186, v187
 PV 124,124,54
 s_add_u32 s42, s65, 7168
 RW 88,5,0
 buffer_store_dwordx4 v[176:179], v1, s[4:7], s42 offen sc1
 PV 120,124,40
 s_waitcnt lgkmcnt(7)
 RW 90,5,2048
 v_cvt_pk_bf16_f32 v180, v180, v181
 GH 96,64,44
 RW 92,6,0
 v_cvt_pk_bf16_f32 v181, v182, v183
 GH 100,64,58
 RW 94,6,2048
 v_cvt_pk_bf16_f32 v182, v188, v189
 GH 108,68,58
 RW 96,3,4096
 v_cvt_pk_bf16_f32 v183, v190, v191
 GH 104,68,44
 s_waitcnt lgkmcnt(9)
 RW 98,3,6144
 s_add_u32 s42, s65, 236544
 GH 112,72,44
 RW 100,4,4096
 buffer_store_dwordx4 v[180:183], v1, s[4:7], s42 offen sc1
 GH 116,72,58
 RW 102,4,6144
 GH 124,76,58
 RW 104,5,4096
 GH 120,76,44
 RW 106,5,6144
 s_waitcnt vmcnt(63)
 s_barrier
 s_waitcnt lgkmcnt(10)
 PVZ 128,80,32
 s_add_u32 s25, s24, 0x18000
 RW 108,6,4096
 s_and_b32 s25, s25, 0x1ffff
 PVZ 132,80,46
 s_add_u32 s24, s24, 0x8000
 RW 110,6,6144
 s_and_b32 s24, s24, 0x1ffff
 PVZ 140,84,46
 RW 112,3,8192
 PVZ 136,84,32
 s_waitcnt lgkmcnt(9)
 RW 114,3,10240
 PVZ 144,88,32
 RW 116,4,8192
 PVZ 148,88,46
 RW 118,4,10240
 PVZ 156,92,46
 RW 120,5,8192
 PVZ 152,92,32
 s_waitcnt lgkmcnt(9)
 RW 122,5,10240
 PV 128,96,36
 RW 124,6,8192
 v_cvt_pk_bf16_f32 v64, v64, v65
 PV 132,96,50
 RW 126,6,10240
 v_cvt_pk_bf16_f32 v65, v66, v67
 PV 140,100,50
 RW 64,3,12288
 v_cvt_pk_bf16_f32 v66, v72, v73
 PV 136,100,36
 s_waitcnt lgkmcnt(9)
 v_cvt_pk_bf16_f32 v67, v74, v75
 s_add_u32 s42, s65, 8192
 PV 144,104,36
 RW 68,4,12288
 buffer_store_dwordx4 v[64:67], v1, s[4:7], s42 offen sc1
 PV 148,104,50
 v_cvt_pk_bf16_f32 v68, v68, v69
 v_cvt_pk_bf16_f32 v69, v70, v71
 PV 156,108,50
 RW 72,5,12288
 v_cvt_pk_bf16_f32 v70, v76, v77
 PV 152,108,36
 s_waitcnt lgkmcnt(7)
 v_cvt_pk_bf16_f32 v71, v78, v79
 s_add_u32 s42, s65, 237568
 PV 128,112,40
 RW 76,6,12288
 buffer_store_dwordx4 v[68:71], v1, s[4:7], s42 offen sc1
 PV 132,112,54
 v_cvt_pk_bf16_f32 v80, v80, v81
 v_cvt_pk_bf16_f32 v81, v82, v83
 PV 140,116,54
 v_cvt_pk_bf16_f32 v82, v88, v89
 v_cvt_pk_bf16_f32 v83, v90, v91
 PV 136,116,40
 s_waitcnt lgkmcnt(4)
 s_add_u32 s42, s65, 9216
 buffer_store_dwordx4 v[80:83], v1, s[4:7], s42 offen sc1
 PV 144,120,40
 v_cvt_pk_bf16_f32 v84, v84, v85
 v_cvt_pk_bf16_f32 v85, v86, v87
 PV 148,120,54
 v_cvt_pk_bf16_f32 v86, v92, v93
 v_cvt_pk_bf16_f32 v87, v94, v95
 PV 156,124,54
 s_add_u32 s42, s65, 238592
 buffer_store_dwordx4 v[84:87], v1, s[4:7], s42 offen sc1
 v_cvt_pk_bf16_f32 v96, v96, v97
 PV 152,124,40
 s_waitcnt lgkmcnt(2)
 v_cvt_pk_bf16_f32 v97, v98, v99
 v_cvt_pk_bf16_f32 v98, v104, v105
 GH 128,64,44
 v_cvt_pk_bf16_f32 v99, v106, v107
 s_add_u32 s42, s65, 10240
 GH 132,64,58
 buffer_store_dwordx4 v[96:99], v1, s[4:7], s42 offen sc1
 v_cvt_pk_bf16_f32 v100, v100, v101
 GH 140,68,58
 v_cvt_pk_bf16_f32 v101, v102, v103
 v_cvt_pk_bf16_f32 v102, v108, v109
 GH 136,68,44
 s_waitcnt lgkmcnt(0)
 v_cvt_pk_bf16_f32 v103, v110, v111
 s_add_u32 s42, s65, 239616
 GH 144,72,44
 buffer_store_dwordx4 v[100:103], v1, s[4:7], s42 offen sc1
 v_cvt_pk_bf16_f32 v112, v112, v113
 GH 148,72,58
 v_cvt_pk_bf16_f32 v113, v114, v115
 v_cvt_pk_bf16_f32 v114, v120, v121
 GH 156,76,58
 v_cvt_pk_bf16_f32 v115, v122, v123
 s_add_u32 s42, s65, 11264
 buffer_store_dwordx4 v[112:115], v1, s[4:7], s42 offen sc1
 v_cvt_pk_bf16_f32 v116, v116, v117
 v_cvt_pk_bf16_f32 v117, v118, v119
 v_cvt_pk_bf16_f32 v118, v124, v125
 v_cvt_pk_bf16_f32 v119, v126, v127
 s_add_u32 s42, s65, 240640
 buffer_store_dwordx4 v[116:119], v1, s[4:7], s42 offen sc1
 GH 152,76,44
 s_nop 7
 v_cvt_pk_bf16_f32 v128, v128, v129
 v_cvt_pk_bf16_f32 v129, v130, v131
 v_cvt_pk_bf16_f32 v130, v136, v137
 v_cvt_pk_bf16_f32 v131, v138, v139
 s_add_u32 s42, s65, 12288
 buffer_store_dwordx4 v[128:131], v1, s[4:7], s42 offen sc1
 v_cvt_pk_bf16_f32 v132, v132, v133
 v_cvt_pk_bf16_f32 v133, v134, v135
 v_cvt_pk_bf16_f32 v134, v140, v141
 v_cvt_pk_bf16_f32 v135, v142, v143
 s_add_u32 s42, s65, 241664
 buffer_store_dwordx4 v[132:135], v1, s[4:7], s42 offen sc1
 v_cvt_pk_bf16_f32 v144, v144, v145
 v_cvt_pk_bf16_f32 v145, v146, v147
 v_cvt_pk_bf16_f32 v146, v152, v153
 v_cvt_pk_bf16_f32 v147, v154, v155
 s_add_u32 s42, s65, 13312
 buffer_store_dwordx4 v[144:147], v1, s[4:7], s42 offen sc1
 v_cvt_pk_bf16_f32 v148, v148, v149
 v_cvt_pk_bf16_f32 v149, v150, v151
 v_cvt_pk_bf16_f32 v150, v156, v157
 v_cvt_pk_bf16_f32 v151, v158, v159
 s_add_u32 s42, s65, 242688
 buffer_store_dwordx4 v[148:151], v1, s[4:7], s42 offen sc1
 s_load_dwordx2 s[92:93], s[0:1], 80
 v_and_b32 v44, 7, v0
 v_lshrrev_b32 v45, 5, v0
 v_bfe_u32 v46, v0, 3, 2
 s_and_b32 s41, s70, 1
 s_lshl_b32 s41, s41, 3
 v_add_u32 v47, s41, v44
 v_lshl_add_u32 v40, v46, 4, v47
 v_lshlrev_b32 v40, 4, v40
 v_lshl_add_u32 v40, v45, 10, v40
 v_mul_u32_u24 v41, 896, v44
 v_lshl_add_u32 v41, v45, 6, v41
 v_lshl_add_u32 v41, v46, 3, v41
 v_lshrrev_b32 v42, 6, v0
 v_lshl_add_u32 v42, v44, 2, v42
 v_lshlrev_b32 v42, 2, v42
 v_lshlrev_b32 v43, 4, v44
 s_waitcnt vmcnt(0) lgkmcnt(0)
 s_barrier
 s_add_u32 s41, s64, 64
 s_cmp_eq_u32 s20, 0
 s_cbranch_scc0 mk_sg_47
 s_lshl_b32 s44, s41, 8
 v_mov_b32 v29, s44
 v_mov_b32 v30, 1
 s_mov_b64 exec, 1
 global_atomic_add v29, v30, s[96:97] sc1
 s_mov_b64 exec, -1
mk_sg_47:
 s_add_u32 s41, s39, 64
 s_cmp_eq_u32 s20, 0
 s_cbranch_scc0 mk_wf_48
 s_lshl_b32 s44, s41, 8
 v_mov_b32 v29, s44
 s_mov_b32 s44, 0
mk_sp_49:
 global_load_dword v30, v29, s[96:97] sc1
 s_waitcnt vmcnt(0)
 v_readfirstlane_b32 s43, v30
 s_add_u32 s44, s44, 1
 s_bfe_u32 s43, s43, 0x100000
 s_cmp_ge_u32 s43, 16
 s_cbranch_scc1 mk_sp_49_ok
 s_sleep 2
 s_cmp_lt_u32 s44, 0x40000
 s_cbranch_scc1 mk_sp_49
mk_sp_49_ok:
mk_wf_48:
 s_barrier
 s_lshr_b32 s42, s70, 1
 s_mul_i32 s42, s42, 229376
 s_add_u32 s42, s42, 0x6000000
 s_add_u32 s43, s42, 8192
 buffer_load_dwordx4 v[64:67], v40, s[4:7], s42 offen
 s_add_u32 s42, s42, 14336
 buffer_load_dwordx4 v[68:71], v40, s[4:7], s42 offen
 s_add_u32 s42, s42, 14336
 buffer_load_dwordx4 v[72:75], v40, s[4:7], s42 offen
 s_add_u32 s42, s42, 14336
 buffer_load_dwordx4 v[76:79], v40, s[4:7], s42 offen
 s_add_u32 s42, s42, 14336
 buffer_load_dwordx4 v[80:83], v40, s[4:7], s42 offen
 s_add_u32 s42, s42, 14336
 buffer_load_dwordx4 v[84:87], v40, s[4:7], s42 offen
 s_add_u32 s42, s42, 14336
 buffer_load_dwordx4 v[88:91], v40, s[4:7], s42 offen
 s_add_u32 s42, s42, 14336
 buffer_load_dwordx4 v[92:95], v40, s[4:7], s42 offen
 s_add_u32 s42, s42, 14336
 buffer_load_dwordx4 v[96:99], v40, s[4:7], s42 offen
 s_add_u32 s42, s42, 14336
 buffer_load_dwordx4 v[100:103], v40, s[4:7], s42 offen
 s_add_u32 s42, s42, 14336
 buffer_load_dwordx4 v[104:107], v40, s[4:7], s42 offen
 s_add_u32 s42, s42, 14336
 buffer_load_dwordx4 v[108:111], v40, s[4:7], s42 offen
 s_add_u32 s42, s42, 14336
 buffer_load_dwordx4 v[112:115], v40, s[4:7], s42 offen
 s_add_u32 s42, s42, 14336
 buffer_load_dwordx4 v[116:119], v40, s[4:7], s42 offen
 s_add_u32 s42, s42, 14336
 buffer_load_dwordx4 v[120:123], v40, s[4:7], s42 offen
 s_add_u32 s42, s42, 14336
 buffer_load_dwordx4 v[124:127], v40, s[4:7], s42 offen
 s_cmp_eq_u32 s20, 3
 s_cbranch_scc1 mk_w3_50
 buffer_load_dwordx4 v[128:131], v40, s[4:7], s43 offen
 s_add_u32 s43, s43, 14336
 buffer_load_dwordx4 v[132:135], v40, s[4:7], s43 offen
 s_add_u32 s43, s43, 14336
 buffer_load_dwordx4 v[136:139], v40, s[4:7], s43 offen
 s_add_u32 s43, s43, 14336
 buffer_load_dwordx4 v[140:143], v40, s[4:7], s43 offen
 s_add_u32 s43, s43, 14336
 buffer_load_dwordx4 v[144:147], v40, s[4:7], s43 offen
 s_add_u32 s43, s43, 14336
 buffer_load_dwordx4 v[148:151], v40, s[4:7], s43 offen
 s_add_u32 s43, s43, 14336
 buffer_load_dwordx4 v[152:155], v40, s[4:7], s43 offen
 s_add_u32 s43, s43, 14336
 buffer_load_dwordx4 v[156:159], v40, s[4:7], s43 offen
 s_add_u32 s43, s43, 14336
 buffer_load_dwordx4 v[160:163], v40, s[4:7], s43 offen
 s_add_u32 s43, s43, 14336
 buffer_load_dwordx4 v[164:167], v40, s[4:7], s43 offen
 s_add_u32 s43, s43, 14336
 buffer_load_dwordx4 v[168:171], v40, s[4:7], s43 offen
 s_add_u32 s43, s43, 14336
 buffer_load_dwordx4 v[172:175], v40, s[4:7], s43 offen
 s_add_u32 s43, s43, 14336
 buffer_load_dwordx4 v[176:179], v40, s[4:7], s43 offen
 s_add_u32 s43, s43, 14336
 buffer_load_dwordx4 v[180:183], v40, s[4:7], s43 offen
 s_add_u32 s43, s43, 14336
 buffer_load_dwordx4 v[184:187], v40, s[4:7], s43 offen
 s_add_u32 s43, s43, 14336
 buffer_load_dwordx4 v[188:191], v40, s[4:7], s43 offen
mk_w3_50:
 v_accvgpr_read_b32 v48, a0
 v_accvgpr_read_b32 v49, a1
 v_accvgpr_read_b32 v50, a2
 v_accvgpr_read_b32 v51, a3
 v_accvgpr_read_b32 v52, a4
 v_accvgpr_read_b32 v53, a5
 v_accvgpr_read_b32 v54, a6
 v_accvgpr_read_b32 v55, a7
 v_accvgpr_read_b32 v56, a8
 v_accvgpr_read_b32 v57, a9
 v_accvgpr_read_b32 v58, a10
 v_accvgpr_read_b32 v59, a11
 v_accvgpr_read_b32 v60, a12
 v_accvgpr_read_b32 v61, a13
 v_accvgpr_read_b32 v62, a14
 v_accvgpr_read_b32 v63, a15
 s_mov_b32 s98, 0x3f80
 s_mov_b32 s99, 0x3f800000
 s_cmp_eq_u32 s20, 3
 s_cbranch_scc1 mk_w3_51
 s_waitcnt vmcnt(31)
 v_dot2_f32_bf16 v48, v64, s98, v48
 v_dot2_f32_bf16 v49, v64, s99, v49
 v_dot2_f32_bf16 v50, v65, s98, v50
 v_dot2_f32_bf16 v51, v65, s99, v51
 v_dot2_f32_bf16 v52, v66, s98, v52
 v_dot2_f32_bf16 v53, v66, s99, v53
 v_dot2_f32_bf16 v54, v67, s98, v54
 v_dot2_f32_bf16 v55, v67, s99, v55
 s_waitcnt vmcnt(30)
 v_dot2_f32_bf16 v48, v68, s98, v48
 v_dot2_f32_bf16 v49, v68, s99, v49
 v_dot2_f32_bf16 v50, v69, s98, v50
 v_dot2_f32_bf16 v51, v69, s99, v51
 v_dot2_f32_bf16 v52, v70, s98, v52
 v_dot2_f32_bf16 v53, v70, s99, v53
 v_dot2_f32_bf16 v54, v71, s98, v54
 v_dot2_f32_bf16 v55, v71, s99, v55
 s_waitcnt vmcnt(29)
 v_dot2_f32_bf16 v48, v72, s98, v48
 v_dot2_f32_bf16 v49, v72, s99, v49
 v_dot2_f32_bf16 v50, v73, s98, v50
 v_dot2_f32_bf16 v51, v73, s99, v51
 v_dot2_f32_bf16 v52, v74, s98, v52
 v_dot2_f32_bf16 v53, v74, s99, v53
 v_dot2_f32_bf16 v54, v75, s98, v54
 v_dot2_f32_bf16 v55, v75, s99, v55
 s_waitcnt vmcnt(28)
 v_dot2_f32_bf16 v48, v76, s98, v48
 v_dot2_f32_bf16 v49, v76, s99, v49
 v_dot2_f32_bf16 v50, v77, s98, v50
 v_dot2_f32_bf16 v51, v77, s99, v51
 v_dot2_f32_bf16 v52, v78, s98, v52
 v_dot2_f32_bf16 v53, v78, s99, v53
 v_dot2_f32_bf16 v54, v79, s98, v54
 v_dot2_f32_bf16 v55, v79, s99, v55
 s_waitcnt vmcnt(27)
 v_dot2_f32_bf16 v48, v80, s98, v48
 v_dot2_f32_bf16 v49, v80, s99, v49
 v_dot2_f32_bf16 v50, v81, s98, v50
 v_dot2_f32_bf16 v51, v81, s99, v51
 v_dot2_f32_bf16 v52, v82, s98, v52
 v_dot2_f32_bf16 v53, v82, s99, v53
 v_dot2_f32_bf16 v54, v83, s98, v54
 v_dot2_f32_bf16 v55, v83, s99, v55
 s_waitcnt vmcnt(26)
 v_dot2_f32_bf16 v48, v84, s98, v48
 v_dot2_f32_bf16 v49, v84, s99, v49
 v_dot2_f32_bf16 v50, v85, s98, v50
 v_dot2_f32_bf16 v51, v85, s99, v51
 v_dot2_f32_bf16 v52, v86, s98, v52
 v_dot2_f32_bf16 v53, v86, s99, v53
 v_dot2_f32_bf16 v54, v87, s98, v54
 v_dot2_f32_bf16 v55, v87, s99, v55
 s_waitcnt vmcnt(25)
 v_dot2_f32_bf16 v48, v88, s98, v48
 v_dot2_f32_bf16 v49, v88, s99, v49
 v_dot2_f32_bf16 v50, v89, s98, v50
 v_dot2_f32_bf16 v51, v89, s99, v51
 v_dot2_f32_bf16 v52, v90, s98, v52
 v_dot2_f32_bf16 v53, v90, s99, v53
 v_dot2_f32_bf16 v54, v91, s98, v54
 v_dot2_f32_bf16 v55, v91, s99, v55
 s_waitcnt vmcnt(24)
 v_dot2_f32_bf16 v48, v92, s98, v48
 v_dot2_f32_bf16 v49, v92, s99, v49
 v_dot2_f32_bf16 v50, v93, s98, v50
 v_dot2_f32_bf16 v51, v93, s99, v51
 v_dot2_f32_bf16 v52, v94, s98, v52
 v_dot2_f32_bf16 v53, v94, s99, v53
 v_dot2_f32_bf16 v54, v95, s98, v54
 v_dot2_f32_bf16 v55, v95, s99, v55
 s_waitcnt vmcnt(23)
 v_dot2_f32_bf16 v48, v96, s98, v48
 v_dot2_f32_bf16 v49, v96, s99, v49
 v_dot2_f32_bf16 v50, v97, s98, v50
 v_dot2_f32_bf16 v51, v97, s99, v51
 v_dot2_f32_bf16 v52, v98, s98, v52
 v_dot2_f32_bf16 v53, v98, s99, v53
 v_dot2_f32_bf16 v54, v99, s98, v54
 v_dot2_f32_bf16 v55, v99, s99, v55
 s_waitcnt vmcnt(22)
 v_dot2_f32_bf16 v48, v100, s98, v48
 v_dot2_f32_bf16 v49, v100, s99, v49
 v_dot2_f32_bf16 v50, v101, s98, v50
 v_dot2_f32_bf16 v51, v101, s99, v51
 v_dot2_f32_bf16 v52, v102, s98, v52
 v_dot2_f32_bf16 v53, v102, s99, v53
 v_dot2_f32_bf16 v54, v103, s98, v54
 v_dot2_f32_bf16 v55, v103, s99, v55
 s_waitcnt vmcnt(21)
 v_dot2_f32_bf16 v48, v104, s98, v48
 v_dot2_f32_bf16 v49, v104, s99, v49
 v_dot2_f32_bf16 v50, v105, s98, v50
 v_dot2_f32_bf16 v51, v105, s99, v51
 v_dot2_f32_bf16 v52, v106, s98, v52
 v_dot2_f32_bf16 v53, v106, s99, v53
 v_dot2_f32_bf16 v54, v107, s98, v54
 v_dot2_f32_bf16 v55, v107, s99, v55
 s_waitcnt vmcnt(20)
 v_dot2_f32_bf16 v48, v108, s98, v48
 v_dot2_f32_bf16 v49, v108, s99, v49
 v_dot2_f32_bf16 v50, v109, s98, v50
 v_dot2_f32_bf16 v51, v109, s99, v51
 v_dot2_f32_bf16 v52, v110, s98, v52
 v_dot2_f32_bf16 v53, v110, s99, v53
 v_dot2_f32_bf16 v54, v111, s98, v54
 v_dot2_f32_bf16 v55, v111, s99, v55
 s_waitcnt vmcnt(19)
 v_dot2_f32_bf16 v48, v112, s98, v48
 v_dot2_f32_bf16 v49, v112, s99, v49
 v_dot2_f32_bf16 v50, v113, s98, v50
 v_dot2_f32_bf16 v51, v113, s99, v51
 v_dot2_f32_bf16 v52, v114, s98, v52
 v_dot2_f32_bf16 v53, v114, s99, v53
 v_dot2_f32_bf16 v54, v115, s98, v54
 v_dot2_f32_bf16 v55, v115, s99, v55
 s_waitcnt vmcnt(18)
 v_dot2_f32_bf16 v48, v116, s98, v48
 v_dot2_f32_bf16 v49, v116, s99, v49
 v_dot2_f32_bf16 v50, v117, s98, v50
 v_dot2_f32_bf16 v51, v117, s99, v51
 v_dot2_f32_bf16 v52, v118, s98, v52
 v_dot2_f32_bf16 v53, v118, s99, v53
 v_dot2_f32_bf16 v54, v119, s98, v54
 v_dot2_f32_bf16 v55, v119, s99, v55
 s_waitcnt vmcnt(17)
 v_dot2_f32_bf16 v48, v120, s98, v48
 v_dot2_f32_bf16 v49, v120, s99, v49
 v_dot2_f32_bf16 v50, v121, s98, v50
 v_dot2_f32_bf16 v51, v121, s99, v51
 v_dot2_f32_bf16 v52, v122, s98, v52
 v_dot2_f32_bf16 v53, v122, s99, v53
 v_dot2_f32_bf16 v54, v123, s98, v54
 v_dot2_f32_bf16 v55, v123, s99, v55
 s_waitcnt vmcnt(16)
 v_dot2_f32_bf16 v48, v124, s98, v48
 v_dot2_f32_bf16 v49, v124, s99, v49
 v_dot2_f32_bf16 v50, v125, s98, v50
 v_dot2_f32_bf16 v51, v125, s99, v51
 v_dot2_f32_bf16 v52, v126, s98, v52
 v_dot2_f32_bf16 v53, v126, s99, v53
 v_dot2_f32_bf16 v54, v127, s98, v54
 v_dot2_f32_bf16 v55, v127, s99, v55
 s_waitcnt vmcnt(15)
 v_dot2_f32_bf16 v56, v128, s98, v56
 v_dot2_f32_bf16 v57, v128, s99, v57
 v_dot2_f32_bf16 v58, v129, s98, v58
 v_dot2_f32_bf16 v59, v129, s99, v59
 v_dot2_f32_bf16 v60, v130, s98, v60
 v_dot2_f32_bf16 v61, v130, s99, v61
 v_dot2_f32_bf16 v62, v131, s98, v62
 v_dot2_f32_bf16 v63, v131, s99, v63
 s_waitcnt vmcnt(14)
 v_dot2_f32_bf16 v56, v132, s98, v56
 v_dot2_f32_bf16 v57, v132, s99, v57
 v_dot2_f32_bf16 v58, v133, s98, v58
 v_dot2_f32_bf16 v59, v133, s99, v59
 v_dot2_f32_bf16 v60, v134, s98, v60
 v_dot2_f32_bf16 v61, v134, s99, v61
 v_dot2_f32_bf16 v62, v135, s98, v62
 v_dot2_f32_bf16 v63, v135, s99, v63
 s_waitcnt vmcnt(13)
 v_dot2_f32_bf16 v56, v136, s98, v56
 v_dot2_f32_bf16 v57, v136, s99, v57
 v_dot2_f32_bf16 v58, v137, s98, v58
 v_dot2_f32_bf16 v59, v137, s99, v59
 v_dot2_f32_bf16 v60, v138, s98, v60
 v_dot2_f32_bf16 v61, v138, s99, v61
 v_dot2_f32_bf16 v62, v139, s98, v62
 v_dot2_f32_bf16 v63, v139, s99, v63
 s_waitcnt vmcnt(12)
 v_dot2_f32_bf16 v56, v140, s98, v56
 v_dot2_f32_bf16 v57, v140, s99, v57
 v_dot2_f32_bf16 v58, v141, s98, v58
 v_dot2_f32_bf16 v59, v141, s99, v59
 v_dot2_f32_bf16 v60, v142, s98, v60
 v_dot2_f32_bf16 v61, v142, s99, v61
 v_dot2_f32_bf16 v62, v143, s98, v62
 v_dot2_f32_bf16 v63, v143, s99, v63
 s_waitcnt vmcnt(11)
 v_dot2_f32_bf16 v56, v144, s98, v56
 v_dot2_f32_bf16 v57, v144, s99, v57
 v_dot2_f32_bf16 v58, v145, s98, v58
 v_dot2_f32_bf16 v59, v145, s99, v59
 v_dot2_f32_bf16 v60, v146, s98, v60
 v_dot2_f32_bf16 v61, v146, s99, v61
 v_dot2_f32_bf16 v62, v147, s98, v62
 v_dot2_f32_bf16 v63, v147, s99, v63
 s_waitcnt vmcnt(10)
 v_dot2_f32_bf16 v56, v148, s98, v56
 v_dot2_f32_bf16 v57, v148, s99, v57
 v_dot2_f32_bf16 v58, v149, s98, v58
 v_dot2_f32_bf16 v59, v149, s99, v59
 v_dot2_f32_bf16 v60, v150, s98, v60
 v_dot2_f32_bf16 v61, v150, s99, v61
 v_dot2_f32_bf16 v62, v151, s98, v62
 v_dot2_f32_bf16 v63, v151, s99, v63
 s_waitcnt vmcnt(9)
 v_dot2_f32_bf16 v56, v152, s98, v56
 v_dot2_f32_bf16 v57, v152, s99, v57
 v_dot2_f32_bf16 v58, v153, s98, v58
 v_dot2_f32_bf16 v59, v153, s99, v59
 v_dot2_f32_bf16 v60, v154, s98, v60
 v_dot2_f32_bf16 v61, v154, s99, v61
 v_dot2_f32_bf16 v62, v155, s98, v62
 v_dot2_f32_bf16 v63, v155, s99, v63
 s_waitcnt vmcnt(8)
 v_dot2_f32_bf16 v56, v156, s98, v56
 v_dot2_f32_bf16 v57, v156, s99, v57
 v_dot2_f32_bf16 v58, v157, s98, v58
 v_dot2_f32_bf16 v59, v157, s99, v59
 v_dot2_f32_bf16 v60, v158, s98, v60
 v_dot2_f32_bf16 v61, v158, s99, v61
 v_dot2_f32_bf16 v62, v159, s98, v62
 v_dot2_f32_bf16 v63, v159, s99, v63
 s_waitcnt vmcnt(7)
 v_dot2_f32_bf16 v56, v160, s98, v56
 v_dot2_f32_bf16 v57, v160, s99, v57
 v_dot2_f32_bf16 v58, v161, s98, v58
 v_dot2_f32_bf16 v59, v161, s99, v59
 v_dot2_f32_bf16 v60, v162, s98, v60
 v_dot2_f32_bf16 v61, v162, s99, v61
 v_dot2_f32_bf16 v62, v163, s98, v62
 v_dot2_f32_bf16 v63, v163, s99, v63
 s_waitcnt vmcnt(6)
 v_dot2_f32_bf16 v56, v164, s98, v56
 v_dot2_f32_bf16 v57, v164, s99, v57
 v_dot2_f32_bf16 v58, v165, s98, v58
 v_dot2_f32_bf16 v59, v165, s99, v59
 v_dot2_f32_bf16 v60, v166, s98, v60
 v_dot2_f32_bf16 v61, v166, s99, v61
 v_dot2_f32_bf16 v62, v167, s98, v62
 v_dot2_f32_bf16 v63, v167, s99, v63
 s_waitcnt vmcnt(5)
 v_dot2_f32_bf16 v56, v168, s98, v56
 v_dot2_f32_bf16 v57, v168, s99, v57
 v_dot2_f32_bf16 v58, v169, s98, v58
 v_dot2_f32_bf16 v59, v169, s99, v59
 v_dot2_f32_bf16 v60, v170, s98, v60
 v_dot2_f32_bf16 v61, v170, s99, v61
 v_dot2_f32_bf16 v62, v171, s98, v62
 v_dot2_f32_bf16 v63, v171, s99, v63
 s_waitcnt vmcnt(4)
 v_dot2_f32_bf16 v56, v172, s98, v56
 v_dot2_f32_bf16 v57, v172, s99, v57
 v_dot2_f32_bf16 v58, v173, s98, v58
 v_dot2_f32_bf16 v59, v173, s99, v59
 v_dot2_f32_bf16 v60, v174, s98, v60
 v_dot2_f32_bf16 v61, v174, s99, v61
 v_dot2_f32_bf16 v62, v175, s98, v62
 v_dot2_f32_bf16 v63, v175, s99, v63
 s_waitcnt vmcnt(3)
 v_dot2_f32_bf16 v56, v176, s98, v56
 v_dot2_f32_bf16 v57, v176, s99, v57
 v_dot2_f32_bf16 v58, v177, s98, v58
 v_dot2_f32_bf16 v59, v177, s99, v59
 v_dot2_f32_bf16 v60, v178, s98, v60
 v_dot2_f32_bf16 v61, v178, s99, v61
 v_dot2_f32_bf16 v62, v179, s98, v62
 v_dot2_f32_bf16 v63, v179, s99, v63
 s_waitcnt vmcnt(2)
 v_dot2_f32_bf16 v56, v180, s98, v56
 v_dot2_f32_bf16 v57, v180, s99, v57
 v_dot2_f32_bf16 v58, v181, s98, v58
 v_dot2_f32_bf16 v59, v181, s99, v59
 v_dot2_f32_bf16 v60, v182, s98, v60
 v_dot2_f32_bf16 v61, v182, s99, v61
 v_dot2_f32_bf16 v62, v183, s98, v62
 v_dot2_f32_bf16 v63, v183, s99, v63
 s_waitcnt vmcnt(1)
 v_dot2_f32_bf16 v56, v184, s98, v56
 v_dot2_f32_bf16 v57, v184, s99, v57
 v_dot2_f32_bf16 v58, v185, s98, v58
 v_dot2_f32_bf16 v59, v185, s99, v59
 v_dot2_f32_bf16 v60, v186, s98, v60
 v_dot2_f32_bf16 v61, v186, s99, v61
 v_dot2_f32_bf16 v62, v187, s98, v62
 v_dot2_f32_bf16 v63, v187, s99, v63
 s_waitcnt vmcnt(0)
 v_dot2_f32_bf16 v56, v188, s98, v56
 v_dot2_f32_bf16 v57, v188, s99, v57
 v_dot2_f32_bf16 v58, v189, s98, v58
 v_dot2_f32_bf16 v59, v189, s99, v59
 v_dot2_f32_bf16 v60, v190, s98, v60
 v_dot2_f32_bf16 v61, v190, s99, v61
 v_dot2_f32_bf16 v62, v191, s98, v62
 v_dot2_f32_bf16 v63, v191, s99, v63
 s_branch mk_ae_52
mk_w3_51:
 s_waitcnt vmcnt(15)
 v_dot2_f32_bf16 v48, v64, s98, v48
 v_dot2_f32_bf16 v49, v64, s99, v49
 v_dot2_f32_bf16 v50, v65, s98, v50
 v_dot2_f32_bf16 v51, v65, s99, v51
 v_dot2_f32_bf16 v52, v66, s98, v52
 v_dot2_f32_bf16 v53, v66, s99, v53
 v_dot2_f32_bf16 v54, v67, s98, v54
 v_dot2_f32_bf16 v55, v67, s99, v55
 s_waitcnt vmcnt(14)
 v_dot2_f32_bf16 v48, v68, s98, v48
 v_dot2_f32_bf16 v49, v68, s99, v49
 v_dot2_f32_bf16 v50, v69, s98, v50
 v_dot2_f32_bf16 v51, v69, s99, v51
 v_dot2_f32_bf16 v52, v70, s98, v52
 v_dot2_f32_bf16 v53, v70, s99, v53
 v_dot2_f32_bf16 v54, v71, s98, v54
 v_dot2_f32_bf16 v55, v71, s99, v55
 s_waitcnt vmcnt(13)
 v_dot2_f32_bf16 v48, v72, s98, v48
 v_dot2_f32_bf16 v49, v72, s99, v49
 v_dot2_f32_bf16 v50, v73, s98, v50
 v_dot2_f32_bf16 v51, v73, s99, v51
 v_dot2_f32_bf16 v52, v74, s98, v52
 v_dot2_f32_bf16 v53, v74, s99, v53
 v_dot2_f32_bf16 v54, v75, s98, v54
 v_dot2_f32_bf16 v55, v75, s99, v55
 s_waitcnt vmcnt(12)
 v_dot2_f32_bf16 v48, v76, s98, v48
 v_dot2_f32_bf16 v49, v76, s99, v49
 v_dot2_f32_bf16 v50, v77, s98, v50
 v_dot2_f32_bf16 v51, v77, s99, v51
 v_dot2_f32_bf16 v52, v78, s98, v52
 v_dot2_f32_bf16 v53, v78, s99, v53
 v_dot2_f32_bf16 v54, v79, s98, v54
 v_dot2_f32_bf16 v55, v79, s99, v55
 s_waitcnt vmcnt(11)
 v_dot2_f32_bf16 v48, v80, s98, v48
 v_dot2_f32_bf16 v49, v80, s99, v49
 v_dot2_f32_bf16 v50, v81, s98, v50
 v_dot2_f32_bf16 v51, v81, s99, v51
 v_dot2_f32_bf16 v52, v82, s98, v52
 v_dot2_f32_bf16 v53, v82, s99, v53
 v_dot2_f32_bf16 v54, v83, s98, v54
 v_dot2_f32_bf16 v55, v83, s99, v55
 s_waitcnt vmcnt(10)
 v_dot2_f32_bf16 v48, v84, s98, v48
 v_dot2_f32_bf16 v49, v84, s99, v49
 v_dot2_f32_bf16 v50, v85, s98, v50
 v_dot2_f32_bf16 v51, v85, s99, v51
 v_dot2_f32_bf16 v52, v86, s98, v52
 v_dot2_f32_bf16 v53, v86, s99, v53
 v_dot2_f32_bf16 v54, v87, s98, v54
 v_dot2_f32_bf16 v55, v87, s99, v55
 s_waitcnt vmcnt(9)
 v_dot2_f32_bf16 v48, v88, s98, v48
 v_dot2_f32_bf16 v49, v88, s99, v49
 v_dot2_f32_bf16 v50, v89, s98, v50
 v_dot2_f32_bf16 v51, v89, s99, v51
 v_dot2_f32_bf16 v52, v90, s98, v52
 v_dot2_f32_bf16 v53, v90, s99, v53
 v_dot2_f32_bf16 v54, v91, s98, v54
 v_dot2_f32_bf16 v55, v91, s99, v55
 s_waitcnt vmcnt(8)
 v_dot2_f32_bf16 v48, v92, s98, v48
 v_dot2_f32_bf16 v49, v92, s99, v49
 v_dot2_f32_bf16 v50, v93, s98, v50
 v_dot2_f32_bf16 v51, v93, s99, v51
 v_dot2_f32_bf16 v52, v94, s98, v52
 v_dot2_f32_bf16 v53, v94, s99, v53
 v_dot2_f32_bf16 v54, v95, s98, v54
 v_dot2_f32_bf16 v55, v95, s99, v55
 s_waitcnt vmcnt(7)
 v_dot2_f32_bf16 v48, v96, s98, v48
 v_dot2_f32_bf16 v49, v96, s99, v49
 v_dot2_f32_bf16 v50, v97, s98, v50
 v_dot2_f32_bf16 v51, v97, s99, v51
 v_dot2_f32_bf16 v52, v98, s98, v52
 v_dot2_f32_bf16 v53, v98, s99, v53
 v_dot2_f32_bf16 v54, v99, s98, v54
 v_dot2_f32_bf16 v55, v99, s99, v55
 s_waitcnt vmcnt(6)
 v_dot2_f32_bf16 v48, v100, s98, v48
 v_dot2_f32_bf16 v49, v100, s99, v49
 v_dot2_f32_bf16 v50, v101, s98, v50
 v_dot2_f32_bf16 v51, v101, s99, v51
 v_dot2_f32_bf16 v52, v102, s98, v52
 v_dot2_f32_bf16 v53, v102, s99, v53
 v_dot2_f32_bf16 v54, v103, s98, v54
 v_dot2_f32_bf16 v55, v103, s99, v55
 s_waitcnt vmcnt(5)
 v_dot2_f32_bf16 v48, v104, s98, v48
 v_dot2_f32_bf16 v49, v104, s99, v49
 v_dot2_f32_bf16 v50, v105, s98, v50
 v_dot2_f32_bf16 v51, v105, s99, v51
 v_dot2_f32_bf16 v52, v106, s98, v52
 v_dot2_f32_bf16 v53, v106, s99, v53
 v_dot2_f32_bf16 v54, v107, s98, v54
 v_dot2_f32_bf16 v55, v107, s99, v55
 s_waitcnt vmcnt(4)
 v_dot2_f32_bf16 v48, v108, s98, v48
 v_dot2_f32_bf16 v49, v108, s99, v49
 v_dot2_f32_bf16 v50, v109, s98, v50
 v_dot2_f32_bf16 v51, v109, s99, v51
 v_dot2_f32_bf16 v52, v110, s98, v52
 v_dot2_f32_bf16 v53, v110, s99, v53
 v_dot2_f32_bf16 v54, v111, s98, v54
 v_dot2_f32_bf16 v55, v111, s99, v55
 s_waitcnt vmcnt(3)
 v_dot2_f32_bf16 v48, v112, s98, v48
 v_dot2_f32_bf16 v49, v112, s99, v49
 v_dot2_f32_bf16 v50, v113, s98, v50
 v_dot2_f32_bf16 v51, v113, s99, v51
 v_dot2_f32_bf16 v52, v114, s98, v52
 v_dot2_f32_bf16 v53, v114, s99, v53
 v_dot2_f32_bf16 v54, v115, s98, v54
 v_dot2_f32_bf16 v55, v115, s99, v55
 s_waitcnt vmcnt(2)
 v_dot2_f32_bf16 v48, v116, s98, v48
 v_dot2_f32_bf16 v49, v116, s99, v49
 v_dot2_f32_bf16 v50, v117, s98, v50
 v_dot2_f32_bf16 v51, v117, s99, v51
 v_dot2_f32_bf16 v52, v118, s98, v52
 v_dot2_f32_bf16 v53, v118, s99, v53
 v_dot2_f32_bf16 v54, v119, s98, v54
 v_dot2_f32_bf16 v55, v119, s99, v55
 s_waitcnt vmcnt(1)
 v_dot2_f32_bf16 v48, v120, s98, v48
 v_dot2_f32_bf16 v49, v120, s99, v49
 v_dot2_f32_bf16 v50, v121, s98, v50
 v_dot2_f32_bf16 v51, v121, s99, v51
 v_dot2_f32_bf16 v52, v122, s98, v52
 v_dot2_f32_bf16 v53, v122, s99, v53
 v_dot2_f32_bf16 v54, v123, s98, v54
 v_dot2_f32_bf16 v55, v123, s99, v55
 s_waitcnt vmcnt(0)
 v_dot2_f32_bf16 v48, v124, s98, v48
 v_dot2_f32_bf16 v49, v124, s99, v49
 v_dot2_f32_bf16 v50, v125, s98, v50
 v_dot2_f32_bf16 v51, v125, s99, v51
 v_dot2_f32_bf16 v52, v126, s98, v52
 v_dot2_f32_bf16 v53, v126, s99, v53
 v_dot2_f32_bf16 v54, v127, s98, v54
 v_dot2_f32_bf16 v55, v127, s99, v55
mk_ae_52:
 s_mul_i32 s42, s70, 7168
 v_cvt_pk_bf16_f32 v200, v48, v49
 v_cvt_pk_bf16_f32 v201, v50, v51
 v_cvt_pk_bf16_f32 v202, v52, v53
 v_cvt_pk_bf16_f32 v203, v54, v55
 buffer_store_dwordx2 v[200:201], v41, s[92:95], s42 offen offset:0
 buffer_store_dwordx2 v[202:203], v41, s[92:95], s42 offen offset:32
 s_cmp_eq_u32 s20, 3
 s_cbranch_scc1 mk_w3_53
 v_cvt_pk_bf16_f32 v204, v56, v57
 v_cvt_pk_bf16_f32 v205, v58, v59
 v_cvt_pk_bf16_f32 v206, v60, v61
 v_cvt_pk_bf16_f32 v207, v62, v63
 buffer_store_dwordx2 v[204:205], v41, s[92:95], s42 offen offset:512
 buffer_store_dwordx2 v[206:207], v41, s[92:95], s42 offen offset:544
mk_w3_53:
 s_endpgm
mk_partial:
 s_mov_b32 s39, s23
 s_lshl_b32 s41, s39, 2
 s_add_u32 s41, s41, s20
 s_mul_i32 s41, s41, 28672
 s_add_u32 s41, s41, 0x2000000
 buffer_load_dwordx4 a[0:3], v1, s[4:7], s41 offen offset:0
 buffer_load_dwordx4 a[4:7], v1, s[4:7], s41 offen offset:1024
 buffer_load_dwordx4 a[8:11], v1, s[4:7], s41 offen offset:2048
 buffer_load_dwordx4 a[12:15], v1, s[4:7], s41 offen offset:3072
 s_add_u32 s41, s41, 4096
 buffer_load_dwordx4 a[16:19], v1, s[4:7], s41 offen offset:0
 buffer_load_dwordx4 a[20:23], v1, s[4:7], s41 offen offset:1024
 buffer_load_dwordx4 a[24:27], v1, s[4:7], s41 offen offset:2048
 buffer_load_dwordx4 a[28:31], v1, s[4:7], s41 offen offset:3072
 s_add_u32 s41, s41, 4096
 buffer_load_dwordx4 a[208:211], v1, s[4:7], s41 offen offset:0
 buffer_load_dwordx4 a[212:215], v1, s[4:7], s41 offen offset:1024
 buffer_load_dwordx4 a[216:219], v1, s[4:7], s41 offen offset:2048
 buffer_load_dwordx4 a[220:223], v1, s[4:7], s41 offen offset:3072
 s_add_u32 s41, s41, 4096
 buffer_load_dwordx4 a[224:227], v1, s[4:7], s41 offen offset:0
 buffer_load_dwordx4 a[228:231], v1, s[4:7], s41 offen offset:1024
 buffer_load_dwordx4 a[232:235], v1, s[4:7], s41 offen offset:2048
 buffer_load_dwordx4 a[236:239], v1, s[4:7], s41 offen offset:3072
 s_add_u32 s41, s41, 4096
 buffer_load_dwordx4 a[160:163], v1, s[4:7], s41 offen offset:0
 buffer_load_dwordx4 a[164:167], v1, s[4:7], s41 offen offset:1024
 buffer_load_dwordx4 a[168:171], v1, s[4:7], s41 offen offset:2048
 buffer_load_dwordx4 a[172:175], v1, s[4:7], s41 offen offset:3072
 s_add_u32 s41, s41, 4096
 buffer_load_dwordx4 a[176:179], v1, s[4:7], s41 offen offset:0
 buffer_load_dwordx4 a[180:183], v1, s[4:7], s41 offen offset:1024
 buffer_load_dwordx4 a[184:187], v1, s[4:7], s41 offen offset:2048
 buffer_load_dwordx4 a[188:191], v1, s[4:7], s41 offen offset:3072
 s_add_u32 s41, s41, 4096
 buffer_load_dwordx4 a[192:195], v1, s[4:7], s41 offen offset:0
 buffer_load_dwordx4 a[196:199], v1, s[4:7], s41 offen offset:1024
 buffer_load_dwordx4 a[200:203], v1, s[4:7], s41 offen offset:2048
 buffer_load_dwordx4 a[204:207], v1, s[4:7], s41 offen offset:3072
 s_mov_b32 s19, 0
 s_lshl_b32 s40, s23, 2
 s_add_u32 s40, s40, 4
 s_mov_b32 s35, 0
 v_rcp_f32 v26, v24
 v_log_f32 v24, v24
 v_rcp_f32 v27, v25
 v_log_f32 v25, v25
 s_nop 0
 v_sub_f32 v24, v24, v32
 v_sub_f32 v25, v25, v36
 v_mov_b32 v80, v26
 v_mov_b32 v81, v26
 v_mov_b32 v82, v27
 v_mov_b32 v83, v27
 v_pk_mul_f32 v[128:129], v[128:129], v[80:81]
 v_pk_mul_f32 v[130:131], v[130:131], v[80:81]
 v_pk_mul_f32 v[136:137], v[136:137], v[80:81]
 v_pk_mul_f32 v[138:139], v[138:139], v[80:81]
 v_cvt_pk_bf16_f32 v128, v128, v129
 v_cvt_pk_bf16_f32 v129, v130, v131
 v_cvt_pk_bf16_f32 v130, v136, v137
 v_cvt_pk_bf16_f32 v131, v138, v139
 s_add_u32 s41, s57, 0
 buffer_store_dwordx4 v[128:131], v1, s[4:7], s41 offen offset:0 sc1
 v_pk_mul_f32 v[132:133], v[132:133], v[82:83]
 v_pk_mul_f32 v[134:135], v[134:135], v[82:83]
 v_pk_mul_f32 v[140:141], v[140:141], v[82:83]
 v_pk_mul_f32 v[142:143], v[142:143], v[82:83]
 v_cvt_pk_bf16_f32 v132, v132, v133
 v_cvt_pk_bf16_f32 v133, v134, v135
 v_cvt_pk_bf16_f32 v134, v140, v141
 v_cvt_pk_bf16_f32 v135, v142, v143
 s_add_u32 s41, s57, 0
 buffer_store_dwordx4 v[132:135], v1, s[4:7], s41 offen offset:1024 sc1
 v_pk_mul_f32 v[144:145], v[144:145], v[80:81]
 v_pk_mul_f32 v[146:147], v[146:147], v[80:81]
 v_pk_mul_f32 v[152:153], v[152:153], v[80:81]
 v_pk_mul_f32 v[154:155], v[154:155], v[80:81]
 v_cvt_pk_bf16_f32 v144, v144, v145
 v_cvt_pk_bf16_f32 v145, v146, v147
 v_cvt_pk_bf16_f32 v146, v152, v153
 v_cvt_pk_bf16_f32 v147, v154, v155
 s_add_u32 s41, s57, 0
 buffer_store_dwordx4 v[144:147], v1, s[4:7], s41 offen offset:2048 sc1
 v_pk_mul_f32 v[148:149], v[148:149], v[82:83]
 v_pk_mul_f32 v[150:151], v[150:151], v[82:83]
 v_pk_mul_f32 v[156:157], v[156:157], v[82:83]
 v_pk_mul_f32 v[158:159], v[158:159], v[82:83]
 v_cvt_pk_bf16_f32 v148, v148, v149
 v_cvt_pk_bf16_f32 v149, v150, v151
 v_cvt_pk_bf16_f32 v150, v156, v157
 v_cvt_pk_bf16_f32 v151, v158, v159
 s_add_u32 s41, s57, 0
 buffer_store_dwordx4 v[148:151], v1, s[4:7], s41 offen offset:3072 sc1
 v_pk_mul_f32 v[160:161], v[160:161], v[80:81]
 v_pk_mul_f32 v[162:163], v[162:163], v[80:81]
 v_pk_mul_f32 v[168:169], v[168:169], v[80:81]
 v_pk_mul_f32 v[170:171], v[170:171], v[80:81]
 v_cvt_pk_bf16_f32 v160, v160, v161
 v_cvt_pk_bf16_f32 v161, v162, v163
 v_cvt_pk_bf16_f32 v162, v168, v169
 v_cvt_pk_bf16_f32 v163, v170, v171
 s_add_u32 s41, s57, 4096
 buffer_store_dwordx4 v[160:163], v1, s[4:7], s41 offen offset:0 sc1
 v_pk_mul_f32 v[164:165], v[164:165], v[82:83]
 v_pk_mul_f32 v[166:167], v[166:167], v[82:83]
 v_pk_mul_f32 v[172:173], v[172:173], v[82:83]
 v_pk_mul_f32 v[174:175], v[174:175], v[82:83]
 v_cvt_pk_bf16_f32 v164, v164, v165
 v_cvt_pk_bf16_f32 v165, v166, v167
 v_cvt_pk_bf16_f32 v166, v172, v173
 v_cvt_pk_bf16_f32 v167, v174, v175
 s_add_u32 s41, s57, 4096
 buffer_store_dwordx4 v[164:167], v1, s[4:7], s41 offen offset:1024 sc1
 v_pk_mul_f32 v[176:177], v[176:177], v[80:81]
 v_pk_mul_f32 v[178:179], v[178:179], v[80:81]
 v_pk_mul_f32 v[184:185], v[184:185], v[80:81]
 v_pk_mul_f32 v[186:187], v[186:187], v[80:81]
 v_cvt_pk_bf16_f32 v176, v176, v177
 v_cvt_pk_bf16_f32 v177, v178, v179
 v_cvt_pk_bf16_f32 v178, v184, v185
 v_cvt_pk_bf16_f32 v179, v186, v187
 s_add_u32 s41, s57, 4096
 buffer_store_dwordx4 v[176:179], v1, s[4:7], s41 offen offset:2048 sc1
 v_pk_mul_f32 v[180:181], v[180:181], v[82:83]
 v_pk_mul_f32 v[182:183], v[182:183], v[82:83]
 v_pk_mul_f32 v[188:189], v[188:189], v[82:83]
 v_pk_mul_f32 v[190:191], v[190:191], v[82:83]
 v_cvt_pk_bf16_f32 v180, v180, v181
 v_cvt_pk_bf16_f32 v181, v182, v183
 v_cvt_pk_bf16_f32 v182, v188, v189
 v_cvt_pk_bf16_f32 v183, v190, v191
 s_add_u32 s41, s57, 4096
 buffer_store_dwordx4 v[180:183], v1, s[4:7], s41 offen offset:3072 sc1
 v_pk_mul_f32 v[192:193], v[192:193], v[80:81]
 v_pk_mul_f32 v[194:195], v[194:195], v[80:81]
 v_pk_mul_f32 v[200:201], v[200:201], v[80:81]
 v_pk_mul_f32 v[202:203], v[202:203], v[80:81]
 v_cvt_pk_bf16_f32 v192, v192, v193
 v_cvt_pk_bf16_f32 v193, v194, v195
 v_cvt_pk_bf16_f32 v194, v200, v201
 v_cvt_pk_bf16_f32 v195, v202, v203
 s_add_u32 s41, s57, 8192
 buffer_store_dwordx4 v[192:195], v1, s[4:7], s41 offen offset:0 sc1
 v_pk_mul_f32 v[196:197], v[196:197], v[82:83]
 v_pk_mul_f32 v[198:199], v[198:199], v[82:83]
 v_pk_mul_f32 v[204:205], v[204:205], v[82:83]
 v_pk_mul_f32 v[206:207], v[206:207], v[82:83]
 v_cvt_pk_bf16_f32 v196, v196, v197
 v_cvt_pk_bf16_f32 v197, v198, v199
 v_cvt_pk_bf16_f32 v198, v204, v205
 v_cvt_pk_bf16_f32 v199, v206, v207
 s_add_u32 s41, s57, 8192
 buffer_store_dwordx4 v[196:199], v1, s[4:7], s41 offen offset:1024 sc1
 v_pk_mul_f32 v[208:209], v[208:209], v[80:81]
 v_pk_mul_f32 v[210:211], v[210:211], v[80:81]
 v_pk_mul_f32 v[216:217], v[216:217], v[80:81]
 v_pk_mul_f32 v[218:219], v[218:219], v[80:81]
 v_cvt_pk_bf16_f32 v208, v208, v209
 v_cvt_pk_bf16_f32 v209, v210, v211
 v_cvt_pk_bf16_f32 v210, v216, v217
 v_cvt_pk_bf16_f32 v211, v218, v219
 s_add_u32 s41, s57, 8192
 buffer_store_dwordx4 v[208:211], v1, s[4:7], s41 offen offset:2048 sc1
 v_pk_mul_f32 v[212:213], v[212:213], v[82:83]
 v_pk_mul_f32 v[214:215], v[214:215], v[82:83]
 v_pk_mul_f32 v[220:221], v[220:221], v[82:83]
 v_pk_mul_f32 v[222:223], v[222:223], v[82:83]
 v_cvt_pk_bf16_f32 v212, v212, v213
 v_cvt_pk_bf16_f32 v213, v214, v215
 v_cvt_pk_bf16_f32 v214, v220, v221
 v_cvt_pk_bf16_f32 v215, v222, v223
 s_add_u32 s41, s57, 8192
 buffer_store_dwordx4 v[212:215], v1, s[4:7], s41 offen offset:3072 sc1
 v_pk_mul_f32 v[224:225], v[224:225], v[80:81]
 v_pk_mul_f32 v[226:227], v[226:227], v[80:81]
 v_pk_mul_f32 v[232:233], v[232:233], v[80:81]
 v_pk_mul_f32 v[234:235], v[234:235], v[80:81]
 v_cvt_pk_bf16_f32 v224, v224, v225
 v_cvt_pk_bf16_f32 v225, v226, v227
 v_cvt_pk_bf16_f32 v226, v232, v233
 v_cvt_pk_bf16_f32 v227, v234, v235
 s_add_u32 s41, s57, 12288
 buffer_store_dwordx4 v[224:227], v1, s[4:7], s41 offen offset:0 sc1
 v_pk_mul_f32 v[228:229], v[228:229], v[82:83]
 v_pk_mul_f32 v[230:231], v[230:231], v[82:83]
 v_pk_mul_f32 v[236:237], v[236:237], v[82:83]
 v_pk_mul_f32 v[238:239], v[238:239], v[82:83]
 v_cvt_pk_bf16_f32 v228, v228, v229
 v_cvt_pk_bf16_f32 v229, v230, v231
 v_cvt_pk_bf16_f32 v230, v236, v237
 v_cvt_pk_bf16_f32 v231, v238, v239
 s_add_u32 s41, s57, 12288
 buffer_store_dwordx4 v[228:231], v1, s[4:7], s41 offen offset:1024 sc1
 v_pk_mul_f32 v[240:241], v[240:241], v[80:81]
 v_pk_mul_f32 v[242:243], v[242:243], v[80:81]
 v_pk_mul_f32 v[248:249], v[248:249], v[80:81]
 v_pk_mul_f32 v[250:251], v[250:251], v[80:81]
 v_cvt_pk_bf16_f32 v240, v240, v241
 v_cvt_pk_bf16_f32 v241, v242, v243
 v_cvt_pk_bf16_f32 v242, v248, v249
 v_cvt_pk_bf16_f32 v243, v250, v251
 s_add_u32 s41, s57, 12288
 buffer_store_dwordx4 v[240:243], v1, s[4:7], s41 offen offset:2048 sc1
 v_pk_mul_f32 v[244:245], v[244:245], v[82:83]
 v_pk_mul_f32 v[246:247], v[246:247], v[82:83]
 v_pk_mul_f32 v[252:253], v[252:253], v[82:83]
 v_pk_mul_f32 v[254:255], v[254:255], v[82:83]
 v_cvt_pk_bf16_f32 v244, v244, v245
 v_cvt_pk_bf16_f32 v245, v246, v247
 v_cvt_pk_bf16_f32 v246, v252, v253
 v_cvt_pk_bf16_f32 v247, v254, v255
 s_add_u32 s41, s57, 12288
 buffer_store_dwordx4 v[244:247], v1, s[4:7], s41 offen offset:3072 sc1
 v_lshrrev_b32 v29, 1, v1
 buffer_store_dwordx2 v[24:25], v29, s[4:7], s58 offen sc1
 s_lshl_b32 s28, s21, 20
 s_lshl_b32 s42, s19, 14
 s_add_u32 s28, s28, s42
 s_add_u32 s28, s28, s26
 s_add_u32 s29, s28, 0x1000000
 s_waitcnt vmcnt(17)
 s_barrier
 v_add_u32 v3, s24, v7
 v_add_u32 v4, s24, v8
 v_add_u32 v5, s24, v9
 v_add_u32 v6, s24, v10
 RW 64,3,0
 RW 66,3,2048
 RW 68,4,0
 RW 70,4,2048
 RW 72,5,0
 RW 74,5,2048
 RW 76,6,0
 RW 78,6,2048
 RW 80,3,8192
 RW 82,3,10240
 RW 84,4,8192
 RW 86,4,10240
 RW 88,5,8192
 RW 90,5,10240
 s_waitcnt lgkmcnt(10)
 GAZ 128,64,0
 s_add_u32 s25, s24, 0x18000
 RW 92,6,8192
 s_and_b32 s25, s25, 0x1ffff
 GAZ 132,64,232
 s_add_u32 s24, s24, 0x8000
 RW 94,6,10240
 s_and_b32 s24, s24, 0x1ffff
 GAZ 140,68,232
 RW 96,3,16384
 GAZ 136,68,0
 s_waitcnt lgkmcnt(9)
 RW 98,3,18432
 GAZ 144,72,0
 s_add_u32 m0, s25, s27
 RW 100,4,16384
 GAZ 148,72,232
 RW 102,4,18432
 GAZ 156,76,232
 RW 104,5,16384
 GAZ 152,76,0
 s_waitcnt lgkmcnt(9)
 RW 106,5,18432
 GAZ 160,80,0
 s_add_u32 s41, s36, s37
 RW 108,6,16384
 GAZ 164,80,232
 RW 110,6,18432
 GAZ 172,84,232
 RW 112,3,24576
 GAZ 168,84,0
 s_waitcnt lgkmcnt(9)
 RW 114,3,26624
 GAZ 176,88,0
 RW 116,4,24576
 GAZ 180,88,232
 RW 118,4,26624
 GAZ 188,92,232
 RW 120,5,24576
 GAZ 184,92,0
 s_waitcnt lgkmcnt(9)
 RW 122,5,26624
 GAZ 192,96,0
 RW 124,6,24576
 GAZ 196,96,232
 RW 126,6,26624
 GAZ 204,100,232
 RW 64,3,4096
 GAZ 200,100,0
 s_waitcnt lgkmcnt(9)
 RW 66,3,6144
 DL 11,8,36,0
 GAZ 208,104,0
 RW 68,4,4096
 GAZ 212,104,232
 RW 70,4,6144
 GAZ 220,108,232
 RW 72,5,4096
 GAZ 216,108,0
 s_waitcnt lgkmcnt(9)
 RW 74,5,6144
 DL 12,8,36,1024
 GAZ 224,112,0
 RW 76,6,4096
 GAZ 228,112,232
 RW 78,6,6144
 GAZ 236,116,232
 RW 80,3,12288
 GAZ 232,116,0
 s_waitcnt lgkmcnt(9)
 RW 82,3,14336
 GAZ 240,120,0
 RW 84,4,12288
 DL 13,8,36,2048
 GAZ 244,120,232
 RW 86,4,14336
 GAZ 252,124,232
 RW 88,5,12288
 GAZ 248,124,0
 s_waitcnt lgkmcnt(9)
 RW 90,5,14336
 GA 128,64,4
 RW 92,6,12288
 DL 14,8,36,3072
 GA 132,64,236
 s_add_u32 m0, m0, 0x1000
 RW 94,6,14336
 GA 140,68,236
 RW 96,3,20480
 GA 136,68,4
 s_waitcnt lgkmcnt(9)
 RW 98,3,22528
 GA 144,72,4
 RW 100,4,20480
 GA 148,72,236
 RW 102,4,22528
 GA 156,76,236
 RW 104,5,20480
 GA 152,76,4
 s_waitcnt lgkmcnt(9)
 RW 106,5,22528
 GA 160,80,4
 RW 108,6,20480
 GA 164,80,236
 RW 110,6,22528
 DL 11,8,41,0
 GA 172,84,236
 RW 112,3,28672
 GA 168,84,4
 s_waitcnt lgkmcnt(9)
 RW 114,3,30720
 GA 176,88,4
 RW 116,4,28672
 GA 180,88,236
 RW 118,4,30720
 GA 188,92,236
 RW 120,5,28672
 DL 12,8,41,1024
 GA 184,92,4
 s_waitcnt lgkmcnt(9)
 RW 122,5,30720
 GA 192,96,4
 RW 124,6,28672
 GA 196,96,236
 RW 126,6,30720
 v_add_u32 v3, s24, v7
 GA 204,100,236
 v_add_u32 v4, s24, v8
 v_add_u32 v5, s24, v9
 v_add_u32 v6, s24, v10
 RW 64,3,0
 DL 13,8,41,2048
 GA 200,100,4
 s_waitcnt lgkmcnt(9)
 RW 66,3,2048
 GA 208,104,4
 RW 68,4,0
 GA 212,104,236
 RW 70,4,2048
 GA 220,108,236
 RW 72,5,0
 GA 216,108,4
 s_waitcnt lgkmcnt(9)
 RW 74,5,2048
 DL 14,8,41,3072
 GA 224,112,4
 s_add_u32 s36, s36, s38
 RW 76,6,0
 GA 228,112,236
 RW 78,6,2048
 GA 236,116,236
 RW 80,3,8192
 GA 232,116,4
 s_waitcnt lgkmcnt(9)
 RW 82,3,10240
 GA 240,120,4
 RW 84,4,8192
 GA 244,120,236
 RW 86,4,10240
 GA 252,124,236
 RW 88,5,8192
 GA 248,124,4
 RW 90,5,10240
 s_waitcnt vmcnt(25)
 s_barrier
 s_waitcnt lgkmcnt(10)
 GA 128,64,8
 s_add_u32 s25, s24, 0x18000
 RW 92,6,8192
 s_and_b32 s25, s25, 0x1ffff
 GA 132,64,160
 s_add_u32 s24, s24, 0x8000
 RW 94,6,10240
 s_and_b32 s24, s24, 0x1ffff
 GA 140,68,160
 RW 96,3,16384
 GA 136,68,8
 s_waitcnt lgkmcnt(9)
 RW 98,3,18432
 GA 144,72,8
 s_add_u32 m0, s25, s27
 RW 100,4,16384
 GA 148,72,160
 RW 102,4,18432
 GA 156,76,160
 RW 104,5,16384
 GA 152,76,8
 s_waitcnt lgkmcnt(9)
 RW 106,5,18432
 GA 160,80,8
 s_add_u32 s41, s36, s37
 RW 108,6,16384
 GA 164,80,160
 RW 110,6,18432
 GA 172,84,160
 RW 112,3,24576
 GA 168,84,8
 s_waitcnt lgkmcnt(9)
 RW 114,3,26624
 GA 176,88,8
 RW 116,4,24576
 GA 180,88,160
 RW 118,4,26624
 GA 188,92,160
 RW 120,5,24576
 GA 184,92,8
 s_waitcnt lgkmcnt(9)
 RW 122,5,26624
 GA 192,96,8
 RW 124,6,24576
 GA 196,96,160
 RW 126,6,26624
 GA 204,100,160
 RW 64,3,4096
 GA 200,100,8
 s_waitcnt lgkmcnt(9)
 RW 66,3,6144
 DL 11,8,36,0
 GA 208,104,8
 RW 68,4,4096
 GA 212,104,160
 RW 70,4,6144
 GA 220,108,160
 RW 72,5,4096
 GA 216,108,8
 s_waitcnt lgkmcnt(9)
 RW 74,5,6144
 DL 12,8,36,1024
 GA 224,112,8
 RW 76,6,4096
 GA 228,112,160
 RW 78,6,6144
 GA 236,116,160
 RW 80,3,12288
 GA 232,116,8
 s_waitcnt lgkmcnt(9)
 RW 82,3,14336
 GA 240,120,8
 RW 84,4,12288
 DL 13,8,36,2048
 GA 244,120,160
 RW 86,4,14336
 GA 252,124,160
 RW 88,5,12288
 GA 248,124,8
 s_waitcnt lgkmcnt(9)
 RW 90,5,14336
 GA 128,64,12
 RW 92,6,12288
 DL 14,8,36,3072
 GA 132,64,164
 s_add_u32 m0, m0, 0x1000
 RW 94,6,14336
 GA 140,68,164
 RW 96,3,20480
 GA 136,68,12
 s_waitcnt lgkmcnt(9)
 RW 98,3,22528
 GA 144,72,12
 RW 100,4,20480
 GA 148,72,164
 RW 102,4,22528
 GA 156,76,164
 RW 104,5,20480
 GA 152,76,12
 s_waitcnt lgkmcnt(9)
 RW 106,5,22528
 GA 160,80,12
 RW 108,6,20480
 GA 164,80,164
 RW 110,6,22528
 DL 11,8,41,0
 GA 172,84,164
 RW 112,3,28672
 GA 168,84,12
 s_waitcnt lgkmcnt(9)
 RW 114,3,30720
 GA 176,88,12
 RW 116,4,28672
 GA 180,88,164
 RW 118,4,30720
 GA 188,92,164
 RW 120,5,28672
 DL 12,8,41,1024
 GA 184,92,12
 s_waitcnt lgkmcnt(9)
 RW 122,5,30720
 GA 192,96,12
 RW 124,6,28672
 GA 196,96,164
 RW 126,6,30720
 v_add_u32 v3, s24, v7
 GA 204,100,164
 v_add_u32 v4, s24, v8
 v_add_u32 v5, s24, v9
 v_add_u32 v6, s24, v10
 RW 64,3,0
 DL 13,8,41,2048
 GA 200,100,12
 s_waitcnt lgkmcnt(9)
 RW 66,3,2048
 GA 208,104,12
 RW 68,4,0
 GA 212,104,164
 RW 70,4,2048
 GA 220,108,164
 RW 72,5,0
 GA 216,108,12
 s_waitcnt lgkmcnt(9)
 RW 74,5,2048
 DL 14,8,41,3072
 GA 224,112,12
 s_add_u32 s36, s36, s38
 RW 76,6,0
 GA 228,112,164
 RW 78,6,2048
 GA 236,116,164
 RW 80,3,8192
 GA 232,116,12
 s_waitcnt lgkmcnt(9)
 RW 82,3,10240
 GA 240,120,12
 RW 84,4,8192
 GA 244,120,164
 RW 86,4,10240
 GA 252,124,164
 RW 88,5,8192
 GA 248,124,12
 RW 90,5,10240
 s_waitcnt vmcnt(8)
 s_barrier
 s_cmp_eq_u32 s20, 0
 s_cbranch_scc0 mk_pf_54
 s_lshl_b32 s41, 1, s23
 s_add_u32 s42, s21, 16
 s_lshl_b32 s42, s42, 8
 v_mov_b32 v29, s42
 v_mov_b32 v30, s41
 s_mov_b64 exec, 1
 global_atomic_or v29, v30, s[96:97] sc1
 s_mov_b64 exec, -1
mk_pf_54:
 s_waitcnt lgkmcnt(10)
 GA 128,64,16
 s_add_u32 s25, s24, 0x18000
 RW 92,6,8192
 s_and_b32 s25, s25, 0x1ffff
 GA 132,64,168
 s_add_u32 s24, s24, 0x8000
 RW 94,6,10240
 s_and_b32 s24, s24, 0x1ffff
 GA 140,68,168
 RW 96,3,16384
 GA 136,68,16
 s_waitcnt lgkmcnt(9)
 RW 98,3,18432
 GA 144,72,16
 s_add_u32 m0, s25, s27
 RW 100,4,16384
 GA 148,72,168
 RW 102,4,18432
 GA 156,76,168
 RW 104,5,16384
 GA 152,76,16
 s_waitcnt lgkmcnt(9)
 RW 106,5,18432
 GA 160,80,16
 s_add_u32 s41, s36, s37
 RW 108,6,16384
 GA 164,80,168
 RW 110,6,18432
 GA 172,84,168
 RW 112,3,24576
 GA 168,84,16
 s_waitcnt lgkmcnt(9)
 RW 114,3,26624
 GA 176,88,16
 RW 116,4,24576
 GA 180,88,168
 RW 118,4,26624
 GA 188,92,168
 RW 120,5,24576
 GA 184,92,16
 s_waitcnt lgkmcnt(9)
 RW 122,5,26624
 GA 192,96,16
 RW 124,6,24576
 GA 196,96,168
 RW 126,6,26624
 GA 204,100,168
 RW 64,3,4096
 GA 200,100,16
 s_waitcnt lgkmcnt(9)
 RW 66,3,6144
 DL 11,8,36,0
 GA 208,104,16
 RW 68,4,4096
 GA 212,104,168
 RW 70,4,6144
 GA 220,108,168
 RW 72,5,4096
 GA 216,108,16
 s_waitcnt lgkmcnt(9)
 RW 74,5,6144
 DL 12,8,36,1024
 GA 224,112,16
 RW 76,6,4096
 GA 228,112,168
 RW 78,6,6144
 GA 236,116,168
 RW 80,3,12288
 GA 232,116,16
 s_waitcnt lgkmcnt(9)
 RW 82,3,14336
 GA 240,120,16
 RW 84,4,12288
 DL 13,8,36,2048
 GA 244,120,168
 RW 86,4,14336
 GA 252,124,168
 RW 88,5,12288
 GA 248,124,16
 s_waitcnt lgkmcnt(9)
 RW 90,5,14336
 GA 128,64,20
 RW 92,6,12288
 DL 14,8,36,3072
 GA 132,64,172
 s_add_u32 m0, m0, 0x1000
 RW 94,6,14336
 GA 140,68,172
 RW 96,3,20480
 GA 136,68,20
 s_waitcnt lgkmcnt(9)
 RW 98,3,22528
 GA 144,72,20
 RW 100,4,20480
 GA 148,72,172
 RW 102,4,22528
 GA 156,76,172
 RW 104,5,20480
 GA 152,76,20
 s_waitcnt lgkmcnt(9)
 RW 106,5,22528
 GA 160,80,20
 RW 108,6,20480
 GA 164,80,172
 RW 110,6,22528
 DL 11,8,41,0
 GA 172,84,172
 RW 112,3,28672
 GA 168,84,20
 s_waitcnt lgkmcnt(9)
 RW 114,3,30720
 GA 176,88,20
 RW 116,4,28672
 GA 180,88,172
 RW 118,4,30720
 GA 188,92,172
 RW 120,5,28672
 DL 12,8,41,1024
 GA 184,92,20
 s_waitcnt lgkmcnt(9)
 RW 122,5,30720
 GA 192,96,20
 RW 124,6,28672
 GA 196,96,172
 RW 126,6,30720
 v_add_u32 v3, s24, v7
 GA 204,100,172
 v_add_u32 v4, s24, v8
 v_add_u32 v5, s24, v9
 v_add_u32 v6, s24, v10
 RW 64,3,0
 DL 13,8,41,2048
 GA 200,100,20
 s_waitcnt lgkmcnt(9)
 RW 66,3,2048
 GA 208,104,20
 RW 68,4,0
 GA 212,104,172
 RW 70,4,2048
 GA 220,108,172
 RW 72,5,0
 GA 216,108,20
 s_waitcnt lgkmcnt(9)
 RW 74,5,2048
 DL 14,8,41,3072
 GA 224,112,20
 s_add_u32 s36, s36, s38
 RW 76,6,0
 GA 228,112,172
 RW 78,6,2048
 GA 236,116,172
 RW 80,3,8192
 GA 232,116,20
 s_waitcnt lgkmcnt(9)
 RW 82,3,10240
 GA 240,120,20
 RW 84,4,8192
 GA 244,120,172
 RW 86,4,10240
 GA 252,124,172
 RW 88,5,8192
 GA 248,124,20
 RW 90,5,10240
 s_waitcnt vmcnt(8)
 s_barrier
 s_waitcnt lgkmcnt(10)
 GA 128,64,24
 s_add_u32 s25, s24, 0x18000
 RW 92,6,8192
 s_and_b32 s25, s25, 0x1ffff
 GA 132,64,176
 s_add_u32 s24, s24, 0x8000
 RW 94,6,10240
 s_and_b32 s24, s24, 0x1ffff
 GA 140,68,176
 RW 96,3,16384
 GA 136,68,24
 s_waitcnt lgkmcnt(9)
 RW 98,3,18432
 GA 144,72,24
 s_add_u32 m0, s25, s27
 RW 100,4,16384
 GA 148,72,176
 RW 102,4,18432
 GA 156,76,176
 RW 104,5,16384
 GA 152,76,24
 s_waitcnt lgkmcnt(9)
 RW 106,5,18432
 GA 160,80,24
 s_add_u32 s41, s36, s37
 RW 108,6,16384
 GA 164,80,176
 RW 110,6,18432
 GA 172,84,176
 RW 112,3,24576
 GA 168,84,24
 s_waitcnt lgkmcnt(9)
 RW 114,3,26624
 GA 176,88,24
 RW 116,4,24576
 GA 180,88,176
 RW 118,4,26624
 GA 188,92,176
 RW 120,5,24576
 GA 184,92,24
 s_waitcnt lgkmcnt(9)
 RW 122,5,26624
 GA 192,96,24
 RW 124,6,24576
 GA 196,96,176
 RW 126,6,26624
 GA 204,100,176
 RW 64,3,4096
 GA 200,100,24
 s_waitcnt lgkmcnt(9)
 RW 66,3,6144
 DL 11,8,36,0
 GA 208,104,24
 RW 68,4,4096
 GA 212,104,176
 RW 70,4,6144
 GA 220,108,176
 RW 72,5,4096
 GA 216,108,24
 s_waitcnt lgkmcnt(9)
 RW 74,5,6144
 DL 12,8,36,1024
 GA 224,112,24
 RW 76,6,4096
 GA 228,112,176
 RW 78,6,6144
 GA 236,116,176
 RW 80,3,12288
 GA 232,116,24
 s_waitcnt lgkmcnt(9)
 RW 82,3,14336
 GA 240,120,24
 RW 84,4,12288
 DL 13,8,36,2048
 GA 244,120,176
 RW 86,4,14336
 GA 252,124,176
 RW 88,5,12288
 GA 248,124,24
 s_waitcnt lgkmcnt(9)
 RW 90,5,14336
 GA 128,64,28
 RW 92,6,12288
 DL 14,8,36,3072
 GA 132,64,180
 s_add_u32 m0, m0, 0x1000
 RW 94,6,14336
 GA 140,68,180
 RW 96,3,20480
 GA 136,68,28
 s_waitcnt lgkmcnt(9)
 RW 98,3,22528
 GA 144,72,28
 RW 100,4,20480
 GA 148,72,180
 RW 102,4,22528
 GA 156,76,180
 RW 104,5,20480
 GA 152,76,28
 s_waitcnt lgkmcnt(9)
 RW 106,5,22528
 GA 160,80,28
 RW 108,6,20480
 GA 164,80,180
 RW 110,6,22528
 DL 11,8,41,0
 GA 172,84,180
 RW 112,3,28672
 GA 168,84,28
 s_waitcnt lgkmcnt(9)
 RW 114,3,30720
 GA 176,88,28
 RW 116,4,28672
 GA 180,88,180
 RW 118,4,30720
 GA 188,92,180
 RW 120,5,28672
 DL 12,8,41,1024
 GA 184,92,28
 s_waitcnt lgkmcnt(9)
 RW 122,5,30720
 GA 192,96,28
 RW 124,6,28672
 GA 196,96,180
 RW 126,6,30720
 v_add_u32 v3, s24, v7
 GA 204,100,180
 v_add_u32 v4, s24, v8
 v_add_u32 v5, s24, v9
 v_add_u32 v6, s24, v10
 RW 64,3,0
 DL 13,8,41,2048
 GA 200,100,28
 s_waitcnt lgkmcnt(9)
 RW 66,3,2048
 GA 208,104,28
 RW 68,4,0
 GA 212,104,180
 RW 70,4,2048
 GA 220,108,180
 RW 72,5,0
 GA 216,108,28
 s_waitcnt lgkmcnt(9)
 RW 74,5,2048
 DL 14,8,41,3072
 GA 224,112,28
 s_add_u32 s36, s36, s38
 RW 76,6,0
 GA 228,112,180
 RW 78,6,2048
 GA 236,116,180
 RW 80,3,8192
 GA 232,116,28
 s_waitcnt lgkmcnt(9)
 RW 82,3,10240
 GA 240,120,28
 RW 84,4,8192
 GA 244,120,180
 RW 86,4,10240
 GA 252,124,180
 RW 88,5,8192
 GA 248,124,28
 RW 90,5,10240
 s_waitcnt vmcnt(8)
 s_barrier
 s_waitcnt lgkmcnt(10)
 GA 128,64,208
 s_add_u32 s25, s24, 0x18000
 RW 92,6,8192
 s_and_b32 s25, s25, 0x1ffff
 GA 132,64,184
 s_add_u32 s24, s24, 0x8000
 RW 94,6,10240
 s_and_b32 s24, s24, 0x1ffff
 GA 140,68,184
 RW 96,3,16384
 GA 136,68,208
 s_waitcnt lgkmcnt(9)
 RW 98,3,18432
 GA 144,72,208
 s_add_u32 m0, s25, s26
 RW 100,4,16384
 GA 148,72,184
 RW 102,4,18432
 GA 156,76,184
 RW 104,5,16384
 GA 152,76,208
 s_waitcnt lgkmcnt(9)
 RW 106,5,18432
 GA 160,80,208
 RW 108,6,16384
 GA 164,80,184
 RW 110,6,18432
 GA 172,84,184
 RW 112,3,24576
 GA 168,84,208
 s_waitcnt lgkmcnt(9)
 RW 114,3,26624
 GA 176,88,208
 RW 116,4,24576
 GA 180,88,184
 RW 118,4,26624
 GA 188,92,184
 RW 120,5,24576
 DL 1,4,28,0
 GA 184,92,208
 s_waitcnt lgkmcnt(9)
 RW 122,5,26624
 GA 192,96,208
 RW 124,6,24576
 GA 196,96,184
 RW 126,6,26624
 GA 204,100,184
 RW 64,3,4096
 GA 200,100,208
 s_waitcnt lgkmcnt(9)
 RW 66,3,6144
 DL 1,4,28,1024
 GA 208,104,208
 RW 68,4,4096
 GA 212,104,184
 RW 70,4,6144
 GA 220,108,184
 RW 72,5,4096
 GA 216,108,208
 s_waitcnt lgkmcnt(9)
 RW 74,5,6144
 DL 1,4,28,2048
 GA 224,112,208
 RW 76,6,4096
 GA 228,112,184
 RW 78,6,6144
 GA 236,116,184
 RW 80,3,12288
 GA 232,116,208
 s_waitcnt lgkmcnt(9)
 RW 82,3,14336
 GA 240,120,208
 RW 84,4,12288
 DL 1,4,28,3072
 GA 244,120,184
 s_add_u32 s28, s28, 0x4000
 RW 86,4,14336
 GA 252,124,184
 RW 88,5,12288
 GA 248,124,208
 s_waitcnt lgkmcnt(9)
 RW 90,5,14336
 GA 128,64,212
 RW 92,6,12288
 GA 132,64,188
 RW 94,6,14336
 GA 140,68,188
 RW 96,3,20480
 GA 136,68,212
 s_waitcnt lgkmcnt(9)
 RW 98,3,22528
 GA 144,72,212
 RW 100,4,20480
 GA 148,72,188
 RW 102,4,22528
 GA 156,76,188
 RW 104,5,20480
 GA 152,76,212
 s_waitcnt lgkmcnt(9)
 RW 106,5,22528
 GA 160,80,212
 RW 108,6,20480
 GA 164,80,188
 RW 110,6,22528
 GA 172,84,188
 RW 112,3,28672
 GA 168,84,212
 s_waitcnt lgkmcnt(9)
 RW 114,3,30720
 GA 176,88,212
 RW 116,4,28672
 GA 180,88,188
 RW 118,4,30720
 GA 188,92,188
 RW 120,5,28672
 GA 184,92,212
 s_waitcnt lgkmcnt(9)
 RW 122,5,30720
 GA 192,96,212
 RW 124,6,28672
 GA 196,96,188
 RW 126,6,30720
 v_add_u32 v3, s24, v7
 GA 204,100,188
 v_add_u32 v4, s24, v8
 v_add_u32 v5, s24, v9
 v_add_u32 v6, s24, v10
 RW 64,3,0
 GA 200,100,212
 s_waitcnt lgkmcnt(9)
 RW 66,3,2048
 GA 208,104,212
 RW 68,4,0
 GA 212,104,188
 RW 70,4,2048
 GA 220,108,188
 RW 72,5,0
 GA 216,108,212
 s_waitcnt lgkmcnt(9)
 RW 74,5,2048
 GA 224,112,212
 RW 76,6,0
 GA 228,112,188
 RW 78,6,2048
 GA 236,116,188
 RW 80,3,8192
 GA 232,116,212
 s_waitcnt lgkmcnt(9)
 RW 82,3,10240
 GA 240,120,212
 RW 84,4,8192
 GA 244,120,188
 RW 86,4,10240
 GA 252,124,188
 RW 88,5,8192
 GA 248,124,212
 RW 90,5,10240
 s_waitcnt vmcnt(4)
 s_barrier
 s_waitcnt lgkmcnt(10)
 GA 128,64,216
 s_add_u32 s25, s24, 0x18000
 RW 92,6,8192
 s_and_b32 s25, s25, 0x1ffff
 GA 132,64,192
 s_add_u32 s24, s24, 0x8000
 RW 94,6,10240
 s_and_b32 s24, s24, 0x1ffff
 GA 140,68,192
 RW 96,3,16384
 GA 136,68,216
 s_waitcnt lgkmcnt(9)
 RW 98,3,18432
 GA 144,72,216
 s_add_u32 m0, s25, s26
 RW 100,4,16384
 GA 148,72,192
 RW 102,4,18432
 GA 156,76,192
 RW 104,5,16384
 GA 152,76,216
 s_waitcnt lgkmcnt(9)
 RW 106,5,18432
 GA 160,80,216
 RW 108,6,16384
 GA 164,80,192
 RW 110,6,18432
 GA 172,84,192
 RW 112,3,24576
 GA 168,84,216
 s_waitcnt lgkmcnt(9)
 RW 114,3,26624
 GA 176,88,216
 RW 116,4,24576
 GA 180,88,192
 RW 118,4,26624
 GA 188,92,192
 RW 120,5,24576
 DL 1,4,28,0
 GA 184,92,216
 s_waitcnt lgkmcnt(9)
 RW 122,5,26624
 GA 192,96,216
 RW 124,6,24576
 GA 196,96,192
 RW 126,6,26624
 GA 204,100,192
 RW 64,3,4096
 GA 200,100,216
 s_waitcnt lgkmcnt(9)
 RW 66,3,6144
 DL 1,4,28,1024
 GA 208,104,216
 RW 68,4,4096
 GA 212,104,192
 RW 70,4,6144
 GA 220,108,192
 RW 72,5,4096
 GA 216,108,216
 s_waitcnt lgkmcnt(9)
 RW 74,5,6144
 DL 1,4,28,2048
 GA 224,112,216
 RW 76,6,4096
 GA 228,112,192
 RW 78,6,6144
 GA 236,116,192
 RW 80,3,12288
 GA 232,116,216
 s_waitcnt lgkmcnt(9)
 RW 82,3,14336
 GA 240,120,216
 RW 84,4,12288
 DL 1,4,28,3072
 GA 244,120,192
 s_add_u32 s28, s28, 0x4000
 RW 86,4,14336
 GA 252,124,192
 RW 88,5,12288
 GA 248,124,216
 s_waitcnt lgkmcnt(9)
 RW 90,5,14336
 s_add_u32 m0, s25, s18
 GA 128,64,220
 RW 92,6,12288
 GA 132,64,196
 RW 94,6,14336
 GA 140,68,196
 RW 96,3,20480
 GA 136,68,220
 s_waitcnt lgkmcnt(9)
 RW 98,3,22528
 GA 144,72,220
 RW 100,4,20480
 GA 148,72,196
 RW 102,4,22528
 GA 156,76,196
 RW 104,5,20480
 GA 152,76,220
 s_waitcnt lgkmcnt(9)
 RW 106,5,22528
 GA 160,80,220
 RW 108,6,20480
 GA 164,80,196
 RW 110,6,22528
 DL 1,4,29,0
 GA 172,84,196
 RW 112,3,28672
 GA 168,84,220
 s_waitcnt lgkmcnt(9)
 RW 114,3,30720
 GA 176,88,220
 RW 116,4,28672
 GA 180,88,196
 RW 118,4,30720
 GA 188,92,196
 RW 120,5,28672
 DL 1,4,29,1024
 GA 184,92,220
 s_waitcnt lgkmcnt(9)
 RW 122,5,30720
 GA 192,96,220
 RW 124,6,28672
 GA 196,96,196
 RW 126,6,30720
 v_add_u32 v3, s24, v7
 GA 204,100,196
 v_add_u32 v4, s24, v8
 v_add_u32 v5, s24, v9
 v_add_u32 v6, s24, v10
 RW 64,3,0
 DL 1,4,29,2048
 GA 200,100,220
 s_waitcnt lgkmcnt(9)
 RW 66,3,2048
 GA 208,104,220
 RW 68,4,0
 GA 212,104,196
 RW 70,4,2048
 GA 220,108,196
 RW 72,5,0
 GA 216,108,220
 s_waitcnt lgkmcnt(9)
 RW 74,5,2048
 DL 1,4,29,3072
 GA 224,112,220
 s_add_u32 s29, s29, 0x4000
 RW 76,6,0
 GA 228,112,196
 RW 78,6,2048
 GA 236,116,196
 RW 80,3,8192
 GA 232,116,220
 s_waitcnt lgkmcnt(9)
 RW 82,3,10240
 GA 240,120,220
 RW 84,4,8192
 GA 244,120,196
 RW 86,4,10240
 GA 252,124,196
 RW 88,5,8192
 GA 248,124,220
 RW 90,5,10240
 s_waitcnt vmcnt(8)
 s_barrier
 s_waitcnt lgkmcnt(10)
 GA 128,64,224
 s_add_u32 s25, s24, 0x18000
 RW 92,6,8192
 s_and_b32 s25, s25, 0x1ffff
 GA 132,64,200
 s_add_u32 s24, s24, 0x8000
 RW 94,6,10240
 s_and_b32 s24, s24, 0x1ffff
 GA 140,68,200
 RW 96,3,16384
 GA 136,68,224
 s_waitcnt lgkmcnt(9)
 RW 98,3,18432
 GA 144,72,224
 s_add_u32 m0, s25, s26
 RW 100,4,16384
 GA 148,72,200
 RW 102,4,18432
 GA 156,76,200
 RW 104,5,16384
 GA 152,76,224
 s_waitcnt lgkmcnt(9)
 RW 106,5,18432
 GA 160,80,224
 RW 108,6,16384
 GA 164,80,200
 RW 110,6,18432
 GA 172,84,200
 RW 112,3,24576
 GA 168,84,224
 s_waitcnt lgkmcnt(9)
 RW 114,3,26624
 GA 176,88,224
 RW 116,4,24576
 GA 180,88,200
 RW 118,4,26624
 GA 188,92,200
 RW 120,5,24576
 DL 1,4,28,0
 GA 184,92,224
 s_waitcnt lgkmcnt(9)
 RW 122,5,26624
 GA 192,96,224
 RW 124,6,24576
 GA 196,96,200
 RW 126,6,26624
 GA 204,100,200
 RW 64,3,4096
 GA 200,100,224
 s_waitcnt lgkmcnt(9)
 RW 66,3,6144
 DL 1,4,28,1024
 GA 208,104,224
 RW 68,4,4096
 GA 212,104,200
 RW 70,4,6144
 GA 220,108,200
 RW 72,5,4096
 GA 216,108,224
 s_waitcnt lgkmcnt(9)
 RW 74,5,6144
 DL 1,4,28,2048
 GA 224,112,224
 RW 76,6,4096
 GA 228,112,200
 RW 78,6,6144
 GA 236,116,200
 RW 80,3,12288
 GA 232,116,224
 s_waitcnt lgkmcnt(9)
 RW 82,3,14336
 GA 240,120,224
 RW 84,4,12288
 DL 1,4,28,3072
 GA 244,120,200
 s_add_u32 s28, s28, 0x4000
 RW 86,4,14336
 GA 252,124,200
 RW 88,5,12288
 GA 248,124,224
 s_waitcnt lgkmcnt(9)
 RW 90,5,14336
 s_add_u32 m0, s25, s18
 GA 128,64,228
 RW 92,6,12288
 GA 132,64,204
 RW 94,6,14336
 GA 140,68,204
 RW 96,3,20480
 GA 136,68,228
 s_waitcnt lgkmcnt(9)
 RW 98,3,22528
 GA 144,72,228
 RW 100,4,20480
 GA 148,72,204
 RW 102,4,22528
 GA 156,76,204
 RW 104,5,20480
 GA 152,76,228
 s_waitcnt lgkmcnt(9)
 RW 106,5,22528
 GA 160,80,228
 RW 108,6,20480
 GA 164,80,204
 RW 110,6,22528
 DL 1,4,29,0
 GA 172,84,204
 RW 112,3,28672
 GA 168,84,228
 s_waitcnt lgkmcnt(9)
 RW 114,3,30720
 GA 176,88,228
 RW 116,4,28672
 GA 180,88,204
 RW 118,4,30720
 GA 188,92,204
 RW 120,5,28672
 DL 1,4,29,1024
 GA 184,92,228
 s_waitcnt lgkmcnt(9)
 RW 122,5,30720
 GA 192,96,228
 RW 124,6,28672
 GA 196,96,204
 RW 126,6,30720
 v_add_u32 v2, s24, v1
 GA 204,100,204
 RC 64,2,0
 DL 1,4,29,2048
 GA 200,100,228
 s_waitcnt lgkmcnt(9)
 DL 1,4,29,3072
 GA 208,104,228
 RC 68,2,8192
 GA 212,104,204
 s_add_u32 s29, s29, 0x4000
 GA 220,108,204
 RC 72,2,1024
 GA 216,108,228
 s_waitcnt lgkmcnt(7)
 GA 224,112,228
 RC 76,2,9216
 GA 228,112,204
 GA 236,116,204
 RC 80,2,2048
 GA 232,116,228
 s_waitcnt lgkmcnt(5)
 GA 240,120,228
 RC 84,2,10240
 GA 244,120,204
 GA 252,124,204
 RC 88,2,3072
 RC 92,2,11264
 RC 96,2,4096
 RC 100,2,12288
 RC 104,2,5120
 RC 108,2,13312
 RC 112,2,6144
 RC 116,2,14336
 GA 248,124,228
 s_branch mk_att
mk_rs_22:
 s_call_b64 s[46:47], mk_rare0
 s_branch mk_rs_22_ret
mk_rs_23:
 s_call_b64 s[46:47], mk_rare1
 s_branch mk_rs_23_ret
mk_rs_24:
 s_call_b64 s[46:47], mk_rare0
 s_branch mk_rs_24_ret
mk_rs_25:
 s_call_b64 s[46:47], mk_rare0
 s_branch mk_rs_25_ret
mk_rs_26:
 s_call_b64 s[46:47], mk_rare1
 s_branch mk_rs_26_ret
mk_rs_27:
 s_call_b64 s[46:47], mk_rare1
 s_branch mk_rs_27_ret
mk_rs_29:
 s_call_b64 s[46:47], mk_rare0
 s_branch mk_rs_29_ret
mk_rs_30:
 s_call_b64 s[46:47], mk_rare0
 s_branch mk_rs_30_ret
mk_rs_32:
 s_call_b64 s[46:47], mk_rare1
 s_branch mk_rs_32_ret
mk_rare0:
 s_nop 7
 s_nop 3
 v_max3_f32 v64, v96, v97, v98
 v_max3_f32 v64, v64, v99, v104
 v_max3_f32 v64, v64, v105, v106
 v_max_f32 v64, v64, v107
 v_mov_b32 v66, v64
 s_nop 1
 v_permlane16_swap_b32 v66, v64
 v_max_f32 v64, v64, v66
 v_mov_b32 v66, v64
 s_nop 1
 v_permlane32_swap_b32 v66, v64
 v_max_f32 v64, v64, v66
 v_max_f32 v64, s34, v64
 v_sub_f32 v96, v96, v64
 v_sub_f32 v97, v97, v64
 v_sub_f32 v98, v98, v64
 v_sub_f32 v99, v99, v64
 v_sub_f32 v104, v104, v64
 v_sub_f32 v105, v105, v64
 v_sub_f32 v106, v106, v64
 v_sub_f32 v107, v107, v64
 v_sub_f32 v112, v112, v64
 v_sub_f32 v113, v113, v64
 v_sub_f32 v114, v114, v64
 v_sub_f32 v115, v115, v64
 v_sub_f32 v120, v120, v64
 v_sub_f32 v121, v121, v64
 v_sub_f32 v122, v122, v64
 v_sub_f32 v123, v123, v64
 v_sub_f32 v32, v32, v64
 v_sub_f32 v33, v33, v64
 v_sub_f32 v34, v34, v64
 v_sub_f32 v35, v35, v64
 v_max3_f32 v65, v100, v101, v102
 v_max3_f32 v65, v65, v103, v108
 v_max3_f32 v65, v65, v109, v110
 v_max_f32 v65, v65, v111
 v_mov_b32 v66, v65
 s_nop 1
 v_permlane16_swap_b32 v66, v65
 v_max_f32 v65, v65, v66
 v_mov_b32 v66, v65
 s_nop 1
 v_permlane32_swap_b32 v66, v65
 v_max_f32 v65, v65, v66
 v_max_f32 v65, s34, v65
 v_sub_f32 v100, v100, v65
 v_sub_f32 v101, v101, v65
 v_sub_f32 v102, v102, v65
 v_sub_f32 v103, v103, v65
 v_sub_f32 v108, v108, v65
 v_sub_f32 v109, v109, v65
 v_sub_f32 v110, v110, v65
 v_sub_f32 v111, v111, v65
 v_sub_f32 v116, v116, v65
 v_sub_f32 v117, v117, v65
 v_sub_f32 v118, v118, v65
 v_sub_f32 v119, v119, v65
 v_sub_f32 v124, v124, v65
 v_sub_f32 v125, v125, v65
 v_sub_f32 v126, v126, v65
 v_sub_f32 v127, v127, v65
 v_sub_f32 v36, v36, v65
 v_sub_f32 v37, v37, v65
 v_sub_f32 v38, v38, v65
 v_sub_f32 v39, v39, v65
 s_cmp_lg_u32 s34, 0
 s_cbranch_scc1 mk_rf_55
 v_sub_f32 v66, 0, v64
 v_exp_f32 v66, v66
 s_nop 0
 v_mul_f32 v24, v24, v66
 v_mul_f32 v128, v128, v66
 v_mul_f32 v129, v129, v66
 v_mul_f32 v130, v130, v66
 v_mul_f32 v131, v131, v66
 v_mul_f32 v136, v136, v66
 v_mul_f32 v137, v137, v66
 v_mul_f32 v138, v138, v66
 v_mul_f32 v139, v139, v66
 v_mul_f32 v144, v144, v66
 v_mul_f32 v145, v145, v66
 v_mul_f32 v146, v146, v66
 v_mul_f32 v147, v147, v66
 v_mul_f32 v152, v152, v66
 v_mul_f32 v153, v153, v66
 v_mul_f32 v154, v154, v66
 v_mul_f32 v155, v155, v66
 v_mul_f32 v160, v160, v66
 v_mul_f32 v161, v161, v66
 v_mul_f32 v162, v162, v66
 v_mul_f32 v163, v163, v66
 v_mul_f32 v168, v168, v66
 v_mul_f32 v169, v169, v66
 v_mul_f32 v170, v170, v66
 v_mul_f32 v171, v171, v66
 v_mul_f32 v176, v176, v66
 v_mul_f32 v177, v177, v66
 v_mul_f32 v178, v178, v66
 v_mul_f32 v179, v179, v66
 v_mul_f32 v184, v184, v66
 v_mul_f32 v185, v185, v66
 v_mul_f32 v186, v186, v66
 v_mul_f32 v187, v187, v66
 v_mul_f32 v192, v192, v66
 v_mul_f32 v193, v193, v66
 v_mul_f32 v194, v194, v66
 v_mul_f32 v195, v195, v66
 v_mul_f32 v200, v200, v66
 v_mul_f32 v201, v201, v66
 v_mul_f32 v202, v202, v66
 v_mul_f32 v203, v203, v66
 v_mul_f32 v208, v208, v66
 v_mul_f32 v209, v209, v66
 v_mul_f32 v210, v210, v66
 v_mul_f32 v211, v211, v66
 v_mul_f32 v216, v216, v66
 v_mul_f32 v217, v217, v66
 v_mul_f32 v218, v218, v66
 v_mul_f32 v219, v219, v66
 v_mul_f32 v224, v224, v66
 v_mul_f32 v225, v225, v66
 v_mul_f32 v226, v226, v66
 v_mul_f32 v227, v227, v66
 v_mul_f32 v232, v232, v66
 v_mul_f32 v233, v233, v66
 v_mul_f32 v234, v234, v66
 v_mul_f32 v235, v235, v66
 v_mul_f32 v240, v240, v66
 v_mul_f32 v241, v241, v66
 v_mul_f32 v242, v242, v66
 v_mul_f32 v243, v243, v66
 v_mul_f32 v248, v248, v66
 v_mul_f32 v249, v249, v66
 v_mul_f32 v250, v250, v66
 v_mul_f32 v251, v251, v66
 v_sub_f32 v66, 0, v65
 v_exp_f32 v66, v66
 s_nop 0
 v_mul_f32 v25, v25, v66
 v_mul_f32 v132, v132, v66
 v_mul_f32 v133, v133, v66
 v_mul_f32 v134, v134, v66
 v_mul_f32 v135, v135, v66
 v_mul_f32 v140, v140, v66
 v_mul_f32 v141, v141, v66
 v_mul_f32 v142, v142, v66
 v_mul_f32 v143, v143, v66
 v_mul_f32 v148, v148, v66
 v_mul_f32 v149, v149, v66
 v_mul_f32 v150, v150, v66
 v_mul_f32 v151, v151, v66
 v_mul_f32 v156, v156, v66
 v_mul_f32 v157, v157, v66
 v_mul_f32 v158, v158, v66
 v_mul_f32 v159, v159, v66
 v_mul_f32 v164, v164, v66
 v_mul_f32 v165, v165, v66
 v_mul_f32 v166, v166, v66
 v_mul_f32 v167, v167, v66
 v_mul_f32 v172, v172, v66
 v_mul_f32 v173, v173, v66
 v_mul_f32 v174, v174, v66
 v_mul_f32 v175, v175, v66
 v_mul_f32 v180, v180, v66
 v_mul_f32 v181, v181, v66
 v_mul_f32 v182, v182, v66
 v_mul_f32 v183, v183, v66
 v_mul_f32 v188, v188, v66
 v_mul_f32 v189, v189, v66
 v_mul_f32 v190, v190, v66
 v_mul_f32 v191, v191, v66
 v_mul_f32 v196, v196, v66
 v_mul_f32 v197, v197, v66
 v_mul_f32 v198, v198, v66
 v_mul_f32 v199, v199, v66
 v_mul_f32 v204, v204, v66
 v_mul_f32 v205, v205, v66
 v_mul_f32 v206, v206, v66
 v_mul_f32 v207, v207, v66
 v_mul_f32 v212, v212, v66
 v_mul_f32 v213, v213, v66
 v_mul_f32 v214, v214, v66
 v_mul_f32 v215, v215, v66
 v_mul_f32 v220, v220, v66
 v_mul_f32 v221, v221, v66
 v_mul_f32 v222, v222, v66
 v_mul_f32 v223, v223, v66
 v_mul_f32 v228, v228, v66
 v_mul_f32 v229, v229, v66
 v_mul_f32 v230, v230, v66
 v_mul_f32 v231, v231, v66
 v_mul_f32 v236, v236, v66
 v_mul_f32 v237, v237, v66
 v_mul_f32 v238, v238, v66
 v_mul_f32 v239, v239, v66
 v_mul_f32 v244, v244, v66
 v_mul_f32 v245, v245, v66
 v_mul_f32 v246, v246, v66
 v_mul_f32 v247, v247, v66
 v_mul_f32 v252, v252, v66
 v_mul_f32 v253, v253, v66
 v_mul_f32 v254, v254, v66
 v_mul_f32 v255, v255, v66
mk_rf_55:
 s_mov_b32 s34, 0
 s_mov_b64 s[32:33], 0
 v_exp_f32 v48, v96
 v_exp_f32 v49, v97
 v_exp_f32 v50, v98
 v_exp_f32 v51, v99
 v_exp_f32 v56, v104
 v_exp_f32 v57, v105
 v_exp_f32 v58, v106
 v_exp_f32 v59, v107
 v_exp_f32 v52, v100
 v_exp_f32 v53, v101
 v_exp_f32 v54, v102
 v_exp_f32 v55, v103
 v_exp_f32 v60, v108
 v_exp_f32 v61, v109
 v_exp_f32 v62, v110
 v_exp_f32 v63, v111
 s_nop 0
 v_add_f32 v26, v48, v49
 v_add_f32 v26, v26, v50
 v_add_f32 v26, v26, v51
 v_add_f32 v26, v26, v56
 v_add_f32 v26, v26, v57
 v_add_f32 v26, v26, v58
 v_add_f32 v26, v26, v59
 v_cvt_pk_bf16_f32 v40, v48, v49
 v_cvt_pk_bf16_f32 v41, v50, v51
 v_cvt_pk_bf16_f32 v42, v56, v57
 v_cvt_pk_bf16_f32 v43, v58, v59
 v_add_f32 v27, v52, v53
 v_add_f32 v27, v27, v54
 v_add_f32 v27, v27, v55
 v_add_f32 v27, v27, v60
 v_add_f32 v27, v27, v61
 v_add_f32 v27, v27, v62
 v_add_f32 v27, v27, v63
 v_cvt_pk_bf16_f32 v44, v52, v53
 v_cvt_pk_bf16_f32 v45, v54, v55
 v_cvt_pk_bf16_f32 v46, v60, v61
 v_cvt_pk_bf16_f32 v47, v62, v63
 s_nop 1
 s_setpc_b64 s[46:47]
mk_rare1:
 s_nop 7
 s_nop 3
 v_max3_f32 v64, v112, v113, v114
 v_max3_f32 v64, v64, v115, v120
 v_max3_f32 v64, v64, v121, v122
 v_max_f32 v64, v64, v123
 v_mov_b32 v66, v64
 s_nop 1
 v_permlane16_swap_b32 v66, v64
 v_max_f32 v64, v64, v66
 v_mov_b32 v66, v64
 s_nop 1
 v_permlane32_swap_b32 v66, v64
 v_max_f32 v64, v64, v66
 v_max_f32 v64, s34, v64
 v_sub_f32 v112, v112, v64
 v_sub_f32 v113, v113, v64
 v_sub_f32 v114, v114, v64
 v_sub_f32 v115, v115, v64
 v_sub_f32 v120, v120, v64
 v_sub_f32 v121, v121, v64
 v_sub_f32 v122, v122, v64
 v_sub_f32 v123, v123, v64
 v_sub_f32 v96, v96, v64
 v_sub_f32 v97, v97, v64
 v_sub_f32 v98, v98, v64
 v_sub_f32 v99, v99, v64
 v_sub_f32 v104, v104, v64
 v_sub_f32 v105, v105, v64
 v_sub_f32 v106, v106, v64
 v_sub_f32 v107, v107, v64
 v_sub_f32 v32, v32, v64
 v_sub_f32 v33, v33, v64
 v_sub_f32 v34, v34, v64
 v_sub_f32 v35, v35, v64
 v_max3_f32 v65, v116, v117, v118
 v_max3_f32 v65, v65, v119, v124
 v_max3_f32 v65, v65, v125, v126
 v_max_f32 v65, v65, v127
 v_mov_b32 v66, v65
 s_nop 1
 v_permlane16_swap_b32 v66, v65
 v_max_f32 v65, v65, v66
 v_mov_b32 v66, v65
 s_nop 1
 v_permlane32_swap_b32 v66, v65
 v_max_f32 v65, v65, v66
 v_max_f32 v65, s34, v65
 v_sub_f32 v116, v116, v65
 v_sub_f32 v117, v117, v65
 v_sub_f32 v118, v118, v65
 v_sub_f32 v119, v119, v65
 v_sub_f32 v124, v124, v65
 v_sub_f32 v125, v125, v65
 v_sub_f32 v126, v126, v65
 v_sub_f32 v127, v127, v65
 v_sub_f32 v100, v100, v65
 v_sub_f32 v101, v101, v65
 v_sub_f32 v102, v102, v65
 v_sub_f32 v103, v103, v65
 v_sub_f32 v108, v108, v65
 v_sub_f32 v109, v109, v65
 v_sub_f32 v110, v110, v65
 v_sub_f32 v111, v111, v65
 v_sub_f32 v36, v36, v65
 v_sub_f32 v37, v37, v65
 v_sub_f32 v38, v38, v65
 v_sub_f32 v39, v39, v65
 s_cmp_lg_u32 s34, 0
 s_cbranch_scc1 mk_rf_56
 v_sub_f32 v66, 0, v64
 v_exp_f32 v66, v66
 s_nop 0
 v_mul_f32 v24, v24, v66
 v_mul_f32 v128, v128, v66
 v_mul_f32 v129, v129, v66
 v_mul_f32 v130, v130, v66
 v_mul_f32 v131, v131, v66
 v_mul_f32 v136, v136, v66
 v_mul_f32 v137, v137, v66
 v_mul_f32 v138, v138, v66
 v_mul_f32 v139, v139, v66
 v_mul_f32 v144, v144, v66
 v_mul_f32 v145, v145, v66
 v_mul_f32 v146, v146, v66
 v_mul_f32 v147, v147, v66
 v_mul_f32 v152, v152, v66
 v_mul_f32 v153, v153, v66
 v_mul_f32 v154, v154, v66
 v_mul_f32 v155, v155, v66
 v_mul_f32 v160, v160, v66
 v_mul_f32 v161, v161, v66
 v_mul_f32 v162, v162, v66
 v_mul_f32 v163, v163, v66
 v_mul_f32 v168, v168, v66
 v_mul_f32 v169, v169, v66
 v_mul_f32 v170, v170, v66
 v_mul_f32 v171, v171, v66
 v_mul_f32 v176, v176, v66
 v_mul_f32 v177, v177, v66
 v_mul_f32 v178, v178, v66
 v_mul_f32 v179, v179, v66
 v_mul_f32 v184, v184, v66
 v_mul_f32 v185, v185, v66
 v_mul_f32 v186, v186, v66
 v_mul_f32 v187, v187, v66
 v_mul_f32 v192, v192, v66
 v_mul_f32 v193, v193, v66
 v_mul_f32 v194, v194, v66
 v_mul_f32 v195, v195, v66
 v_mul_f32 v200, v200, v66
 v_mul_f32 v201, v201, v66
 v_mul_f32 v202, v202, v66
 v_mul_f32 v203, v203, v66
 v_mul_f32 v208, v208, v66
 v_mul_f32 v209, v209, v66
 v_mul_f32 v210, v210, v66
 v_mul_f32 v211, v211, v66
 v_mul_f32 v216, v216, v66
 v_mul_f32 v217, v217, v66
 v_mul_f32 v218, v218, v66
 v_mul_f32 v219, v219, v66
 v_mul_f32 v224, v224, v66
 v_mul_f32 v225, v225, v66
 v_mul_f32 v226, v226, v66
 v_mul_f32 v227, v227, v66
 v_mul_f32 v232, v232, v66
 v_mul_f32 v233, v233, v66
 v_mul_f32 v234, v234, v66
 v_mul_f32 v235, v235, v66
 v_mul_f32 v240, v240, v66
 v_mul_f32 v241, v241, v66
 v_mul_f32 v242, v242, v66
 v_mul_f32 v243, v243, v66
 v_mul_f32 v248, v248, v66
 v_mul_f32 v249, v249, v66
 v_mul_f32 v250, v250, v66
 v_mul_f32 v251, v251, v66
 v_sub_f32 v66, 0, v65
 v_exp_f32 v66, v66
 s_nop 0
 v_mul_f32 v25, v25, v66
 v_mul_f32 v132, v132, v66
 v_mul_f32 v133, v133, v66
 v_mul_f32 v134, v134, v66
 v_mul_f32 v135, v135, v66
 v_mul_f32 v140, v140, v66
 v_mul_f32 v141, v141, v66
 v_mul_f32 v142, v142, v66
 v_mul_f32 v143, v143, v66
 v_mul_f32 v148, v148, v66
 v_mul_f32 v149, v149, v66
 v_mul_f32 v150, v150, v66
 v_mul_f32 v151, v151, v66
 v_mul_f32 v156, v156, v66
 v_mul_f32 v157, v157, v66
 v_mul_f32 v158, v158, v66
 v_mul_f32 v159, v159, v66
 v_mul_f32 v164, v164, v66
 v_mul_f32 v165, v165, v66
 v_mul_f32 v166, v166, v66
 v_mul_f32 v167, v167, v66
 v_mul_f32 v172, v172, v66
 v_mul_f32 v173, v173, v66
 v_mul_f32 v174, v174, v66
 v_mul_f32 v175, v175, v66
 v_mul_f32 v180, v180, v66
 v_mul_f32 v181, v181, v66
 v_mul_f32 v182, v182, v66
 v_mul_f32 v183, v183, v66
 v_mul_f32 v188, v188, v66
 v_mul_f32 v189, v189, v66
 v_mul_f32 v190, v190, v66
 v_mul_f32 v191, v191, v66
 v_mul_f32 v196, v196, v66
 v_mul_f32 v197, v197, v66
 v_mul_f32 v198, v198, v66
 v_mul_f32 v199, v199, v66
 v_mul_f32 v204, v204, v66
 v_mul_f32 v205, v205, v66
 v_mul_f32 v206, v206, v66
 v_mul_f32 v207, v207, v66
 v_mul_f32 v212, v212, v66
 v_mul_f32 v213, v213, v66
 v_mul_f32 v214, v214, v66
 v_mul_f32 v215, v215, v66
 v_mul_f32 v220, v220, v66
 v_mul_f32 v221, v221, v66
 v_mul_f32 v222, v222, v66
 v_mul_f32 v223, v223, v66
 v_mul_f32 v228, v228, v66
 v_mul_f32 v229, v229, v66
 v_mul_f32 v230, v230, v66
 v_mul_f32 v231, v231, v66
 v_mul_f32 v236, v236, v66
 v_mul_f32 v237, v237, v66
 v_mul_f32 v238, v238, v66
 v_mul_f32 v239, v239, v66
 v_mul_f32 v244, v244, v66
 v_mul_f32 v245, v245, v66
 v_mul_f32 v246, v246, v66
 v_mul_f32 v247, v247, v66
 v_mul_f32 v252, v252, v66
 v_mul_f32 v253, v253, v66
 v_mul_f32 v254, v254, v66
 v_mul_f32 v255, v255, v66
mk_rf_56:
 s_mov_b32 s34, 0
 s_mov_b64 s[32:33], 0
 v_exp_f32 v48, v112
 v_exp_f32 v49, v113
 v_exp_f32 v50, v114
 v_exp_f32 v51, v115
 v_exp_f32 v56, v120
 v_exp_f32 v57, v121
 v_exp_f32 v58, v122
 v_exp_f32 v59, v123
 v_exp_f32 v52, v116
 v_exp_f32 v53, v117
 v_exp_f32 v54, v118
 v_exp_f32 v55, v119
 v_exp_f32 v60, v124
 v_exp_f32 v61, v125
 v_exp_f32 v62, v126
 v_exp_f32 v63, v127
 s_nop 0
 v_add_f32 v26, v48, v49
 v_add_f32 v26, v26, v50
 v_add_f32 v26, v26, v51
 v_add_f32 v26, v26, v56
 v_add_f32 v26, v26, v57
 v_add_f32 v26, v26, v58
 v_add_f32 v26, v26, v59
 v_cvt_pk_bf16_f32 v40, v48, v49
 v_cvt_pk_bf16_f32 v41, v50, v51
 v_cvt_pk_bf16_f32 v42, v56, v57
 v_cvt_pk_bf16_f32 v43, v58, v59
 v_add_f32 v27, v52, v53
 v_add_f32 v27, v27, v54
 v_add_f32 v27, v27, v55
 v_add_f32 v27, v27, v60
 v_add_f32 v27, v27, v61
 v_add_f32 v27, v27, v62
 v_add_f32 v27, v27, v63
 v_cvt_pk_bf16_f32 v44, v52, v53
 v_cvt_pk_bf16_f32 v45, v54, v55
 v_cvt_pk_bf16_f32 v46, v60, v61
 v_cvt_pk_bf16_f32 v47, v62, v63
 s_nop 1
 s_setpc_b64 s[46:47]
mk_done:
 s_endpgm
.section .rodata,"a"
.p2align 6
.amdhsa_kernel sequential_preLN__compressed_kv_cla__geglu_ffn__prompt_kernel
  .amdhsa_next_free_vgpr 512
  .amdhsa_next_free_sgpr 102
  .amdhsa_accum_offset 256
  .amdhsa_group_segment_fixed_size 0
  .amdhsa_kernarg_size 104
  .amdhsa_user_sgpr_count 2
  .amdhsa_user_sgpr_kernarg_segment_ptr 1
  .amdhsa_system_sgpr_workgroup_id_x 1
  .amdhsa_float_denorm_mode_32 3
.end_amdhsa_kernel
.text
```
